```python
import torch

def _softmax(x, axis=-1):
    return torch.softmax(x, dim=axis)
def _gelu(x):
    return torch.nn.functional.gelu(x, approximate="tanh")
def _silu(x):
    return torch.nn.functional.silu(x)
def _sigmoid(x):
    return torch.sigmoid(x)
def _layernorm(x, axis=-1, eps=1e-5):
    m = x.mean(dim=axis, keepdim=True)
    v = x.var(dim=axis, keepdim=True, unbiased=False)
    return (x - m) / torch.sqrt(v + eps)
def _scatter_add(tgt, idx, src, axis=0):
    return tgt.clone().index_add_(axis, idx, src)
def _segment_sum(src, seg, n):
    out = torch.zeros((n,) + src.shape[1:], dtype=src.dtype)
    return out.index_add_(0, seg, src)
def _pad(x, pw):
    flat = tuple(v for pair in reversed(pw) for v in pair)
    return torch.nn.functional.pad(x, flat)

kernel_name = 'interleave_layers__sliding_local_dilated__dense_activation_squared_relu__prompt'

def setup_inputs():

    _w = (lambda a: (lambda t: t.to(torch.bfloat16) if t.is_floating_point() else t)(torch.as_tensor(a)))
    def _A_setup():
        B, S, D = 1, 2048, 640
        return {
            "x": _w((lambda *s: torch.randn(*s, dtype=torch.bfloat16) * 0.05)(B, S, D)),
            "wqkv": _w((lambda *s: torch.randn(*s, dtype=torch.bfloat16) * 0.05)(D, 3 * D)),
            "wo": _w((lambda *s: torch.randn(*s, dtype=torch.bfloat16) * 0.05)(D, D)),
        }
    _A_in = _A_setup()

    def _B_setup():
        B, S, D, F = 1, 2048, 640, 1536
        return {
            "x": _w((lambda *s: torch.randn(*s, dtype=torch.bfloat16) * 0.05)(B, S, D)),
            "w1": _w((lambda *s: torch.randn(*s, dtype=torch.bfloat16) * 0.05)(D, F)),
            "b1": _w((lambda *s: torch.randn(*s, dtype=torch.bfloat16) * 0.2)(F)),
            "w2": _w((lambda *s: torch.randn(*s, dtype=torch.bfloat16) * 0.05)(F, D)),
            "b2": _w((lambda *s: torch.randn(*s, dtype=torch.bfloat16) * 0.8)(D)),
        }
    _B_in = _B_setup()

    return {
        "A_x": _A_in["x"],
        "A_wqkv": _A_in["wqkv"],
        "A_wo": _A_in["wo"],
        "B_x": _B_in["x"],
        "B_w1": _B_in["w1"],
        "B_b1": _B_in["b1"],
        "B_w2": _B_in["w2"],
        "B_b2": _B_in["b2"],
    }

def reference(A_x, A_wqkv, A_wo, B_x, B_w1, B_b1, B_w2, B_b2):
    def _A_ref(x, wqkv, wo):
        B, S, D = x.shape
        H = 32; Dh = D // H
        W, dil = 8, 2
        qkv = (lambda x, *d: x.permute(*d))((x @ wqkv).reshape(B, S, 3, H, Dh), 2, 0, 3, 1, 4)
        q, k, v = qkv[0], qkv[1], qkv[2]
        scale = Dh ** -0.5
        pos = torch.arange(S)
        off = torch.arange(W) * dil
        idx = pos[:, None] - off[None, :]
        mask = idx >= 0
        idx_c = torch.where(mask, idx, 0).reshape(-1)
        kg = k[:, :, idx_c, :].reshape(B, H, S, W, Dh)
        vg = v[:, :, idx_c, :].reshape(B, H, S, W, Dh)
        logits = torch.einsum("bhsd,bhswd->bhsw", q, kg) * scale
        logits = torch.where(mask[None, None, :, :], logits, -1e9)
        attn = _softmax(logits, axis=-1)
        o = torch.einsum("bhsw,bhswd->bhsd", attn, vg)
        return (lambda x, *d: x.permute(*d))(o, 0, 2, 1, 3).reshape(B, S, D) @ wo

    def _B_ref(x, w1, b1, w2, b2):
        h = torch.einsum("bsd,df->bsf", x, w1) + b1
        zero = torch.zeros_like(h)
        r = torch.where(h > zero, h, zero)
        h = r * r
        out = torch.einsum("bsf,fd->bsd", h, w2) + b2
        return out

    x = A_x
    x = x + _A_ref(_layernorm(x, axis=-1), A_wqkv, A_wo)
    x = x + _B_ref(_layernorm(x, axis=-1), B_w1, B_b1, B_w2, B_b2)
    x = x + _A_ref(_layernorm(x, axis=-1), A_wqkv, A_wo)
    x = x + _B_ref(_layernorm(x, axis=-1), B_w1, B_b1, B_w2, B_b2)
    return x
```

```asm
; @launch grid=(256,1,1) block=(512,1,1) lds=163840
.amdgcn_target "amdgcn-amd-amdhsa--gfx950"
.text
.globl interleave_layers__sliding_local_dilated__dense_activation_squared_relu__prompt_kernel
.p2align 8
.type interleave_layers__sliding_local_dilated__dense_activation_squared_relu__prompt_kernel,@function
interleave_layers__sliding_local_dilated__dense_activation_squared_relu__prompt_kernel:
    s_cmp_ge_u32 s2, 256
    s_cbranch_scc1 .Lend
    s_load_dwordx16 s[16:31], s[0:1], 0
    s_load_dwordx4 s[32:35], s[0:1], 64
    s_load_dwordx2 s[36:37], s[0:1], 80
    v_lshrrev_b32 v9, 6, v0
    v_and_b32 v1, 63, v0
    v_readfirstlane_b32 s38, v9
    s_getpc_b64 s[68:69]
.Lpc0:
    s_cmp_lg_u32 s38, 6
    s_cbranch_scc1 .Lnopf
    s_bfe_u32 s70, s2, 0x30003
    s_lshl_b32 s70, s70, 13
    v_lshl_add_u32 v9, v1, 7, s70
    v_min_u32 v10, .Lcode_end-.Lpc0-4, v9
    global_load_dword v24, v10, s[68:69]
.Lnopf:
    s_sub_u32 s89, s38, 4
    s_lshl_b32 s89, s89, 5
    s_lshr_b32 s68, s2, 3
    s_add_u32 s89, s89, s68
    s_and_b32 s68, s2, 7
    s_mul_i32 s68, s68, 40
    s_add_u32 s68, s68, s89
    s_cmp_lt_u32 s89, 40
    s_cselect_b32 s89, s68, 0x4000
    s_and_b32 s91, s89, 15
    s_lshr_b32 s90, s89, 4
    s_mul_i32 s72, s90, 122880
    s_mul_i32 s68, s91, 80
    s_add_u32 s72, s72, s68
    v_mul_u32_u24 v28, 4370, v1
    v_lshrrev_b32 v28, 16, v28
    v_mul_u32_u24 v29, 15, v28
    v_sub_u32 v29, v1, v29
    v_mul_u32_u24 v30, 13108, v29
    v_lshrrev_b32 v30, 16, v30
    v_mul_u32_u24 v30, 1200, v30
    v_mul_u32_u24 v28, 3840, v28
    v_lshl_add_u32 v28, v29, 4, v28
    v_add_u32 v28, v28, v30
    s_mul_i32 s80, s38, 10240
    s_add_u32 s80, s80, 79872
    s_mov_b32 s10, 0x258000
    s_mov_b32 s11, 0x20000
    s_getreg_b32 s39, hwreg(HW_REG_XCC_ID, 0, 4)
    s_and_b32 s39, s39, 7
    s_waitcnt lgkmcnt(0)
    s_cmpk_ge_u32 s89, 320
    s_cbranch_scc1 .Lu_nodma
    s_mov_b32 s8, s18
    s_and_b32 s9, s19, 0xffff
    s_mov_b32 exec_hi, 0xfffffff
    s_mov_b32 m0, s80
    s_nop 0
    buffer_load_dwordx4 v28, s[8:11], s72 offen lds
    s_add_u32 m0, m0, 960
    s_add_u32 s72, s72, 15360
    buffer_load_dwordx4 v28, s[8:11], s72 offen lds
    s_add_u32 m0, m0, 960
    s_add_u32 s72, s72, 15360
    buffer_load_dwordx4 v28, s[8:11], s72 offen lds
    s_add_u32 m0, m0, 960
    s_add_u32 s72, s72, 15360
    buffer_load_dwordx4 v28, s[8:11], s72 offen lds
    s_add_u32 m0, m0, 960
    s_add_u32 s72, s72, 15360
    buffer_load_dwordx4 v28, s[8:11], s72 offen lds
    s_add_u32 m0, m0, 960
    s_add_u32 s72, s72, 15360
    buffer_load_dwordx4 v28, s[8:11], s72 offen lds
    s_add_u32 m0, m0, 960
    s_add_u32 s72, s72, 15360
    buffer_load_dwordx4 v28, s[8:11], s72 offen lds
    s_add_u32 m0, m0, 960
    s_add_u32 s72, s72, 15360
    buffer_load_dwordx4 v28, s[8:11], s72 offen lds
    s_mov_b64 exec, -1
.Lu_nodma:
    s_cmp_lg_u32 s38, 7
    s_cbranch_scc1 .Lnorank
    s_lshl_b32 s68, s39, 5
    s_add_u32 s68, s34, s68
    s_addc_u32 s69, s35, 0
    s_mov_b32 s40, 1
    s_atomic_add s40, s[68:69], 0 glc
    s_add_u32 s98, s36, 0x29f0000
    s_addc_u32 s99, s37, 0
    s_load_dword s41, s[98:99], 0
.Lnorank:
    v_and_b32 v2, 15, v0
    v_bfe_u32 v3, v0, 4, 2
    v_lshlrev_b32 v4, 4, v1
    v_mov_b32 v8, 0
    s_mov_b32 s4, s36
    s_and_b32 s5, s37, 0xffff
    s_mov_b32 s6, 0x10000000
    s_mov_b32 s7, 0x20000
    s_mov_b32 s12, s16
    s_and_b32 s13, s17, 0xffff
    s_mov_b32 s14, 0x280000
    s_mov_b32 s15, 0x20000
    s_cmp_lg_u32 s38, 66
    s_cbranch_scc1 .Lnoxp
    s_bfe_u32 s68, s2, 0x50003
    s_lshl_b32 s69, s39, 5
    s_add_u32 s68, s68, s69
    s_mul_i32 s69, s68, 10240
    v_lshlrev_b32 v9, 7, v1
    v_lshlrev_b32 v10, 7, v2
    buffer_load_dword v24, v9, s[12:15], s69 offen
    s_add_u32 s69, s69, 8192
    buffer_load_dword v25, v10, s[12:15], s69 offen
.Lnoxp:
    s_cmp_lg_u32 s38, 6
    s_cbranch_scc1 .Lnotlb
    s_lshl_b32 s68, s39, 21
    v_lshlrev_b32 v9, 7, v1
    v_and_b32 v9, 0xfff, v9
    v_lshrrev_b32 v10, 5, v1
    v_lshl_add_u32 v9, v10, 20, v9
    s_add_u32 s69, s68, 0xb0000
    buffer_load_dword v108, v9, s[4:7], s69 offen
.Lnotlb:
    s_mov_b32 s88, 0x200000
    s_mov_b32 s43, 0
    v_cmp_eq_u32 vcc, 0, v1
    v_mov_b32 v9, 0x40000000
    s_lshl_b32 s68, s38, 2
    s_add_u32 s68, s68, 161792
    v_cndmask_b32 v11, v9, 0, vcc
    v_mov_b32 v9, s68
    v_mov_b32 v10, 0x40000
    v_cndmask_b32 v5, v10, v9, vcc
    v_mov_b32 v6, 161808
    s_cmp_le_u32 s38, 4
    s_cselect_b32 s68, 0, -30
    v_mov_b32 v9, s68
    ds_write2_b32 v5, v9, v8 offset0:0 offset1:8
    ds_write_b32 v5, v8 offset:64
    s_cmp_eq_u32 s38, 7
    s_cbranch_scc1 .Lbar
    s_waitcnt lgkmcnt(0)
.Lbar:
    s_barrier
    s_cmp_lg_u32 s38, 7
    s_cbranch_scc1 .Lnorank2
    s_waitcnt lgkmcnt(0)
    s_xor_b32 s41, s41, 0x9e3779b9
    s_mul_i32 s41, s41, 0x85ebca6b
    s_add_u32 s41, s41, 0x7f4a7c15
    s_add_u32 s40, s40, 1
    v_mov_b32 v26, s41
    v_mov_b32 v27, s40
    ds_write_b64 v5, v[26:27] offset:12
    s_lshl_b32 s68, s2, 2
    s_add_u32 s68, s68, 0x29ec000
    buffer_store_dword v26, v11, s[4:7], s68 offen sc1
.Lnorank2:
    v_mov_b32 v36, 0x3f803f80
    v_mov_b32 v37, 0x3f803f80
    v_mov_b32 v38, 0x3f803f80
    v_mov_b32 v39, 0x3f803f80
    v_lshlrev_b32 v34, 2, v1
    v_mul_u32_u24 v31, 2560, v2
    v_lshl_add_u32 v31, v3, 3, v31
    s_cmpk_ge_u32 s89, 320
    s_cbranch_scc1 .Lrank0
    v_lshrrev_b32 v32, 2, v1
    v_mul_u32_u24 v32, 240, v32
    v_add_u32 v32, s80, v32
    v_and_b32 v9, 3, v1
    v_mad_u32_u24 v33, v9, 40, v32
    v_lshl_add_u32 v32, v9, 3, v32
    s_mul_i32 s78, s91, 153600
    s_add_u32 s78, s78, 0x2201000
    s_mul_i32 s86, s91, 20
    s_add_u32 s86, s86, s90
    s_lshl_b32 s86, s86, 7
    s_add_u32 s86, s86, 0x29e0000
    s_waitcnt vmcnt(0)
    ds_read_b64_tr_b16 v[40:41], v32 offset:0
    ds_read_b64_tr_b16 v[42:43], v32 offset:3840
    ds_read_b64_tr_b16 v[44:45], v32 offset:40
    ds_read_b64_tr_b16 v[46:47], v32 offset:3880
    ds_read_b64_tr_b16 v[48:49], v32 offset:80
    ds_read_b64_tr_b16 v[50:51], v32 offset:3920
    ds_read_b64_tr_b16 v[52:53], v32 offset:120
    ds_read_b64_tr_b16 v[54:55], v32 offset:3960
    ds_read_b64_tr_b16 v[56:57], v33 offset:32
    ds_read_b64_tr_b16 v[58:59], v33 offset:3872
    ds_read_b64_tr_b16 v[60:61], v32 offset:160
    ds_read_b64_tr_b16 v[62:63], v32 offset:4000
    ds_read_b64_tr_b16 v[64:65], v32 offset:200
    ds_read_b64_tr_b16 v[66:67], v32 offset:4040
    ds_read_b64_tr_b16 v[68:69], v33 offset:192
    ds_read_b64_tr_b16 v[70:71], v33 offset:4032
    s_lshr_b32 s68, s90, 1
    s_mul_i32 s68, s68, 15360
    s_add_u32 s78, s78, s68
    s_and_b32 s69, s90, 1
    s_lshl_b32 s68, s69, 13
    s_add_u32 s68, s68, s78
    s_add_u32 s82, s68, 4096
    s_lshl_b32 s69, s69, 7
    s_add_u32 s69, s69, s78
    s_add_u32 s69, s69, 7168
    v_cmp_gt_u32 vcc, 8, v2
    v_mov_b32 v9, 0x40000000
    s_nop 0
    v_cndmask_b32 v10, v9, v4, vcc
    s_waitcnt lgkmcnt(14)
    buffer_store_dwordx4 v[40:43], v4, s[4:7], s68 offen offset:0 sc1
    s_waitcnt lgkmcnt(12)
    buffer_store_dwordx4 v[44:47], v4, s[4:7], s68 offen offset:1024 sc1
    s_waitcnt lgkmcnt(10)
    buffer_store_dwordx4 v[48:51], v4, s[4:7], s68 offen offset:2048 sc1
    s_waitcnt lgkmcnt(8)
    buffer_store_dwordx4 v[52:55], v4, s[4:7], s68 offen offset:3072 sc1
    s_waitcnt lgkmcnt(6)
    buffer_store_dwordx4 v[56:59], v4, s[4:7], s82 offen offset:0 sc1
    s_waitcnt lgkmcnt(4)
    buffer_store_dwordx4 v[60:63], v4, s[4:7], s82 offen offset:1024 sc1
    s_waitcnt lgkmcnt(2)
    buffer_store_dwordx4 v[64:67], v4, s[4:7], s82 offen offset:2048 sc1
    s_waitcnt lgkmcnt(0)
    buffer_store_dwordx4 v[68:71], v10, s[4:7], s69 offen sc1
    v_mfma_f32_16x16x32_bf16 v[72:75], v[36:39], v[40:43], 0
    v_mfma_f32_16x16x32_bf16 v[76:79], v[36:39], v[44:47], 0
    v_mfma_f32_16x16x32_bf16 v[80:83], v[36:39], v[48:51], 0
    v_mfma_f32_16x16x32_bf16 v[84:87], v[36:39], v[52:55], 0
    v_mfma_f32_16x16x32_bf16 v[88:91], v[36:39], v[56:59], 0
    v_mfma_f32_16x16x32_bf16 v[92:95], v[36:39], v[60:63], 0
    v_mfma_f32_16x16x32_bf16 v[96:99], v[36:39], v[64:67], 0
    v_mfma_f32_16x16x32_bf16 v[100:103], v[36:39], v[68:71], 0
    s_mul_i32 s68, s91, 10240
    s_lshl_b32 s69, s90, 9
    s_add_u32 s68, s68, s69
    s_add_u32 s68, s68, 0x2980000
    v_cmp_eq_u32 vcc, 1, v3
    s_nop 1
    v_cndmask_b32 v72, v72, v76, vcc
    v_cmp_eq_u32 vcc, 2, v3
    s_nop 1
    v_cndmask_b32 v72, v72, v80, vcc
    v_cmp_eq_u32 vcc, 3, v3
    s_nop 1
    v_cndmask_b32 v72, v72, v84, vcc
    buffer_store_dword v72, v34, s[4:7], s68 offen offset:0 sc1
    v_cmp_eq_u32 vcc, 1, v3
    s_nop 1
    v_cndmask_b32 v88, v88, v92, vcc
    v_cmp_eq_u32 vcc, 2, v3
    s_nop 1
    v_cndmask_b32 v88, v88, v96, vcc
    v_cmp_eq_u32 vcc, 3, v3
    s_nop 1
    v_cndmask_b32 v88, v88, v100, vcc
    buffer_store_dword v88, v34, s[4:7], s68 offen offset:256 sc1
.Lrank0:
    s_cmpk_lt_u32 s89, 320
    s_cbranch_scc1 .Lrank1
    s_cmp_ge_u32 s38, 5
    s_cbranch_scc1 .Lhelper
.Lrank1:
    s_call_b64 s[46:47], .Lrankw
    s_cmp_ge_u32 s38, 4
    s_cbranch_scc1 .Lu_nox
    buffer_load_dwordx2 v[12:13], v31, s[12:15], s64 offen offset:0
    buffer_load_dwordx2 v[14:15], v31, s[12:15], s64 offen offset:32
    buffer_load_dwordx2 v[16:17], v31, s[12:15], s64 offen offset:64
    buffer_load_dwordx2 v[18:19], v31, s[12:15], s64 offen offset:96
    buffer_load_dwordx2 v[20:21], v31, s[12:15], s65 offen
    s_mul_i32 s66, s60, 5
    s_add_u32 s66, s66, s62
    s_lshl_b32 s66, s66, 9
    s_mul_i32 s69, s62, 3064
    s_sub_u32 s67, s66, s69
    s_add_u32 s67, s67, 2048
    s_waitcnt vmcnt(0)
    s_branch .Lcompute
.Lu_nox:
    s_waitcnt vmcnt(0)
    buffer_store_dword v7, v11, s[4:7], s86 offen sc1
    s_cmp_eq_u32 s38, 4
    s_cbranch_scc1 .Lloader
    s_branch .Lhelper
.Lrankw:
    ds_read_b64 v[14:15], v6 offset:24
    s_waitcnt lgkmcnt(0)
    v_readfirstlane_b32 s40, v15
    v_readfirstlane_b32 s41, v14
    s_sub_u32 s88, s88, 1
    s_cbranch_scc1 .Lend
    s_cmp_eq_u32 s40, 0
    s_cbranch_scc1 .Lrankw
    s_sub_u32 s40, s40, 1
    v_mov_b32 v7, s41
    s_getreg_b32 s39, hwreg(HW_REG_XCC_ID, 0, 4)
    s_and_b32 s39, s39, 7
    s_lshl_b32 s39, s39, 1
    s_bfe_u32 s68, s40, 0x10004
    s_add_u32 s39, s39, s68
    s_and_b32 s40, s40, 15
    s_lshl_b32 s42, s39, 20
    s_and_b32 s60, s40, 7
    s_lshr_b32 s61, s40, 3
    s_and_b32 s62, s40, 1
    s_lshl_b32 s63, s38, 1
    s_add_u32 s63, s63, s61
    s_and_b32 s68, s63, 3
    s_lshl_b32 s68, s68, 5
    s_lshr_b32 s69, s63, 2
    s_add_u32 s68, s68, s69
    s_lshl_b32 s69, s39, 7
    s_add_u32 s68, s68, s69
    s_mul_i32 s68, s68, 1280
    s_mul_i32 s69, s60, 160
    s_add_u32 s68, s68, s69
    s_lshl_b32 s69, s62, 5
    s_add_u32 s64, s68, s69
    s_lshl_b32 s69, s62, 7
    s_sub_u32 s65, s68, s69
    s_add_u32 s65, s65, 128
    s_setpc_b64 s[46:47]
.Lcompute:
    s_mov_b32 s44, 0
    s_lshr_b32 s68, s60, 1
    s_lshl_b32 s68, s68, 8
    s_lshl_b32 s69, s62, 3
    s_add_u32 s68, s68, s69
    v_lshlrev_b32 v9, 4, v2
    v_lshl_add_u32 v9, v3, 1, v9
    v_add_u32 v9, s68, v9
    v_and_b32 v10, 1, v3
    v_lshlrev_b32 v10, 30, v10
    v_or_b32 v22, v9, v10
    s_mul_i32 s68, s63, 20480
    s_add_u32 s68, s68, s42
    s_add_u32 s68, s68, 0x0
    s_add_u32 s69, s68, s67
    s_add_u32 s68, s68, s66
    s_lshl_b32 s70, s63, 10
    s_add_u32 s70, s70, s42
    s_add_u32 s70, s70, 0xb1000
    s_lshl_b32 s71, s63, 5
    s_add_u32 s71, s71, s60
    s_lshl_b32 s71, s71, 2
    s_add_u32 s71, s71, s42
    s_add_u32 s71, s71, 0xb0000
    v_lshlrev_b32 v108, 16, v12
    v_and_b32 v109, 0xffff0000, v12
    v_lshlrev_b32 v110, 16, v13
    v_and_b32 v111, 0xffff0000, v13
    v_lshlrev_b32 v112, 16, v14
    v_and_b32 v113, 0xffff0000, v14
    v_lshlrev_b32 v114, 16, v15
    v_and_b32 v115, 0xffff0000, v15
    v_lshlrev_b32 v116, 16, v16
    v_and_b32 v117, 0xffff0000, v16
    v_lshlrev_b32 v118, 16, v17
    v_and_b32 v119, 0xffff0000, v17
    v_lshlrev_b32 v120, 16, v18
    v_and_b32 v121, 0xffff0000, v18
    v_lshlrev_b32 v122, 16, v19
    v_and_b32 v123, 0xffff0000, v19
    v_lshlrev_b32 v124, 16, v20
    v_and_b32 v125, 0xffff0000, v20
    v_lshlrev_b32 v126, 16, v21
    v_and_b32 v127, 0xffff0000, v21
    buffer_store_dwordx4 v[12:15], v4, s[4:7], s68 offen sc1
    buffer_store_dwordx4 v[16:19], v4, s[4:7], s68 offen offset:1024 sc1
    buffer_store_dwordx2 v[20:21], v4, s[4:7], s69 offen sc1
    v_pk_add_f32 v[128:129], v[108:109], v[110:111]
    v_pk_mul_f32 v[130:131], v[108:109], v[108:109]
    v_pk_fma_f32 v[130:131], v[110:111], v[110:111], v[130:131]
    v_pk_add_f32 v[128:129], v[128:129], v[112:113]
    v_pk_fma_f32 v[130:131], v[112:113], v[112:113], v[130:131]
    v_pk_add_f32 v[128:129], v[128:129], v[114:115]
    v_pk_fma_f32 v[130:131], v[114:115], v[114:115], v[130:131]
    v_pk_add_f32 v[128:129], v[128:129], v[116:117]
    v_pk_fma_f32 v[130:131], v[116:117], v[116:117], v[130:131]
    v_pk_add_f32 v[128:129], v[128:129], v[118:119]
    v_pk_fma_f32 v[130:131], v[118:119], v[118:119], v[130:131]
    v_pk_add_f32 v[128:129], v[128:129], v[120:121]
    v_pk_fma_f32 v[130:131], v[120:121], v[120:121], v[130:131]
    v_pk_add_f32 v[128:129], v[128:129], v[122:123]
    v_pk_fma_f32 v[130:131], v[122:123], v[122:123], v[130:131]
    v_pk_add_f32 v[128:129], v[128:129], v[124:125]
    v_pk_fma_f32 v[130:131], v[124:125], v[124:125], v[130:131]
    v_pk_add_f32 v[128:129], v[128:129], v[126:127]
    v_pk_fma_f32 v[130:131], v[126:127], v[126:127], v[130:131]
    v_add_f32 v128, v128, v129
    v_add_f32 v130, v130, v131
    s_nop 1
    v_permlane32_swap_b32 v128, v130
    v_add_f32 v128, v128, v130
    v_mov_b32 v130, v128
    s_nop 1
    v_permlane16_swap_b32 v128, v130
    v_add_f32 v128, v128, v130
    buffer_store_dword v128, v22, s[4:7], s70 offen sc1
    s_mov_b32 s87, 0x3ea52b5c
    s_mov_b64 s[56:57], 0xffff
    s_mov_b32 s58, 0xffff0000
    s_mov_b32 s59, 0
    v_lshlrev_b32 v9, 2, v3
    v_sub_u32 v9, v2, v9
    v_subrev_u32 v10, 0, v9
    v_cmp_ge_u32 s[48:49], 7, v10
    v_subrev_u32 v10, 1, v9
    v_cmp_ge_u32 s[50:51], 7, v10
    v_subrev_u32 v10, 2, v9
    v_cmp_ge_u32 s[52:53], 7, v10
    v_subrev_u32 v10, 3, v9
    v_cmp_ge_u32 s[54:55], 7, v10
    s_mov_b32 s90, 0x40000000
    s_mov_b32 s89, 0xb4000
    s_mov_b32 s91, -1
    s_waitcnt vmcnt(0)
    buffer_store_dword v7, v11, s[4:7], s71 offen offset:0
.Liter:
    s_waitcnt lgkmcnt(0)
    s_and_b32 s81, s38, 1
    s_lshl_b32 s83, s38, 1
    v_mov_b32 v128, v4
    v_and_b32 v129, 0x370, v4
    s_mul_i32 s97, s83, 20480
    s_add_u32 s97, s97, s42
    s_add_u32 s95, s97, 20480
    s_mov_b32 s84, s97
    v_add_u32 v255, 20480, v4
    s_lshl_b32 s72, s83, 10
    s_add_u32 s72, s72, s42
    s_add_u32 s72, s72, 0xb1000
    s_lshl_b32 s73, s83, 7
    s_add_u32 s73, s73, s42
    s_add_u32 s74, s73, 0xb0000
    v_and_b32 v9, 7, v1
    v_lshlrev_b32 v9, 2, v9
    v_and_b32 v10, 8, v1
    v_lshl_add_u32 v130, v10, 4, v9
    s_mov_b32 exec_lo, 0xffff
    s_mov_b32 exec_hi, 0x0
.Lp1:
    buffer_load_dword v9, v130, s[4:7], s74 offen sc1
    s_waitcnt vmcnt(0)
    v_cmp_ne_u32 vcc, s41, v9
    s_nop 0
    s_cbranch_vccz .Lpd2
    s_sub_u32 s88, s88, 1
    s_cbranch_scc1 .Lend
    s_branch .Lp1
.Lpd2:
    s_mov_b64 exec, -1
    buffer_load_dwordx4 v[148:151], v4, s[4:7], s84 offen offset:0 sc1
    buffer_load_dwordx4 v[152:155], v255, s[4:7], s84 offen offset:0 sc1
    buffer_load_dwordx4 v[120:123], v4, s[4:7], s72 offen sc1
    buffer_load_dwordx4 v[124:127], v4, s[4:7], s72 offen offset:1024 sc1
    buffer_load_dwordx4 v[156:159], v4, s[4:7], s84 offen offset:1024 sc1
    buffer_load_dwordx4 v[160:163], v255, s[4:7], s84 offen offset:1024 sc1
    buffer_load_dwordx4 v[164:167], v4, s[4:7], s84 offen offset:2048 sc1
    buffer_load_dwordx4 v[168:171], v255, s[4:7], s84 offen offset:2048 sc1
    s_cmpk_ge_i32 s44, 15
    s_cbranch_scc0 .Lcf3
.Lcr4:
    ds_read_b128 v[88:91], v128 offset:0
    ds_read_b128 v[92:95], v128 offset:1024
    ds_read_b128 v[96:99], v128 offset:2048
    ds_read_b128 v[100:103], v128 offset:3072
    ds_read_b128 v[104:107], v128 offset:4096
    ds_read_b128 v[108:111], v128 offset:5120
    ds_read_b128 v[112:115], v128 offset:6144
    ds_read_b128 v[116:119], v129 offset:7168
    s_waitcnt vmcnt(6) lgkmcnt(6)
    v_mfma_f32_16x16x32_bf16 v[24:27], v[88:91], v[148:151], 0
    buffer_load_dwordx4 v[172:175], v4, s[4:7], s84 offen offset:3072 sc1
    v_mfma_f32_16x16x32_bf16 v[56:59], v[88:91], v[152:155], 0
    ds_read_b128 v[88:91], v128 offset:8192
    v_mfma_f32_16x16x32_bf16 v[28:31], v[92:95], v[148:151], 0
    buffer_load_dwordx4 v[176:179], v255, s[4:7], s84 offen offset:3072 sc1
    v_mfma_f32_16x16x32_bf16 v[60:63], v[92:95], v[152:155], 0
    ds_read_b128 v[92:95], v128 offset:9216
    s_waitcnt lgkmcnt(6)
    v_mfma_f32_16x16x32_bf16 v[32:35], v[96:99], v[148:151], 0
    s_add_u32 s84, s84, 4096
    ds_read_b32 v10, v6
    v_mfma_f32_16x16x32_bf16 v[64:67], v[96:99], v[152:155], 0
    ds_read_b128 v[96:99], v128 offset:10240
    v_mfma_f32_16x16x32_bf16 v[36:39], v[100:103], v[148:151], 0
    v_mfma_f32_16x16x32_bf16 v[68:71], v[100:103], v[152:155], 0
    ds_read_b128 v[100:103], v128 offset:11264
    s_waitcnt lgkmcnt(7)
    v_mfma_f32_16x16x32_bf16 v[40:43], v[104:107], v[148:151], 0
    buffer_load_dwordx4 v[180:183], v4, s[4:7], s84 offen offset:0 sc1
    v_mfma_f32_16x16x32_bf16 v[72:75], v[104:107], v[152:155], 0
    ds_read_b128 v[104:107], v128 offset:12288
    s_mul_i32 s68, s83, 20480
    v_mfma_f32_16x16x32_bf16 v[44:47], v[148:151], v[108:111], 0
    buffer_load_dwordx4 v[184:187], v255, s[4:7], s84 offen offset:0 sc1
    v_mfma_f32_16x16x32_bf16 v[76:79], v[152:155], v[108:111], 0
    ds_read_b128 v[108:111], v128 offset:13312
    s_waitcnt lgkmcnt(7)
    v_mfma_f32_16x16x32_bf16 v[48:51], v[148:151], v[112:115], 0
    s_add_u32 s68, s68, s42
    s_add_u32 s68, s68, 0x28000
    s_lshl_b32 s69, s40, 2
    v_mfma_f32_16x16x32_bf16 v[80:83], v[152:155], v[112:115], 0
    ds_read_b128 v[112:115], v128 offset:14336
    s_add_u32 s76, s73, s69
    v_mfma_f32_16x16x32_bf16 v[52:55], v[148:151], v[116:119], 0
    s_add_u32 s76, s76, 0xb0400
    s_lshl_b32 s69, s40, 10
    s_add_u32 s72, s68, s69
    v_mfma_f32_16x16x32_bf16 v[84:87], v[152:155], v[116:119], 0
    ds_read_b128 v[116:119], v129 offset:7296
    s_waitcnt vmcnt(6) lgkmcnt(7)
    v_mfma_f32_16x16x32_bf16 v[24:27], v[88:91], v[156:159], v[24:27]
    s_cmpk_ge_i32 s44, 30
    s_cbranch_scc0 .Lcf5
.Lcr6:
    v_mfma_f32_16x16x32_bf16 v[56:59], v[88:91], v[160:163], v[56:59]
    ds_read_b128 v[88:91], v128 offset:15360
    s_add_u32 s73, s72, 20480
    v_mfma_f32_16x16x32_bf16 v[28:31], v[92:95], v[156:159], v[28:31]
    buffer_load_dwordx4 v[188:191], v4, s[4:7], s84 offen offset:1024 sc1
    v_mfma_f32_16x16x32_bf16 v[60:63], v[92:95], v[160:163], v[60:63]
    ds_read_b128 v[92:95], v128 offset:16384
    s_waitcnt lgkmcnt(6)
    v_mfma_f32_16x16x32_bf16 v[32:35], v[96:99], v[156:159], v[32:35]
    buffer_load_dwordx4 v[192:195], v255, s[4:7], s84 offen offset:1024 sc1
    v_mfma_f32_16x16x32_bf16 v[64:67], v[96:99], v[160:163], v[64:67]
    ds_read_b128 v[96:99], v128 offset:17408
    s_lshl_b32 s69, s40, 8
    v_mfma_f32_16x16x32_bf16 v[36:39], v[100:103], v[156:159], v[36:39]
    s_add_u32 s74, s68, s69
    s_add_u32 s74, s74, 16384
    s_add_u32 s75, s74, 20480
    v_mfma_f32_16x16x32_bf16 v[68:71], v[100:103], v[160:163], v[68:71]
    ds_read_b128 v[100:103], v128 offset:18432
    s_waitcnt lgkmcnt(6)
    v_mfma_f32_16x16x32_bf16 v[40:43], v[104:107], v[156:159], v[40:43]
    buffer_load_dwordx4 v[196:199], v4, s[4:7], s84 offen offset:2048 sc1
    v_mfma_f32_16x16x32_bf16 v[72:75], v[104:107], v[160:163], v[72:75]
    ds_read_b128 v[104:107], v128 offset:19456
    s_lshl_b32 s78, s40, 2
    v_mfma_f32_16x16x32_bf16 v[44:47], v[156:159], v[108:111], v[44:47]
    v_readfirstlane_b32 s94, v10
    v_mfma_f32_16x16x32_bf16 v[76:79], v[160:163], v[108:111], v[76:79]
    s_sub_u32 s44, s94, s43
    s_add_u32 s78, s78, s38
    s_waitcnt lgkmcnt(5)
    v_mfma_f32_16x16x32_bf16 v[48:51], v[156:159], v[112:115], v[48:51]
    ds_read_b128 v[108:111], v128 offset:20480
    s_lshl_b32 s78, s78, 11
    v_mfma_f32_16x16x32_bf16 v[80:83], v[160:163], v[112:115], v[80:83]
    ds_read_b128 v[112:115], v128 offset:21504
    s_add_u32 s78, s78, s42
    v_mfma_f32_16x16x32_bf16 v[52:55], v[156:159], v[116:119], v[52:55]
    buffer_load_dwordx4 v[200:203], v255, s[4:7], s84 offen offset:2048 sc1
    v_mfma_f32_16x16x32_bf16 v[84:87], v[160:163], v[116:119], v[84:87]
    ds_read_b128 v[116:119], v129 offset:22528
    s_waitcnt vmcnt(8) lgkmcnt(6)
    v_mfma_f32_16x16x32_bf16 v[24:27], v[88:91], v[164:167], v[24:27]
    buffer_load_dwordx4 v[204:207], v4, s[4:7], s84 offen offset:3072 sc1
    v_mfma_f32_16x16x32_bf16 v[56:59], v[88:91], v[168:171], v[56:59]
    ds_read_b128 v[88:91], v128 offset:23552
    s_add_u32 s78, s78, s89
    v_mfma_f32_16x16x32_bf16 v[28:31], v[92:95], v[164:167], v[28:31]
    buffer_load_dwordx4 v[208:211], v255, s[4:7], s84 offen offset:3072 sc1
    v_mfma_f32_16x16x32_bf16 v[60:63], v[92:95], v[168:171], v[60:63]
    ds_read_b128 v[92:95], v128 offset:24576
    s_waitcnt lgkmcnt(6)
    v_mfma_f32_16x16x32_bf16 v[32:35], v[96:99], v[164:167], v[32:35]
    s_add_u32 s84, s84, 4096
    ds_read_b32 v10, v6
    v_mfma_f32_16x16x32_bf16 v[64:67], v[96:99], v[168:171], v[64:67]
    ds_read_b128 v[96:99], v128 offset:25600
    s_mul_i32 s77, s81, 0xff000
    v_mfma_f32_16x16x32_bf16 v[36:39], v[100:103], v[164:167], v[36:39]
    s_add_u32 s77, s77, s78
    s_add_u32 s77, s77, 2048
    s_and_b32 s80, s39, s81
    v_mfma_f32_16x16x32_bf16 v[68:71], v[100:103], v[168:171], v[68:71]
    ds_read_b128 v[100:103], v128 offset:26624
    s_waitcnt lgkmcnt(7)
    v_mfma_f32_16x16x32_bf16 v[40:43], v[104:107], v[164:167], v[40:43]
    buffer_load_dwordx4 v[212:215], v4, s[4:7], s84 offen offset:0 sc1
    v_mfma_f32_16x16x32_bf16 v[72:75], v[104:107], v[168:171], v[72:75]
    ds_read_b128 v[104:107], v128 offset:27648
    s_xor_b32 s80, s80, 1
    v_mfma_f32_16x16x32_bf16 v[44:47], v[164:167], v[108:111], v[44:47]
    buffer_load_dwordx4 v[216:219], v255, s[4:7], s84 offen offset:0 sc1
    v_mfma_f32_16x16x32_bf16 v[76:79], v[168:171], v[108:111], v[76:79]
    ds_read_b128 v[108:111], v128 offset:28672
    s_waitcnt lgkmcnt(7)
    v_mfma_f32_16x16x32_bf16 v[48:51], v[164:167], v[112:115], v[48:51]
    s_and_b32 s80, s80, 1
    v_mov_b32 v252, 0xffff
    v_mfma_f32_16x16x32_bf16 v[80:83], v[168:171], v[112:115], v[80:83]
    ds_read_b128 v[112:115], v128 offset:29696
    v_mov_b32 v253, 0xffff0000
    v_mfma_f32_16x16x32_bf16 v[52:55], v[164:167], v[116:119], v[52:55]
    v_cndmask_b32 v138, 0, v252, s[48:49]
    v_mfma_f32_16x16x32_bf16 v[84:87], v[168:171], v[116:119], v[84:87]
    ds_read_b128 v[116:119], v129 offset:22656
    s_waitcnt vmcnt(10) lgkmcnt(7)
    v_mfma_f32_16x16x32_bf16 v[24:27], v[88:91], v[172:175], v[24:27]
    s_cmpk_ge_i32 s44, 45
    s_cbranch_scc0 .Lcf7
.Lcr8:
    v_mfma_f32_16x16x32_bf16 v[56:59], v[88:91], v[176:179], v[56:59]
    ds_read_b128 v[88:91], v128 offset:30720
    v_cndmask_b32 v254, 0, v253, s[50:51]
    v_mfma_f32_16x16x32_bf16 v[28:31], v[92:95], v[172:175], v[28:31]
    buffer_load_dwordx4 v[220:223], v4, s[4:7], s84 offen offset:1024 sc1
    v_mfma_f32_16x16x32_bf16 v[60:63], v[92:95], v[176:179], v[60:63]
    ds_read_b128 v[92:95], v128 offset:31744
    s_waitcnt lgkmcnt(6)
    v_mfma_f32_16x16x32_bf16 v[32:35], v[96:99], v[172:175], v[32:35]
    buffer_load_dwordx4 v[224:227], v255, s[4:7], s84 offen offset:1024 sc1
    v_mfma_f32_16x16x32_bf16 v[64:67], v[96:99], v[176:179], v[64:67]
    ds_read_b128 v[96:99], v128 offset:32768
    s_add_u32 s84, s84, 2048
    v_mfma_f32_16x16x32_bf16 v[36:39], v[100:103], v[172:175], v[36:39]
    v_readfirstlane_b32 s94, v10
    v_mfma_f32_16x16x32_bf16 v[68:71], v[100:103], v[176:179], v[68:71]
    ds_read_b128 v[100:103], v128 offset:33792
    s_waitcnt lgkmcnt(6)
    v_mfma_f32_16x16x32_bf16 v[40:43], v[104:107], v[172:175], v[40:43]
    s_sub_u32 s44, s94, s43
    v_or_b32 v138, v138, v254
    v_mfma_f32_16x16x32_bf16 v[72:75], v[104:107], v[176:179], v[72:75]
    ds_read_b128 v[104:107], v128 offset:34816
    v_cndmask_b32 v139, 0, v252, s[52:53]
    v_mfma_f32_16x16x32_bf16 v[44:47], v[172:175], v[108:111], v[44:47]
    buffer_load_dwordx4 v[228:231], v4, s[4:7], s84 offen offset:0 sc1
    v_mfma_f32_16x16x32_bf16 v[76:79], v[176:179], v[108:111], v[76:79]
    ds_read_b128 v[108:111], v128 offset:35840
    s_waitcnt lgkmcnt(6)
    v_mfma_f32_16x16x32_bf16 v[48:51], v[172:175], v[112:115], v[48:51]
    buffer_load_dwordx4 v[232:235], v255, s[4:7], s84 offen offset:0 sc1
    v_mfma_f32_16x16x32_bf16 v[80:83], v[176:179], v[112:115], v[80:83]
    ds_read_b128 v[112:115], v128 offset:36864
    v_cndmask_b32 v254, 0, v253, s[54:55]
    v_mfma_f32_16x16x32_bf16 v[52:55], v[172:175], v[116:119], v[52:55]
    v_or_b32 v139, v139, v254
    v_mfma_f32_16x16x32_bf16 v[84:87], v[176:179], v[116:119], v[84:87]
    ds_read_b128 v[116:119], v129 offset:37888
    s_waitcnt vmcnt(12) lgkmcnt(6)
    v_mfma_f32_16x16x32_bf16 v[24:27], v[88:91], v[180:183], v[24:27]
    buffer_load_dwordx4 v[236:239], v4, s[4:7], s84 offen offset:1024 sc1
    v_mfma_f32_16x16x32_bf16 v[56:59], v[88:91], v[184:187], v[56:59]
    ds_read_b128 v[88:91], v128 offset:38912
    v_add_f32 v120, v120, v122
    v_mfma_f32_16x16x32_bf16 v[28:31], v[92:95], v[180:183], v[28:31]
    buffer_load_dwordx4 v[240:243], v255, s[4:7], s84 offen offset:1024 sc1
    v_mfma_f32_16x16x32_bf16 v[60:63], v[92:95], v[184:187], v[60:63]
    ds_read_b128 v[92:95], v128 offset:39936
    s_waitcnt lgkmcnt(6)
    v_mfma_f32_16x16x32_bf16 v[32:35], v[96:99], v[180:183], v[32:35]
    ds_read_b32 v10, v6
    v_add_f32 v121, v121, v123
    v_mfma_f32_16x16x32_bf16 v[64:67], v[96:99], v[184:187], v[64:67]
    ds_read_b128 v[96:99], v128 offset:40960
    v_permlane32_swap_b32 v120, v121
    v_mfma_f32_16x16x32_bf16 v[36:39], v[100:103], v[180:183], v[36:39]
    v_add_f32 v120, v120, v121
    v_mfma_f32_16x16x32_bf16 v[68:71], v[100:103], v[184:187], v[68:71]
    ds_read_b128 v[100:103], v128 offset:41984
    s_waitcnt lgkmcnt(7)
    v_mfma_f32_16x16x32_bf16 v[40:43], v[104:107], v[180:183], v[40:43]
    buffer_load_dwordx4 v[148:151], v4, s[4:7], s84 offen offset:2048 sc1
    v_mfma_f32_16x16x32_bf16 v[72:75], v[104:107], v[184:187], v[72:75]
    ds_read_b128 v[104:107], v128 offset:43008
    v_mov_b32 v121, v120
    v_mfma_f32_16x16x32_bf16 v[44:47], v[180:183], v[108:111], v[44:47]
    buffer_load_dwordx4 v[152:155], v255, s[4:7], s84 offen offset:2048 sc1
    v_mfma_f32_16x16x32_bf16 v[76:79], v[184:187], v[108:111], v[76:79]
    ds_read_b128 v[108:111], v128 offset:44032
    s_waitcnt lgkmcnt(7)
    v_mfma_f32_16x16x32_bf16 v[48:51], v[180:183], v[112:115], v[48:51]
    v_add_u32 v9, 45, v8
    v_mfma_f32_16x16x32_bf16 v[80:83], v[184:187], v[112:115], v[80:83]
    ds_read_b128 v[112:115], v128 offset:45056
    v_permlane16_swap_b32 v120, v121
    v_mfma_f32_16x16x32_bf16 v[52:55], v[180:183], v[116:119], v[52:55]
    v_add_f32 v120, v120, v121
    v_mfma_f32_16x16x32_bf16 v[84:87], v[184:187], v[116:119], v[84:87]
    ds_read_b128 v[116:119], v129 offset:38016
    s_waitcnt vmcnt(14) lgkmcnt(7)
    v_mfma_f32_16x16x32_bf16 v[24:27], v[88:91], v[188:191], v[24:27]
    ds_write_b32 v5, v9
    v_mul_f32 v120, 0x3acccccd, v120
    v_mfma_f32_16x16x32_bf16 v[56:59], v[88:91], v[192:195], v[56:59]
    s_cmpk_ge_i32 s44, 60
    s_cbranch_scc0 .Lcf9
.Lcr10:
    v_mfma_f32_16x16x32_bf16 v[28:31], v[92:95], v[188:191], v[28:31]
    ds_read_b128 v[88:91], v128 offset:46080
    v_mov_b32 v121, v120
    v_mfma_f32_16x16x32_bf16 v[60:63], v[92:95], v[192:195], v[60:63]
    ds_read_b128 v[92:95], v128 offset:47104
    s_waitcnt lgkmcnt(7)
    v_mfma_f32_16x16x32_bf16 v[32:35], v[96:99], v[188:191], v[32:35]
    buffer_load_dwordx4 v[156:159], v4, s[4:7], s84 offen offset:3072 sc1
    v_mfma_f32_16x16x32_bf16 v[64:67], v[96:99], v[192:195], v[64:67]
    buffer_load_dwordx4 v[160:163], v255, s[4:7], s84 offen offset:3072 sc1
    v_mfma_f32_16x16x32_bf16 v[36:39], v[100:103], v[188:191], v[36:39]
    ds_read_b128 v[96:99], v128 offset:48128
    s_add_u32 s84, s84, 4096
    v_mfma_f32_16x16x32_bf16 v[68:71], v[100:103], v[192:195], v[68:71]
    ds_read_b128 v[100:103], v128 offset:49152
    s_waitcnt lgkmcnt(7)
    v_mfma_f32_16x16x32_bf16 v[40:43], v[104:107], v[188:191], v[40:43]
    buffer_load_dwordx4 v[164:167], v4, s[4:7], s84 offen offset:0 sc1
    v_mfma_f32_16x16x32_bf16 v[72:75], v[104:107], v[192:195], v[72:75]
    ds_read_b128 v[104:107], v128 offset:50176
    v_readfirstlane_b32 s94, v10
    v_mfma_f32_16x16x32_bf16 v[44:47], v[188:191], v[108:111], v[44:47]
    buffer_load_dwordx4 v[168:171], v255, s[4:7], s84 offen offset:0 sc1
    v_mfma_f32_16x16x32_bf16 v[76:79], v[192:195], v[108:111], v[76:79]
    s_sub_u32 s44, s94, s43
    v_permlane32_swap_b32 v120, v121
    s_waitcnt lgkmcnt(6)
    v_mfma_f32_16x16x32_bf16 v[48:51], v[188:191], v[112:115], v[48:51]
    ds_read_b128 v[108:111], v128 offset:51200
    v_fma_f32 v122, -v120, v120, v121
    v_mfma_f32_16x16x32_bf16 v[80:83], v[192:195], v[112:115], v[80:83]
    ds_read_b128 v[112:115], v128 offset:52224
    v_max_f32 v122, 0, v122
    v_mfma_f32_16x16x32_bf16 v[52:55], v[188:191], v[116:119], v[52:55]
    v_add_f32 v122, 0x3727c5ac, v122
    v_mfma_f32_16x16x32_bf16 v[84:87], v[192:195], v[116:119], v[84:87]
    ds_read_b128 v[116:119], v129 offset:53248
    s_waitcnt vmcnt(16) lgkmcnt(6)
    v_mfma_f32_16x16x32_bf16 v[24:27], v[88:91], v[196:199], v[24:27]
    buffer_load_dwordx4 v[172:175], v4, s[4:7], s84 offen offset:1024 sc1
    v_mfma_f32_16x16x32_bf16 v[56:59], v[88:91], v[200:203], v[56:59]
    ds_read_b128 v[88:91], v128 offset:54272
    v_lshlrev_b32 v252, 2, v3
    v_mfma_f32_16x16x32_bf16 v[28:31], v[92:95], v[196:199], v[28:31]
    buffer_load_dwordx4 v[176:179], v255, s[4:7], s84 offen offset:1024 sc1
    v_mfma_f32_16x16x32_bf16 v[60:63], v[92:95], v[200:203], v[60:63]
    ds_read_b128 v[92:95], v128 offset:55296
    s_waitcnt lgkmcnt(6)
    v_mfma_f32_16x16x32_bf16 v[32:35], v[96:99], v[196:199], v[32:35]
    ds_read_b32 v10, v6
    v_sub_u32 v252, v252, v2
    v_mfma_f32_16x16x32_bf16 v[64:67], v[96:99], v[200:203], v[64:67]
    ds_read_b128 v[96:99], v128 offset:56320
    v_mov_b32 v253, 0xf149f2ca
    v_mfma_f32_16x16x32_bf16 v[36:39], v[100:103], v[196:199], v[36:39]
    s_or_b32 s79, s39, s81
    s_cselect_b64 s[70:71], -1, 0
    v_cmp_le_i32 vcc, 9, v252
    v_mfma_f32_16x16x32_bf16 v[68:71], v[100:103], v[200:203], v[68:71]
    ds_read_b128 v[100:103], v128 offset:57344
    s_waitcnt lgkmcnt(7)
    v_mfma_f32_16x16x32_bf16 v[40:43], v[104:107], v[196:199], v[40:43]
    buffer_load_dwordx4 v[180:183], v4, s[4:7], s84 offen offset:2048 sc1
    v_mfma_f32_16x16x32_bf16 v[72:75], v[104:107], v[200:203], v[72:75]
    ds_read_b128 v[104:107], v128 offset:58368
    v_cndmask_b32 v144, v253, 0, vcc
    v_mfma_f32_16x16x32_bf16 v[44:47], v[196:199], v[108:111], v[44:47]
    buffer_load_dwordx4 v[184:187], v255, s[4:7], s84 offen offset:2048 sc1
    v_mfma_f32_16x16x32_bf16 v[76:79], v[200:203], v[108:111], v[76:79]
    ds_read_b128 v[108:111], v128 offset:59392
    s_waitcnt lgkmcnt(7)
    v_mfma_f32_16x16x32_bf16 v[48:51], v[196:199], v[112:115], v[48:51]
    v_add_u32 v9, 60, v8
    v_mfma_f32_16x16x32_bf16 v[80:83], v[200:203], v[112:115], v[80:83]
    ds_read_b128 v[112:115], v128 offset:60416
    v_cndmask_b32 v140, v253, v144, s[70:71]
    v_mfma_f32_16x16x32_bf16 v[52:55], v[196:199], v[116:119], v[52:55]
    v_rsq_f32 v123, v122
    v_mfma_f32_16x16x32_bf16 v[84:87], v[200:203], v[116:119], v[84:87]
    ds_read_b128 v[116:119], v129 offset:53376
    s_waitcnt vmcnt(18) lgkmcnt(7)
    v_mfma_f32_16x16x32_bf16 v[24:27], v[88:91], v[204:207], v[24:27]
    ds_write_b32 v5, v9
    v_mul_f32_e64 v121, -v120, v123
    v_mfma_f32_16x16x32_bf16 v[56:59], v[88:91], v[208:211], v[56:59]
    s_cmpk_ge_i32 s44, 75
    s_cbranch_scc0 .Lcf11
.Lcr12:
    v_mfma_f32_16x16x32_bf16 v[28:31], v[92:95], v[204:207], v[28:31]
    buffer_load_dwordx4 v[188:191], v4, s[4:7], s84 offen offset:3072 sc1
    v_mfma_f32_16x16x32_bf16 v[60:63], v[92:95], v[208:211], v[60:63]
    v_add_u32 v128, 61440, v128
    s_waitcnt lgkmcnt(5)
    v_mfma_f32_16x16x32_bf16 v[32:35], v[96:99], v[204:207], v[32:35]
    ds_read_b128 v[88:91], v128 offset:0
    v_readfirstlane_b32 s94, v10
    v_mfma_f32_16x16x32_bf16 v[64:67], v[96:99], v[208:211], v[64:67]
    ds_read_b128 v[92:95], v128 offset:1024
    v_mov_b32 v120, v123
    v_mfma_f32_16x16x32_bf16 v[36:39], v[100:103], v[204:207], v[36:39]
    buffer_load_dwordx4 v[192:195], v255, s[4:7], s84 offen offset:3072 sc1
    v_mfma_f32_16x16x32_bf16 v[68:71], v[100:103], v[208:211], v[68:71]
    ds_read_b128 v[96:99], v128 offset:2048
    s_waitcnt lgkmcnt(6)
    v_mfma_f32_16x16x32_bf16 v[40:43], v[104:107], v[204:207], v[40:43]
    s_add_u32 s84, s84, 4096
    ds_read_b128 v[100:103], v128 offset:3072
    v_mfma_f32_16x16x32_bf16 v[72:75], v[104:107], v[208:211], v[72:75]
    s_sub_u32 s44, s94, s43
    ds_read_b128 v[104:107], v128 offset:4096
    v_mfma_f32_16x16x32_bf16 v[44:47], v[204:207], v[108:111], v[44:47]
    buffer_load_dwordx4 v[196:199], v4, s[4:7], s84 offen offset:0 sc1
    v_mfma_f32_16x16x32_bf16 v[76:79], v[208:211], v[108:111], v[76:79]
    ds_read_b128 v[108:111], v128 offset:5120
    s_waitcnt lgkmcnt(7)
    v_mfma_f32_16x16x32_bf16 v[48:51], v[204:207], v[112:115], v[48:51]
    buffer_load_dwordx4 v[200:203], v255, s[4:7], s84 offen offset:0 sc1
    v_mfma_f32_16x16x32_bf16 v[80:83], v[208:211], v[112:115], v[80:83]
    ds_read_b128 v[112:115], v128 offset:6144
    v_add_f32 v124, v124, v126
    v_mfma_f32_16x16x32_bf16 v[52:55], v[204:207], v[116:119], v[52:55]
    v_add_u32 v129, 61440, v129
    v_mfma_f32_16x16x32_bf16 v[84:87], v[208:211], v[116:119], v[84:87]
    ds_read_b128 v[116:119], v129 offset:7168
    s_waitcnt vmcnt(20) lgkmcnt(6)
    v_mfma_f32_16x16x32_bf16 v[24:27], v[88:91], v[212:215], v[24:27]
    buffer_load_dwordx4 v[204:207], v4, s[4:7], s84 offen offset:1024 sc1
    v_mfma_f32_16x16x32_bf16 v[56:59], v[88:91], v[216:219], v[56:59]
    ds_read_b128 v[88:91], v128 offset:8192
    v_add_f32 v125, v125, v127
    v_mfma_f32_16x16x32_bf16 v[28:31], v[92:95], v[212:215], v[28:31]
    buffer_load_dwordx4 v[208:211], v255, s[4:7], s84 offen offset:1024 sc1
    v_mfma_f32_16x16x32_bf16 v[60:63], v[92:95], v[216:219], v[60:63]
    ds_read_b128 v[92:95], v128 offset:9216
    s_waitcnt lgkmcnt(6)
    v_mfma_f32_16x16x32_bf16 v[32:35], v[96:99], v[212:215], v[32:35]
    ds_read_b32 v10, v6
    v_permlane32_swap_b32 v124, v125
    v_mfma_f32_16x16x32_bf16 v[64:67], v[96:99], v[216:219], v[64:67]
    ds_read_b128 v[96:99], v128 offset:10240
    v_add_f32 v124, v124, v125
    v_mfma_f32_16x16x32_bf16 v[36:39], v[100:103], v[212:215], v[36:39]
    v_mov_b32 v125, v124
    v_mfma_f32_16x16x32_bf16 v[68:71], v[100:103], v[216:219], v[68:71]
    ds_read_b128 v[100:103], v128 offset:11264
    s_waitcnt lgkmcnt(7)
    v_mfma_f32_16x16x32_bf16 v[40:43], v[104:107], v[212:215], v[40:43]
    v_permlane16_swap_b32 v124, v125
    v_mfma_f32_16x16x32_bf16 v[72:75], v[104:107], v[216:219], v[72:75]
    ds_read_b128 v[104:107], v128 offset:12288
    v_add_f32 v124, v124, v125
    v_mfma_f32_16x16x32_bf16 v[44:47], v[212:215], v[108:111], v[44:47]
    v_mul_f32 v124, 0x3acccccd, v124
    v_mfma_f32_16x16x32_bf16 v[76:79], v[216:219], v[108:111], v[76:79]
    ds_read_b128 v[108:111], v128 offset:13312
    s_waitcnt lgkmcnt(7)
    v_mfma_f32_16x16x32_bf16 v[48:51], v[212:215], v[112:115], v[48:51]
    v_add_u32 v9, 75, v8
    v_mfma_f32_16x16x32_bf16 v[80:83], v[216:219], v[112:115], v[80:83]
    ds_read_b128 v[112:115], v128 offset:14336
    v_mov_b32 v125, v124
    v_mfma_f32_16x16x32_bf16 v[52:55], v[212:215], v[116:119], v[52:55]
    s_nop 0
    v_permlane32_swap_b32 v124, v125
    v_mfma_f32_16x16x32_bf16 v[84:87], v[216:219], v[116:119], v[84:87]
    ds_read_b128 v[116:119], v129 offset:7296
    s_waitcnt vmcnt(20) lgkmcnt(7)
    v_mfma_f32_16x16x32_bf16 v[24:27], v[88:91], v[220:223], v[24:27]
    ds_write_b32 v5, v9
    v_fma_f32 v126, -v124, v124, v125
    v_mfma_f32_16x16x32_bf16 v[56:59], v[88:91], v[224:227], v[56:59]
    s_cmpk_ge_i32 s44, 90
    s_cbranch_scc0 .Lcf13
.Lcr14:
    v_mfma_f32_16x16x32_bf16 v[28:31], v[92:95], v[220:223], v[28:31]
    ds_read_b128 v[88:91], v128 offset:15360
    v_max_f32 v126, 0, v126
    v_mfma_f32_16x16x32_bf16 v[60:63], v[92:95], v[224:227], v[60:63]
    ds_read_b128 v[92:95], v128 offset:16384
    s_waitcnt lgkmcnt(7)
    v_mfma_f32_16x16x32_bf16 v[32:35], v[96:99], v[220:223], v[32:35]
    v_readfirstlane_b32 s94, v10
    v_mfma_f32_16x16x32_bf16 v[64:67], v[96:99], v[224:227], v[64:67]
    ds_read_b128 v[96:99], v128 offset:17408
    v_add_f32 v126, 0x3727c5ac, v126
    v_mfma_f32_16x16x32_bf16 v[36:39], v[100:103], v[220:223], v[36:39]
    s_sub_u32 s44, s94, s43
    v_cmp_le_i32 vcc, 8, v252
    v_mfma_f32_16x16x32_bf16 v[68:71], v[100:103], v[224:227], v[68:71]
    ds_read_b128 v[100:103], v128 offset:18432
    s_waitcnt lgkmcnt(7)
    v_mfma_f32_16x16x32_bf16 v[40:43], v[104:107], v[220:223], v[40:43]
    v_cndmask_b32 v145, v253, 0, vcc
    v_mfma_f32_16x16x32_bf16 v[72:75], v[104:107], v[224:227], v[72:75]
    ds_read_b128 v[104:107], v128 offset:19456
    v_cndmask_b32 v141, v253, v145, s[70:71]
    v_mfma_f32_16x16x32_bf16 v[44:47], v[220:223], v[108:111], v[44:47]
    v_cmp_le_i32 vcc, 7, v252
    v_mfma_f32_16x16x32_bf16 v[76:79], v[224:227], v[108:111], v[76:79]
    ds_read_b128 v[108:111], v128 offset:20480
    s_waitcnt lgkmcnt(7)
    v_mfma_f32_16x16x32_bf16 v[48:51], v[220:223], v[112:115], v[48:51]
    v_cndmask_b32 v146, v253, 0, vcc
    v_mfma_f32_16x16x32_bf16 v[80:83], v[224:227], v[112:115], v[80:83]
    ds_read_b128 v[112:115], v128 offset:21504
    v_cndmask_b32 v142, v253, v146, s[70:71]
    v_mfma_f32_16x16x32_bf16 v[52:55], v[220:223], v[116:119], v[52:55]
    v_cmp_le_i32 vcc, 6, v252
    v_mfma_f32_16x16x32_bf16 v[84:87], v[224:227], v[116:119], v[84:87]
    ds_read_b128 v[116:119], v129 offset:22528
    s_waitcnt vmcnt(18) lgkmcnt(6)
    v_mfma_f32_16x16x32_bf16 v[24:27], v[88:91], v[228:231], v[24:27]
    v_cndmask_b32 v147, v253, 0, vcc
    v_mfma_f32_16x16x32_bf16 v[56:59], v[88:91], v[232:235], v[56:59]
    ds_read_b128 v[88:91], v128 offset:23552
    v_cndmask_b32 v143, v253, v147, s[70:71]
    v_mfma_f32_16x16x32_bf16 v[28:31], v[92:95], v[228:231], v[28:31]
    ds_read_b32 v10, v6
    v_and_b32 v133, 7, v2
    v_mfma_f32_16x16x32_bf16 v[60:63], v[92:95], v[232:235], v[60:63]
    ds_read_b128 v[92:95], v128 offset:24576
    s_waitcnt lgkmcnt(7)
    v_mfma_f32_16x16x32_bf16 v[32:35], v[96:99], v[228:231], v[32:35]
    v_lshl_add_u32 v133, v3, 3, v133
    v_mfma_f32_16x16x32_bf16 v[64:67], v[96:99], v[232:235], v[64:67]
    ds_read_b128 v[96:99], v128 offset:25600
    v_lshlrev_b32 v133, 4, v133
    v_mfma_f32_16x16x32_bf16 v[36:39], v[100:103], v[228:231], v[36:39]
    v_and_b32 v134, 0x1f0, v4
    v_mfma_f32_16x16x32_bf16 v[68:71], v[100:103], v[232:235], v[68:71]
    ds_read_b128 v[100:103], v128 offset:26624
    s_waitcnt lgkmcnt(7)
    v_mfma_f32_16x16x32_bf16 v[40:43], v[104:107], v[228:231], v[40:43]
    v_and_b32 v252, 8, v2
    v_mfma_f32_16x16x32_bf16 v[72:75], v[104:107], v[232:235], v[72:75]
    ds_read_b128 v[104:107], v128 offset:27648
    v_xor_b32 v252, 8, v252
    v_mfma_f32_16x16x32_bf16 v[44:47], v[228:231], v[108:111], v[44:47]
    v_lshl_or_b32 v131, v252, 27, v133
    v_mfma_f32_16x16x32_bf16 v[76:79], v[232:235], v[108:111], v[76:79]
    ds_read_b128 v[108:111], v128 offset:28672
    s_waitcnt lgkmcnt(7)
    v_mfma_f32_16x16x32_bf16 v[48:51], v[228:231], v[112:115], v[48:51]
    v_and_b32 v252, 2, v3
    v_mfma_f32_16x16x32_bf16 v[80:83], v[232:235], v[112:115], v[80:83]
    v_xor_b32 v253, 2, v252
    v_lshl_or_b32 v132, v253, 29, v134
    v_lshlrev_b32 v136, 4, v2
    v_lshl_add_u32 v136, v3, 3, v136
    v_lshl_or_b32 v136, v252, 29, v136
    v_lshlrev_b32 v135, 4, v3
    v_mfma_f32_16x16x32_bf16 v[52:55], v[228:231], v[116:119], v[52:55]
    v_rsq_f32 v127, v126
    v_add_u32 v137, 161888, v135
    v_mfma_f32_16x16x32_bf16 v[84:87], v[232:235], v[116:119], v[84:87]
    v_add_u32 v9, 90, v8
    ds_read_b128 v[112:115], v128 offset:29696
    ds_read_b128 v[116:119], v129 offset:22656
    v_mul_f32_e64 v125, -v124, v127
    v_lshlrev_b32 v130, 2, v2
    s_waitcnt vmcnt(16) lgkmcnt(6)
    v_mfma_f32_16x16x32_bf16 v[24:27], v[88:91], v[236:239], v[24:27]
    ds_write_b32 v5, v9
    v_mov_b32 v124, v127
    v_add_u32 v130, 161888, v130
    v_mfma_f32_16x16x32_bf16 v[56:59], v[88:91], v[240:243], v[56:59]
    s_cmpk_ge_i32 s44, 105
    s_cbranch_scc0 .Lcf15
.Lcr16:
    v_mfma_f32_16x16x32_bf16 v[28:31], v[92:95], v[236:239], v[28:31]
    ds_read_b128 v[88:91], v128 offset:30720
    v_and_b32 v252, 31, v1
    v_mfma_f32_16x16x32_bf16 v[60:63], v[92:95], v[240:243], v[60:63]
    ds_read_b128 v[92:95], v128 offset:31744
    s_waitcnt lgkmcnt(7)
    v_mfma_f32_16x16x32_bf16 v[32:35], v[96:99], v[236:239], v[32:35]
    v_readfirstlane_b32 s94, v10
    v_mfma_f32_16x16x32_bf16 v[64:67], v[96:99], v[240:243], v[64:67]
    ds_read_b128 v[96:99], v128 offset:32768
    v_lshrrev_b32 v253, 5, v1
    v_mfma_f32_16x16x32_bf16 v[36:39], v[100:103], v[236:239], v[36:39]
    s_sub_u32 s44, s94, s43
    v_lshlrev_b32 v253, 17, v253
    v_mfma_f32_16x16x32_bf16 v[68:71], v[100:103], v[240:243], v[68:71]
    ds_read_b128 v[100:103], v128 offset:33792
    s_waitcnt lgkmcnt(7)
    v_mfma_f32_16x16x32_bf16 v[40:43], v[104:107], v[236:239], v[40:43]
    v_lshl_add_u32 v252, v252, 6, v253
    v_mfma_f32_16x16x32_bf16 v[72:75], v[104:107], v[240:243], v[72:75]
    ds_read_b128 v[104:107], v128 offset:34816
    v_and_b32 v252, s91, v252
    v_mfma_f32_16x16x32_bf16 v[44:47], v[236:239], v[108:111], v[44:47]
    buffer_load_dword v253, v252, s[4:7], s78 offen sc1
    v_mfma_f32_16x16x32_bf16 v[76:79], v[240:243], v[108:111], v[76:79]
    ds_read_b128 v[108:111], v128 offset:35840
    s_waitcnt lgkmcnt(7)
    v_mfma_f32_16x16x32_bf16 v[48:51], v[236:239], v[112:115], v[48:51]
    v_and_b32 v252, 7, v1
    v_mfma_f32_16x16x32_bf16 v[80:83], v[240:243], v[112:115], v[80:83]
    v_lshlrev_b32 v252, 7, v252
    v_bfe_u32 v254, v1, 3, 1
    v_mul_u32_u24 v254, 20480, v254
    v_add_u32 v252, v252, v254
    v_or_b32 v252, s90, v252
    v_mfma_f32_16x16x32_bf16 v[52:55], v[236:239], v[116:119], v[52:55]
    buffer_load_dword v0, v252, s[4:7], s72 offen sc1
    v_mfma_f32_16x16x32_bf16 v[84:87], v[240:243], v[116:119], v[84:87]
    v_and_b32 v252, 0xfffff080, v252
    s_waitcnt vmcnt(16) lgkmcnt(4)
    v_mfma_f32_16x16x32_bf16 v[24:27], v[88:91], v[148:151], v[24:27]
    ds_read_b128 v[112:115], v128 offset:36864
    buffer_load_dword v254, v252, s[4:7], s74 offen sc1
    v_mfma_f32_16x16x32_bf16 v[56:59], v[88:91], v[152:155], v[56:59]
    ds_read_b128 v[116:119], v129 offset:37888
    v_mfma_f32_16x16x32_bf16 v[28:31], v[92:95], v[148:151], v[28:31]
    ds_read_b128 v[88:91], v128 offset:38912
    v_mfma_f32_16x16x32_bf16 v[60:63], v[92:95], v[152:155], v[60:63]
    ds_read_b128 v[92:95], v128 offset:39936
    s_waitcnt lgkmcnt(6)
    v_mfma_f32_16x16x32_bf16 v[32:35], v[96:99], v[148:151], v[32:35]
    ds_read_b32 v10, v6
    v_mfma_f32_16x16x32_bf16 v[64:67], v[96:99], v[152:155], v[64:67]
    ds_read_b128 v[96:99], v128 offset:40960
    v_mfma_f32_16x16x32_bf16 v[36:39], v[100:103], v[148:151], v[36:39]
    ds_read_b128 v[212:215], v137 offset:0
    v_mfma_f32_16x16x32_bf16 v[68:71], v[100:103], v[152:155], v[68:71]
    ds_read_b128 v[100:103], v128 offset:41984
    s_waitcnt lgkmcnt(8)
    v_mfma_f32_16x16x32_bf16 v[40:43], v[104:107], v[148:151], v[40:43]
    ds_read_b128 v[216:219], v137 offset:64
    v_mfma_f32_16x16x32_bf16 v[72:75], v[104:107], v[152:155], v[72:75]
    ds_read_b128 v[104:107], v128 offset:43008
    v_mfma_f32_16x16x32_bf16 v[44:47], v[148:151], v[108:111], v[44:47]
    ds_read_b32 v232, v130 offset:320
    v_mfma_f32_16x16x32_bf16 v[76:79], v[152:155], v[108:111], v[76:79]
    ds_read_b128 v[108:111], v128 offset:44032
    s_waitcnt lgkmcnt(10)
    v_mfma_f32_16x16x32_bf16 v[48:51], v[148:151], v[112:115], v[48:51]
    ds_read_b128 v[220:223], v137 offset:128
    v_add_u32 v9, 105, v8
    v_mfma_f32_16x16x32_bf16 v[80:83], v[152:155], v[112:115], v[80:83]
    ds_read_b128 v[112:115], v128 offset:45056
    v_mfma_f32_16x16x32_bf16 v[52:55], v[148:151], v[116:119], v[52:55]
    ds_read_b32 v233, v130 offset:384
    v_mfma_f32_16x16x32_bf16 v[84:87], v[152:155], v[116:119], v[84:87]
    ds_read_b128 v[116:119], v129 offset:38016
    s_waitcnt vmcnt(15) lgkmcnt(12)
    v_mfma_f32_16x16x32_bf16 v[24:27], v[88:91], v[156:159], v[24:27]
    ds_write_b32 v5, v9
    v_mfma_f32_16x16x32_bf16 v[56:59], v[88:91], v[160:163], v[56:59]
    s_cmpk_ge_i32 s44, 120
    s_cbranch_scc0 .Lcf17
.Lcr18:
    v_mfma_f32_16x16x32_bf16 v[28:31], v[92:95], v[156:159], v[28:31]
    ds_read_b128 v[88:91], v128 offset:46080
    v_mfma_f32_16x16x32_bf16 v[60:63], v[92:95], v[160:163], v[60:63]
    ds_read_b128 v[92:95], v128 offset:47104
    s_waitcnt lgkmcnt(11)
    v_mfma_f32_16x16x32_bf16 v[32:35], v[96:99], v[156:159], v[32:35]
    ds_read_b128 v[224:227], v137 offset:192
    v_readfirstlane_b32 s94, v10
    v_mfma_f32_16x16x32_bf16 v[64:67], v[96:99], v[160:163], v[64:67]
    ds_read_b128 v[96:99], v128 offset:48128
    v_mfma_f32_16x16x32_bf16 v[36:39], v[100:103], v[156:159], v[36:39]
    s_sub_u32 s44, s94, s43
    ds_read_b32 v234, v130 offset:448
    v_mfma_f32_16x16x32_bf16 v[68:71], v[100:103], v[160:163], v[68:71]
    ds_read_b128 v[100:103], v128 offset:49152
    s_waitcnt lgkmcnt(11)
    v_mfma_f32_16x16x32_bf16 v[40:43], v[104:107], v[156:159], v[40:43]
    ds_read_b128 v[228:231], v137 offset:256
    v_mul_f32 v148, v212, v121
    v_mfma_f32_16x16x32_bf16 v[72:75], v[104:107], v[160:163], v[72:75]
    ds_read_b128 v[104:107], v128 offset:50176
    v_mul_f32 v212, v212, v125
    v_mfma_f32_16x16x32_bf16 v[44:47], v[156:159], v[108:111], v[44:47]
    ds_bpermute_b32 v236, v135, v120 offset:0
    v_mul_f32 v149, v213, v121
    v_mfma_f32_16x16x32_bf16 v[76:79], v[160:163], v[108:111], v[76:79]
    ds_read_b128 v[108:111], v128 offset:51200
    s_waitcnt lgkmcnt(11)
    v_mfma_f32_16x16x32_bf16 v[48:51], v[156:159], v[112:115], v[48:51]
    ds_bpermute_b32 v240, v135, v121 offset:0
    v_mul_f32 v213, v213, v125
    v_mfma_f32_16x16x32_bf16 v[80:83], v[160:163], v[112:115], v[80:83]
    ds_read_b128 v[112:115], v128 offset:52224
    v_mul_f32 v150, v214, v121
    v_mfma_f32_16x16x32_bf16 v[52:55], v[156:159], v[116:119], v[52:55]
    ds_bpermute_b32 v237, v135, v120 offset:4
    v_mul_f32 v214, v214, v125
    v_mfma_f32_16x16x32_bf16 v[84:87], v[160:163], v[116:119], v[84:87]
    ds_read_b128 v[116:119], v129 offset:53248
    s_waitcnt vmcnt(13) lgkmcnt(12)
    v_mfma_f32_16x16x32_bf16 v[24:27], v[88:91], v[164:167], v[24:27]
    ds_bpermute_b32 v241, v135, v121 offset:4
    v_mul_f32 v151, v215, v121
    v_mfma_f32_16x16x32_bf16 v[56:59], v[88:91], v[168:171], v[56:59]
    ds_read_b128 v[88:91], v128 offset:54272
    v_mul_f32 v215, v215, v125
    v_mfma_f32_16x16x32_bf16 v[28:31], v[92:95], v[164:167], v[28:31]
    ds_read_b32 v10, v6
    v_mul_f32 v152, v216, v121
    v_mfma_f32_16x16x32_bf16 v[60:63], v[92:95], v[168:171], v[60:63]
    ds_read_b128 v[92:95], v128 offset:55296
    s_waitcnt lgkmcnt(12)
    v_mfma_f32_16x16x32_bf16 v[32:35], v[96:99], v[164:167], v[32:35]
    ds_bpermute_b32 v238, v135, v120 offset:8
    v_mul_f32 v216, v216, v125
    v_mfma_f32_16x16x32_bf16 v[64:67], v[96:99], v[168:171], v[64:67]
    ds_read_b128 v[96:99], v128 offset:56320
    v_mul_f32 v153, v217, v121
    v_mfma_f32_16x16x32_bf16 v[36:39], v[100:103], v[164:167], v[36:39]
    ds_bpermute_b32 v242, v135, v121 offset:8
    v_mul_f32 v217, v217, v125
    v_mfma_f32_16x16x32_bf16 v[68:71], v[100:103], v[168:171], v[68:71]
    ds_read_b128 v[100:103], v128 offset:57344
    s_waitcnt lgkmcnt(12)
    v_mfma_f32_16x16x32_bf16 v[40:43], v[104:107], v[164:167], v[40:43]
    ds_bpermute_b32 v239, v135, v120 offset:12
    v_mul_f32 v154, v218, v121
    v_mfma_f32_16x16x32_bf16 v[72:75], v[104:107], v[168:171], v[72:75]
    ds_read_b128 v[104:107], v128 offset:58368
    v_mul_f32 v218, v218, v125
    v_mfma_f32_16x16x32_bf16 v[44:47], v[164:167], v[108:111], v[44:47]
    ds_bpermute_b32 v243, v135, v121 offset:12
    v_mul_f32 v155, v219, v121
    v_mfma_f32_16x16x32_bf16 v[76:79], v[168:171], v[108:111], v[76:79]
    ds_read_b128 v[108:111], v128 offset:59392
    s_waitcnt lgkmcnt(12)
    v_mfma_f32_16x16x32_bf16 v[48:51], v[164:167], v[112:115], v[48:51]
    ds_bpermute_b32 v244, v135, v124 offset:0
    v_add_u32 v9, 120, v8
    v_mfma_f32_16x16x32_bf16 v[80:83], v[168:171], v[112:115], v[80:83]
    ds_read_b128 v[112:115], v128 offset:60416
    v_mul_f32 v219, v219, v125
    v_mfma_f32_16x16x32_bf16 v[52:55], v[164:167], v[116:119], v[52:55]
    ds_bpermute_b32 v248, v135, v125 offset:0
    v_mul_f32 v156, v220, v121
    v_mfma_f32_16x16x32_bf16 v[84:87], v[168:171], v[116:119], v[84:87]
    ds_read_b128 v[116:119], v129 offset:53376
    s_waitcnt vmcnt(11) lgkmcnt(12)
    v_mfma_f32_16x16x32_bf16 v[24:27], v[88:91], v[172:175], v[24:27]
    ds_write_b32 v5, v9
    v_mul_f32 v220, v220, v125
    v_mfma_f32_16x16x32_bf16 v[56:59], v[88:91], v[176:179], v[56:59]
    s_cmpk_ge_i32 s44, 135
    s_cbranch_scc0 .Lcf19
.Lcr20:
    v_mfma_f32_16x16x32_bf16 v[28:31], v[92:95], v[172:175], v[28:31]
    ds_bpermute_b32 v245, v135, v124 offset:4
    v_add_u32 v128, 61440, v128
    v_mfma_f32_16x16x32_bf16 v[60:63], v[92:95], v[176:179], v[60:63]
    ds_read_b128 v[88:91], v128 offset:0
    s_waitcnt lgkmcnt(11)
    v_mfma_f32_16x16x32_bf16 v[32:35], v[96:99], v[172:175], v[32:35]
    ds_read_b128 v[92:95], v128 offset:1024
    v_readfirstlane_b32 s94, v10
    v_mfma_f32_16x16x32_bf16 v[64:67], v[96:99], v[176:179], v[64:67]
    ds_read_b128 v[96:99], v128 offset:2048
    v_mul_f32 v157, v221, v121
    v_mfma_f32_16x16x32_bf16 v[36:39], v[100:103], v[172:175], v[36:39]
    ds_bpermute_b32 v249, v135, v125 offset:4
    s_sub_u32 s44, s94, s43
    v_mfma_f32_16x16x32_bf16 v[68:71], v[100:103], v[176:179], v[68:71]
    ds_bpermute_b32 v246, v135, v124 offset:8
    s_waitcnt lgkmcnt(11)
    v_mfma_f32_16x16x32_bf16 v[40:43], v[104:107], v[172:175], v[40:43]
    ds_read_b128 v[100:103], v128 offset:3072
    v_mul_f32 v221, v221, v125
    v_mfma_f32_16x16x32_bf16 v[72:75], v[104:107], v[176:179], v[72:75]
    ds_bpermute_b32 v250, v135, v125 offset:8
    v_mul_f32 v158, v222, v121
    v_mfma_f32_16x16x32_bf16 v[44:47], v[172:175], v[108:111], v[44:47]
    ds_bpermute_b32 v247, v135, v124 offset:12
    v_mul_f32 v222, v222, v125
    v_mfma_f32_16x16x32_bf16 v[76:79], v[176:179], v[108:111], v[76:79]
    ds_read_b128 v[104:107], v128 offset:4096
    s_waitcnt lgkmcnt(11)
    v_mfma_f32_16x16x32_bf16 v[48:51], v[172:175], v[112:115], v[48:51]
    ds_bpermute_b32 v251, v135, v125 offset:12
    v_mul_f32 v168, v232, v240
    v_mfma_f32_16x16x32_bf16 v[80:83], v[176:179], v[112:115], v[80:83]
    ds_read_b128 v[108:111], v128 offset:5120
    v_mul_f32 v169, v232, v241
    v_mfma_f32_16x16x32_bf16 v[52:55], v[172:175], v[116:119], v[52:55]
    ds_read_b128 v[112:115], v128 offset:6144
    v_add_u32 v129, 61440, v129
    v_mfma_f32_16x16x32_bf16 v[84:87], v[176:179], v[116:119], v[84:87]
    ds_read_b128 v[116:119], v129 offset:7168
    s_waitcnt vmcnt(9) lgkmcnt(11)
    v_mfma_f32_16x16x32_bf16 v[24:27], v[88:91], v[180:183], v[24:27]
    v_mul_f32 v170, v232, v242
    v_mfma_f32_16x16x32_bf16 v[56:59], v[88:91], v[184:187], v[56:59]
    ds_read_b128 v[88:91], v128 offset:8192
    v_mul_f32 v171, v232, v243
    v_mfma_f32_16x16x32_bf16 v[28:31], v[92:95], v[180:183], v[28:31]
    ds_read_b32 v10, v6
    v_mul_f32 v172, v233, v240
    v_mfma_f32_16x16x32_bf16 v[60:63], v[92:95], v[184:187], v[60:63]
    ds_read_b128 v[92:95], v128 offset:9216
    s_waitcnt lgkmcnt(10)
    v_mfma_f32_16x16x32_bf16 v[32:35], v[96:99], v[180:183], v[32:35]
    v_mul_f32 v173, v233, v241
    v_mfma_f32_16x16x32_bf16 v[64:67], v[96:99], v[184:187], v[64:67]
    ds_read_b128 v[96:99], v128 offset:10240
    v_mul_f32 v174, v233, v242
    v_mfma_f32_16x16x32_bf16 v[36:39], v[100:103], v[180:183], v[36:39]
    v_mul_f32 v175, v233, v243
    v_mfma_f32_16x16x32_bf16 v[68:71], v[100:103], v[184:187], v[68:71]
    ds_read_b128 v[100:103], v128 offset:11264
    s_waitcnt lgkmcnt(7)
    v_mfma_f32_16x16x32_bf16 v[40:43], v[104:107], v[180:183], v[40:43]
    v_mul_f32 v176, v232, v248
    v_mfma_f32_16x16x32_bf16 v[72:75], v[104:107], v[184:187], v[72:75]
    ds_read_b128 v[104:107], v128 offset:12288
    v_mul_f32 v177, v232, v249
    v_mfma_f32_16x16x32_bf16 v[44:47], v[180:183], v[108:111], v[44:47]
    v_mul_f32 v178, v232, v250
    v_mfma_f32_16x16x32_bf16 v[76:79], v[184:187], v[108:111], v[76:79]
    ds_read_b128 v[108:111], v128 offset:13312
    s_waitcnt lgkmcnt(7)
    v_mfma_f32_16x16x32_bf16 v[48:51], v[180:183], v[112:115], v[48:51]
    v_add_u32 v9, 135, v8
    v_mfma_f32_16x16x32_bf16 v[80:83], v[184:187], v[112:115], v[80:83]
    ds_read_b128 v[112:115], v128 offset:14336
    v_mul_f32 v179, v232, v251
    v_mfma_f32_16x16x32_bf16 v[52:55], v[180:183], v[116:119], v[52:55]
    v_mul_f32 v159, v223, v121
    v_mfma_f32_16x16x32_bf16 v[84:87], v[184:187], v[116:119], v[84:87]
    ds_read_b128 v[116:119], v129 offset:7296
    s_waitcnt vmcnt(7) lgkmcnt(6)
    v_mfma_f32_16x16x32_bf16 v[24:27], v[88:91], v[188:191], v[24:27]
    ds_write_b32 v5, v9
    v_mul_f32 v180, v233, v248
    v_mfma_f32_16x16x32_bf16 v[56:59], v[88:91], v[192:195], v[56:59]
    s_cmpk_ge_i32 s44, 150
    s_cbranch_scc0 .Lcf21
.Lcr22:
    v_mfma_f32_16x16x32_bf16 v[28:31], v[92:95], v[188:191], v[28:31]
    ds_read_b128 v[88:91], v128 offset:15360
    v_mul_f32 v181, v233, v249
    v_mfma_f32_16x16x32_bf16 v[60:63], v[92:95], v[192:195], v[60:63]
    ds_read_b128 v[92:95], v128 offset:16384
    s_waitcnt lgkmcnt(7)
    v_mfma_f32_16x16x32_bf16 v[32:35], v[96:99], v[188:191], v[32:35]
    v_readfirstlane_b32 s94, v10
    v_mfma_f32_16x16x32_bf16 v[64:67], v[96:99], v[192:195], v[64:67]
    ds_read_b128 v[96:99], v128 offset:17408
    v_mul_f32 v182, v233, v250
    v_mfma_f32_16x16x32_bf16 v[36:39], v[100:103], v[188:191], v[36:39]
    s_sub_u32 s44, s94, s43
    v_mul_f32 v183, v233, v251
    v_mfma_f32_16x16x32_bf16 v[68:71], v[100:103], v[192:195], v[68:71]
    ds_read_b128 v[100:103], v128 offset:18432
    s_waitcnt lgkmcnt(7)
    v_mfma_f32_16x16x32_bf16 v[40:43], v[104:107], v[188:191], v[40:43]
    v_mul_f32 v240, v234, v240
    v_mfma_f32_16x16x32_bf16 v[72:75], v[104:107], v[192:195], v[72:75]
    ds_read_b128 v[104:107], v128 offset:19456
    v_mul_f32 v241, v234, v241
    v_mfma_f32_16x16x32_bf16 v[44:47], v[188:191], v[108:111], v[44:47]
    v_mul_f32 v242, v234, v242
    v_mfma_f32_16x16x32_bf16 v[76:79], v[192:195], v[108:111], v[76:79]
    ds_read_b128 v[108:111], v128 offset:20480
    s_waitcnt lgkmcnt(7)
    v_mfma_f32_16x16x32_bf16 v[48:51], v[188:191], v[112:115], v[48:51]
    v_mul_f32 v243, v234, v243
    v_mfma_f32_16x16x32_bf16 v[80:83], v[192:195], v[112:115], v[80:83]
    ds_read_b128 v[112:115], v128 offset:21504
    v_mul_f32 v248, v234, v248
    v_mfma_f32_16x16x32_bf16 v[52:55], v[188:191], v[116:119], v[52:55]
    v_mul_f32 v223, v223, v125
    v_mfma_f32_16x16x32_bf16 v[84:87], v[192:195], v[116:119], v[84:87]
    ds_read_b128 v[116:119], v129 offset:22528
    s_waitcnt vmcnt(5) lgkmcnt(6)
    v_mfma_f32_16x16x32_bf16 v[24:27], v[88:91], v[196:199], v[24:27]
    v_mul_f32 v160, v224, v121
    v_mfma_f32_16x16x32_bf16 v[56:59], v[88:91], v[200:203], v[56:59]
    ds_read_b128 v[88:91], v128 offset:23552
    v_mul_f32 v224, v224, v125
    v_mfma_f32_16x16x32_bf16 v[28:31], v[92:95], v[196:199], v[28:31]
    ds_read_b32 v10, v6
    v_mul_f32 v161, v225, v121
    v_mfma_f32_16x16x32_bf16 v[60:63], v[92:95], v[200:203], v[60:63]
    ds_read_b128 v[92:95], v128 offset:24576
    s_waitcnt lgkmcnt(7)
    v_mfma_f32_16x16x32_bf16 v[32:35], v[96:99], v[196:199], v[32:35]
    v_mul_f32 v225, v225, v125
    v_mfma_f32_16x16x32_bf16 v[64:67], v[96:99], v[200:203], v[64:67]
    ds_read_b128 v[96:99], v128 offset:25600
    v_mul_f32 v162, v226, v121
    v_mfma_f32_16x16x32_bf16 v[36:39], v[100:103], v[196:199], v[36:39]
    v_mul_f32 v226, v226, v125
    v_mfma_f32_16x16x32_bf16 v[68:71], v[100:103], v[200:203], v[68:71]
    ds_read_b128 v[100:103], v128 offset:26624
    s_waitcnt lgkmcnt(7)
    v_mfma_f32_16x16x32_bf16 v[40:43], v[104:107], v[196:199], v[40:43]
    v_mul_f32 v163, v227, v121
    v_mfma_f32_16x16x32_bf16 v[72:75], v[104:107], v[200:203], v[72:75]
    ds_read_b128 v[104:107], v128 offset:27648
    v_mul_f32 v227, v227, v125
    v_mfma_f32_16x16x32_bf16 v[44:47], v[196:199], v[108:111], v[44:47]
    v_mul_f32 v164, v228, v121
    v_mfma_f32_16x16x32_bf16 v[76:79], v[200:203], v[108:111], v[76:79]
    ds_read_b128 v[108:111], v128 offset:28672
    s_waitcnt lgkmcnt(7)
    v_mfma_f32_16x16x32_bf16 v[48:51], v[196:199], v[112:115], v[48:51]
    v_add_u32 v9, 158, v8
    v_mfma_f32_16x16x32_bf16 v[80:83], v[200:203], v[112:115], v[80:83]
    ds_read_b128 v[112:115], v128 offset:29696
    v_mul_f32 v228, v228, v125
    v_mfma_f32_16x16x32_bf16 v[52:55], v[196:199], v[116:119], v[52:55]
    v_mul_f32 v165, v229, v121
    v_mfma_f32_16x16x32_bf16 v[84:87], v[200:203], v[116:119], v[84:87]
    ds_read_b128 v[116:119], v129 offset:22656
    s_waitcnt vmcnt(3) lgkmcnt(6)
    v_mfma_f32_16x16x32_bf16 v[24:27], v[88:91], v[204:207], v[24:27]
    ds_write_b32 v5, v9
    v_mul_f32 v229, v229, v125
    v_mfma_f32_16x16x32_bf16 v[56:59], v[88:91], v[208:211], v[56:59]
    v_mul_f32 v166, v230, v121
    v_mfma_f32_16x16x32_bf16 v[28:31], v[92:95], v[204:207], v[28:31]
    v_mul_f32 v249, v234, v249
    v_mfma_f32_16x16x32_bf16 v[60:63], v[92:95], v[208:211], v[60:63]
    v_mul_f32 v230, v230, v125
    s_waitcnt lgkmcnt(5)
    v_mfma_f32_16x16x32_bf16 v[32:35], v[96:99], v[204:207], v[32:35]
    v_readfirstlane_b32 s94, v10
    v_mfma_f32_16x16x32_bf16 v[64:67], v[96:99], v[208:211], v[64:67]
    v_mul_f32 v250, v234, v250
    v_mfma_f32_16x16x32_bf16 v[36:39], v[100:103], v[204:207], v[36:39]
    s_sub_u32 s44, s94, s43
    v_mul_f32 v167, v231, v121
    v_mfma_f32_16x16x32_bf16 v[68:71], v[100:103], v[208:211], v[68:71]
    v_mul_f32 v251, v234, v251
    s_waitcnt lgkmcnt(3)
    v_mfma_f32_16x16x32_bf16 v[40:43], v[104:107], v[204:207], v[40:43]
    v_mul_f32 v231, v231, v125
    v_mfma_f32_16x16x32_bf16 v[72:75], v[104:107], v[208:211], v[72:75]
    v_mfma_f32_16x16x32_bf16 v[44:47], v[204:207], v[108:111], v[44:47]
    v_mfma_f32_16x16x32_bf16 v[76:79], v[208:211], v[108:111], v[76:79]
    s_waitcnt lgkmcnt(1)
    v_mfma_f32_16x16x32_bf16 v[48:51], v[204:207], v[112:115], v[48:51]
    v_mfma_f32_16x16x32_bf16 v[80:83], v[208:211], v[112:115], v[80:83]
    v_mfma_f32_16x16x32_bf16 v[52:55], v[204:207], v[116:119], v[52:55]
    v_mfma_f32_16x16x32_bf16 v[84:87], v[208:211], v[116:119], v[84:87]
    s_nop 0
    v_pk_fma_f32 v[72:73], v[72:73], v[124:125], v[228:229] op_sel_hi:[1,0,1]
    v_pk_fma_f32 v[74:75], v[74:75], v[124:125], v[230:231] op_sel_hi:[1,0,1]
    v_cvt_pk_bf16_f32 v106, v72, v73
    v_cvt_pk_bf16_f32 v107, v74, v75
    v_mov_b32 v114, v106
    v_mov_b32 v115, v107
    v_pk_fma_f32 v[64:65], v[64:65], v[124:125], v[220:221] op_sel_hi:[1,0,1]
    v_pk_fma_f32 v[66:67], v[66:67], v[124:125], v[222:223] op_sel_hi:[1,0,1]
    v_cvt_pk_bf16_f32 v112, v64, v65
    v_cvt_pk_bf16_f32 v113, v66, v67
    v_permlane32_swap_b32 v106, v114
    v_permlane32_swap_b32 v107, v115
    v_pk_fma_f32 v[68:69], v[68:69], v[124:125], v[224:225] op_sel_hi:[1,0,1]
    v_pk_fma_f32 v[70:71], v[70:71], v[124:125], v[226:227] op_sel_hi:[1,0,1]
    v_cvt_pk_bf16_f32 v116, v68, v69
    v_cvt_pk_bf16_f32 v117, v70, v71
    v_mov_b32 v118, v114
    v_mov_b32 v119, v115
    v_mov_b32 v64, v112
    v_mov_b32 v65, v113
    v_mov_b32 v66, v116
    v_mov_b32 v67, v7
    s_cmp_eq_u32 s80, 0
    s_cbranch_scc1 .Ls23
    buffer_store_dwordx4 v[64:67], v131, s[4:7], s77 offen offset:0
.Ls24:
    v_mov_b32 v68, v117
    v_mov_b32 v69, v114
    v_mov_b32 v70, v115
    v_mov_b32 v71, v7
    s_cmp_eq_u32 s80, 0
    s_cbranch_scc1 .Ls25
    buffer_store_dwordx4 v[68:71], v131, s[4:7], s77 offen offset:512
.Ls26:
    v_pk_fma_f32 v[76:77], v[76:77], v[244:245], v[176:177]
    v_pk_fma_f32 v[78:79], v[78:79], v[246:247], v[178:179]
    v_cvt_pk_bf16_f32 v196, v76, v77
    v_cvt_pk_bf16_f32 v197, v78, v79
    v_pk_fma_f32 v[80:81], v[80:81], v[244:245], v[180:181]
    v_pk_fma_f32 v[82:83], v[82:83], v[246:247], v[182:183]
    v_cvt_pk_bf16_f32 v202, v80, v81
    v_cvt_pk_bf16_f32 v203, v82, v83
    v_pk_fma_f32 v[84:85], v[84:85], v[244:245], v[248:249]
    v_pk_fma_f32 v[86:87], v[86:87], v[246:247], v[250:251]
    v_cvt_pk_bf16_f32 v208, v84, v85
    v_cvt_pk_bf16_f32 v209, v86, v87
    v_mov_b32 v76, v196
    v_mov_b32 v77, v197
    v_mov_b32 v78, v202
    v_mov_b32 v79, v7
    s_cmp_eq_u32 s80, 0
    s_cbranch_scc1 .Ls27
    buffer_store_dwordx4 v[76:79], v132, s[4:7], s77 offen offset:1024
.Ls28:
    v_mov_b32 v80, v203
    v_mov_b32 v81, v208
    v_mov_b32 v82, v209
    v_mov_b32 v83, v7
    s_cmp_eq_u32 s80, 0
    s_cbranch_scc1 .Ls29
    buffer_store_dwordx4 v[80:83], v132, s[4:7], s77 offen offset:1536
.Ls30:
    v_pk_fma_f32 v[40:41], v[40:41], v[120:121], v[164:165] op_sel_hi:[1,0,1]
    v_pk_fma_f32 v[42:43], v[42:43], v[120:121], v[166:167] op_sel_hi:[1,0,1]
    v_cvt_pk_bf16_f32 v90, v40, v41
    v_cvt_pk_bf16_f32 v91, v42, v43
    v_mov_b32 v98, v90
    v_mov_b32 v99, v91
    v_pk_fma_f32 v[32:33], v[32:33], v[120:121], v[156:157] op_sel_hi:[1,0,1]
    v_pk_fma_f32 v[34:35], v[34:35], v[120:121], v[158:159] op_sel_hi:[1,0,1]
    v_cvt_pk_bf16_f32 v96, v32, v33
    v_cvt_pk_bf16_f32 v97, v34, v35
    v_permlane32_swap_b32 v90, v98
    v_permlane32_swap_b32 v91, v99
    v_pk_fma_f32 v[36:37], v[36:37], v[120:121], v[160:161] op_sel_hi:[1,0,1]
    v_pk_fma_f32 v[38:39], v[38:39], v[120:121], v[162:163] op_sel_hi:[1,0,1]
    v_cvt_pk_bf16_f32 v100, v36, v37
    v_cvt_pk_bf16_f32 v101, v38, v39
    v_mov_b32 v102, v98
    v_mov_b32 v103, v99
    v_pk_fma_f32 v[56:57], v[56:57], v[124:125], v[212:213] op_sel_hi:[1,0,1]
    v_pk_fma_f32 v[58:59], v[58:59], v[124:125], v[214:215] op_sel_hi:[1,0,1]
    v_cvt_pk_bf16_f32 v104, v56, v57
    v_cvt_pk_bf16_f32 v105, v58, v59
    v_pk_fma_f32 v[60:61], v[60:61], v[124:125], v[216:217] op_sel_hi:[1,0,1]
    v_pk_fma_f32 v[62:63], v[62:63], v[124:125], v[218:219] op_sel_hi:[1,0,1]
    v_cvt_pk_bf16_f32 v108, v60, v61
    v_cvt_pk_bf16_f32 v109, v62, v63
    v_cndmask_b32 v110, 0, v106, s[58:59]
    v_cndmask_b32 v111, 0, v107, s[58:59]
    v_cndmask_b32 v106, 0, v106, s[56:57]
    v_cndmask_b32 v107, 0, v107, s[56:57]
    s_nop 1
    v_mfma_f32_16x16x32_bf16 v[56:59], v[112:115], v[104:107], 0
    v_mfma_f32_16x16x32_bf16 v[60:63], v[96:99], v[104:107], v[144:147]
    v_mfma_f32_16x16x32_bf16 v[72:75], v[116:119], v[108:111], 0
    v_mfma_f32_16x16x32_bf16 v[76:79], v[100:103], v[108:111], v[144:147]
    v_pk_fma_f32 v[44:45], v[44:45], v[236:237], v[168:169]
    v_pk_fma_f32 v[46:47], v[46:47], v[238:239], v[170:171]
    v_cvt_pk_bf16_f32 v194, v44, v45
    v_cvt_pk_bf16_f32 v195, v46, v47
    v_pk_fma_f32 v[48:49], v[48:49], v[236:237], v[172:173]
    v_pk_fma_f32 v[50:51], v[50:51], v[238:239], v[174:175]
    v_cvt_pk_bf16_f32 v200, v48, v49
    v_cvt_pk_bf16_f32 v201, v50, v51
    v_cndmask_b32 v56, v60, v56, s[48:49]
    v_cndmask_b32 v72, v76, v72, s[48:49]
    v_cndmask_b32 v57, v61, v57, s[50:51]
    v_cndmask_b32 v73, v77, v73, s[50:51]
    v_cndmask_b32 v58, v62, v58, s[52:53]
    v_cndmask_b32 v74, v78, v74, s[52:53]
    v_pk_fma_f32 v[52:53], v[52:53], v[236:237], v[240:241]
    v_cndmask_b32 v59, v63, v59, s[54:55]
    v_cndmask_b32 v75, v79, v75, s[54:55]
    v_max3_f32 v60, v56, v57, v58
    v_max3_f32 v76, v72, v73, v74
    v_pk_fma_f32 v[54:55], v[54:55], v[238:239], v[242:243]
    v_max_f32 v60, v60, v59
    v_max_f32 v76, v76, v75
    v_mov_b32 v61, v60
    v_mov_b32 v77, v76
    s_nop 0
    v_permlane32_swap_b32 v60, v61
    v_permlane32_swap_b32 v76, v77
    v_cvt_pk_bf16_f32 v206, v52, v53
    v_max_f32 v60, v60, v61
    v_max_f32 v76, v76, v77
    v_mov_b32 v61, v60
    v_mov_b32 v77, v76
    v_cvt_pk_bf16_f32 v207, v54, v55
    v_permlane16_swap_b32 v60, v61
    v_permlane16_swap_b32 v76, v77
    v_max_f32 v60, v60, v61
    v_max_f32 v76, v76, v77
    v_pk_fma_f32 v[24:25], v[24:25], v[120:121], v[148:149] op_sel_hi:[1,0,1]
    v_mul_f32 v60, s87, v60
    v_mul_f32 v76, s87, v76
    v_fma_f32 v56, v56, s87, -v60
    v_fma_f32 v72, v72, s87, -v76
    v_fma_f32 v57, v57, s87, -v60
    v_fma_f32 v73, v73, s87, -v76
    v_pk_fma_f32 v[26:27], v[26:27], v[120:121], v[150:151] op_sel_hi:[1,0,1]
    v_fma_f32 v58, v58, s87, -v60
    v_fma_f32 v74, v74, s87, -v76
    v_fma_f32 v59, v59, s87, -v60
    v_fma_f32 v75, v75, s87, -v76
    v_cvt_pk_bf16_f32 v88, v24, v25
    v_exp_f32 v56, v56
    v_exp_f32 v72, v72
    v_exp_f32 v57, v57
    v_exp_f32 v73, v73
    v_cvt_pk_bf16_f32 v89, v26, v27
    v_exp_f32 v58, v58
    v_exp_f32 v74, v74
    v_exp_f32 v59, v59
    v_exp_f32 v75, v75
    v_pk_add_f32 v[60:61], v[56:57], v[58:59]
    v_pk_add_f32 v[76:77], v[72:73], v[74:75]
    v_pk_fma_f32 v[28:29], v[28:29], v[120:121], v[152:153] op_sel_hi:[1,0,1]
    v_add_f32 v60, v60, v61
    v_add_f32 v76, v76, v77
    v_mov_b32 v61, v60
    v_mov_b32 v77, v76
    v_pk_fma_f32 v[30:31], v[30:31], v[120:121], v[154:155] op_sel_hi:[1,0,1]
    v_permlane32_swap_b32 v60, v61
    v_permlane32_swap_b32 v76, v77
    v_add_f32 v60, v60, v61
    v_add_f32 v76, v76, v77
    v_mov_b32 v61, v60
    v_mov_b32 v77, v76
    v_cvt_pk_bf16_f32 v92, v28, v29
    v_permlane16_swap_b32 v60, v61
    v_permlane16_swap_b32 v76, v77
    v_add_f32 v60, v60, v61
    v_add_f32 v76, v76, v77
    v_cvt_pk_bf16_f32 v93, v30, v31
    v_rcp_f32 v60, v60
    v_rcp_f32 v76, v76
    v_pk_mul_f32 v[56:57], v[56:57], v[60:61] op_sel_hi:[1,0]
    v_pk_mul_f32 v[72:73], v[72:73], v[76:77] op_sel_hi:[1,0]
    v_cndmask_b32 v94, 0, v90, s[58:59]
    v_pk_mul_f32 v[58:59], v[58:59], v[60:61] op_sel_hi:[1,0]
    v_pk_mul_f32 v[74:75], v[74:75], v[76:77] op_sel_hi:[1,0]
    v_cvt_pk_bf16_f32 v64, v56, v57
    v_cvt_pk_bf16_f32 v80, v72, v73
    v_cvt_pk_bf16_f32 v65, v58, v59
    v_cvt_pk_bf16_f32 v81, v74, v75
    v_cndmask_b32 v95, 0, v91, s[58:59]
    buffer_load_dwordx4 v[212:215], v133, s[4:7], s78 offen offset:0 sc1
    buffer_load_dwordx4 v[216:219], v133, s[4:7], s78 offen offset:512 sc1
    buffer_load_dwordx4 v[220:223], v134, s[4:7], s78 offen offset:1024 sc1
    buffer_load_dwordx4 v[224:227], v134, s[4:7], s78 offen offset:1536 sc1
    v_and_b32 v66, v138, v64
    v_and_b32 v82, v138, v80
    v_and_b32 v67, v139, v65
    v_and_b32 v83, v139, v81
    v_cndmask_b32 v90, 0, v90, s[56:57]
    v_xor_b32 v64, v64, v66
    v_xor_b32 v80, v80, v82
    v_xor_b32 v65, v65, v67
    v_xor_b32 v81, v81, v83
    v_cndmask_b32 v91, 0, v91, s[56:57]
    v_mfma_f32_16x16x32_bf16 v[68:71], v[194:197], v[64:67], 0
    v_mfma_f32_16x16x32_bf16 v[56:59], v[206:209], v[64:67], 0
    v_mfma_f32_16x16x32_bf16 v[84:87], v[200:203], v[80:83], 0
    v_mfma_f32_16x16x32_bf16 v[72:75], v[206:209], v[80:83], 0
    v_mfma_f32_16x16x32_bf16 v[24:27], v[96:99], v[88:91], 0
    v_mfma_f32_16x16x32_bf16 v[40:43], v[100:103], v[92:95], 0
    s_nop 2
    v_cvt_pk_bf16_f32 v60, v68, v69
    v_cvt_pk_bf16_f32 v61, v70, v71
    v_cvt_pk_bf16_f32 v76, v56, v57
    v_cvt_pk_bf16_f32 v77, v58, v59
    v_cvt_pk_bf16_f32 v62, v84, v85
    v_cvt_pk_bf16_f32 v63, v86, v87
    s_cmp_eq_u32 s43, 0
    s_cbranch_scc1 .Ls31
    buffer_store_dwordx4 v[60:63], v4, s[4:7], s73 offen
.Ls32:
    v_cvt_pk_bf16_f32 v78, v72, v73
    v_cvt_pk_bf16_f32 v79, v74, v75
    v_cndmask_b32 v76, v78, v76, s[56:57]
    v_cndmask_b32 v77, v79, v77, s[56:57]
    s_cmp_eq_u32 s43, 0
    s_cbranch_scc1 .Ls33
    buffer_store_dwordx2 v[76:77], v136, s[4:7], s75 offen
.Ls34:
    s_or_b32 s68, s39, s81
    s_cbranch_scc0 .Lxz37
.Lx35:
    s_waitcnt vmcnt(2)
    v_xor_b32 v9, v215, v7
    v_xor_b32 v10, v219, v7
    v_xor_b32 v215, v223, v7
    v_xor_b32 v219, v227, v7
    v_or3_b32 v9, v9, v10, v215
    v_or_b32 v9, v9, v219
    v_cmp_ne_u32 vcc, 0, v9
    s_nop 0
    s_cbranch_vccz .Lxd36
    buffer_load_dwordx4 v[212:215], v133, s[4:7], s78 offen offset:0 sc1
    buffer_load_dwordx4 v[216:219], v133, s[4:7], s78 offen offset:512 sc1
    buffer_load_dwordx4 v[220:223], v134, s[4:7], s78 offen offset:1024 sc1
    buffer_load_dwordx4 v[224:227], v134, s[4:7], s78 offen offset:1536 sc1
    s_waitcnt vmcnt(0)
    s_sub_u32 s88, s88, 1
    s_cbranch_scc1 .Lend
    s_branch .Lx35
.Lxz37:
    s_waitcnt vmcnt(2)
    v_mov_b32 v212, 0
    v_mov_b32 v213, 0
    v_mov_b32 v214, 0
    v_mov_b32 v215, 0
    v_mov_b32 v216, 0
    v_mov_b32 v217, 0
    v_mov_b32 v218, 0
    v_mov_b32 v219, 0
    v_mov_b32 v220, 0
    v_mov_b32 v221, 0
    v_mov_b32 v222, 0
    v_mov_b32 v223, 0
    v_mov_b32 v224, 0
    v_mov_b32 v225, 0
    v_mov_b32 v226, 0
    v_mov_b32 v227, 0
.Lxd36:
    v_mov_b32 v184, v212
    v_mov_b32 v185, v213
    v_mov_b32 v188, v214
    v_mov_b32 v189, v216
    v_mov_b32 v186, v217
    v_mov_b32 v187, v218
    v_mov_b32 v190, v217
    v_mov_b32 v191, v218
    v_mfma_f32_16x16x32_bf16 v[28:31], v[184:187], v[88:91], v[140:143]
    s_nop 0
    v_mfma_f32_16x16x32_bf16 v[44:47], v[188:191], v[92:95], v[140:143]
    v_mov_b32 v192, v220
    v_mov_b32 v193, v221
    v_mov_b32 v198, v222
    v_mov_b32 v199, v224
    v_mov_b32 v204, v225
    v_mov_b32 v205, v226
    v_cndmask_b32 v24, v28, v24, s[48:49]
    s_nop 0
    v_cndmask_b32 v40, v44, v40, s[48:49]
    v_cndmask_b32 v25, v29, v25, s[50:51]
    v_cndmask_b32 v41, v45, v41, s[50:51]
    v_cndmask_b32 v26, v30, v26, s[52:53]
    v_cndmask_b32 v42, v46, v42, s[52:53]
    v_cndmask_b32 v27, v31, v27, s[54:55]
    v_cndmask_b32 v43, v47, v43, s[54:55]
    v_max3_f32 v28, v24, v25, v26
    v_max3_f32 v44, v40, v41, v42
    v_max_f32 v28, v28, v27
    v_max_f32 v44, v44, v43
    v_mov_b32 v29, v28
    v_mov_b32 v45, v44
    s_nop 0
    v_permlane32_swap_b32 v28, v29
    v_permlane32_swap_b32 v44, v45
    v_max_f32 v28, v28, v29
    v_max_f32 v44, v44, v45
    v_mov_b32 v29, v28
    v_mov_b32 v45, v44
    s_nop 0
    v_permlane16_swap_b32 v28, v29
    v_permlane16_swap_b32 v44, v45
    v_max_f32 v28, v28, v29
    v_max_f32 v44, v44, v45
    v_mul_f32 v28, s87, v28
    v_mul_f32 v44, s87, v44
    v_fma_f32 v24, v24, s87, -v28
    v_fma_f32 v40, v40, s87, -v44
    v_fma_f32 v25, v25, s87, -v28
    v_fma_f32 v41, v41, s87, -v44
    v_fma_f32 v26, v26, s87, -v28
    v_fma_f32 v42, v42, s87, -v44
    v_fma_f32 v27, v27, s87, -v28
    v_fma_f32 v43, v43, s87, -v44
    v_exp_f32 v24, v24
    v_exp_f32 v40, v40
    v_exp_f32 v25, v25
    v_exp_f32 v41, v41
    v_exp_f32 v26, v26
    v_exp_f32 v42, v42
    v_exp_f32 v27, v27
    v_exp_f32 v43, v43
    v_pk_add_f32 v[28:29], v[24:25], v[26:27]
    v_pk_add_f32 v[44:45], v[40:41], v[42:43]
    v_add_f32 v28, v28, v29
    v_add_f32 v44, v44, v45
    v_mov_b32 v29, v28
    v_mov_b32 v45, v44
    s_nop 0
    v_permlane32_swap_b32 v28, v29
    v_permlane32_swap_b32 v44, v45
    v_add_f32 v28, v28, v29
    v_add_f32 v44, v44, v45
    v_mov_b32 v29, v28
    v_mov_b32 v45, v44
    s_nop 0
    v_permlane16_swap_b32 v28, v29
    v_permlane16_swap_b32 v44, v45
    v_add_f32 v28, v28, v29
    v_add_f32 v44, v44, v45
    v_rcp_f32 v28, v28
    v_rcp_f32 v44, v44
    v_pk_mul_f32 v[24:25], v[24:25], v[28:29] op_sel_hi:[1,0]
    v_pk_mul_f32 v[40:41], v[40:41], v[44:45] op_sel_hi:[1,0]
    v_pk_mul_f32 v[26:27], v[26:27], v[28:29] op_sel_hi:[1,0]
    v_pk_mul_f32 v[42:43], v[42:43], v[44:45] op_sel_hi:[1,0]
    v_cvt_pk_bf16_f32 v32, v24, v25
    v_cvt_pk_bf16_f32 v48, v40, v41
    v_cvt_pk_bf16_f32 v33, v26, v27
    v_cvt_pk_bf16_f32 v49, v42, v43
    v_and_b32 v34, v138, v32
    v_and_b32 v50, v138, v48
    v_and_b32 v35, v139, v33
    v_and_b32 v51, v139, v49
    v_xor_b32 v32, v32, v34
    v_xor_b32 v48, v48, v50
    v_xor_b32 v33, v33, v35
    v_xor_b32 v49, v49, v51
    s_nop 0
    v_mfma_f32_16x16x32_bf16 v[36:39], v[192:195], v[32:35], 0
    v_mfma_f32_16x16x32_bf16 v[24:27], v[204:207], v[32:35], 0
    v_mfma_f32_16x16x32_bf16 v[52:55], v[198:201], v[48:51], 0
    v_mfma_f32_16x16x32_bf16 v[40:43], v[204:207], v[48:51], 0
    s_waitcnt vmcnt(0)
    buffer_store_dword v7, v11, s[4:7], s76 offen offset:128
    s_nop 2
    v_cvt_pk_bf16_f32 v28, v36, v37
    v_cvt_pk_bf16_f32 v29, v38, v39
    v_cvt_pk_bf16_f32 v44, v24, v25
    v_cvt_pk_bf16_f32 v45, v26, v27
    v_cvt_pk_bf16_f32 v30, v52, v53
    v_cvt_pk_bf16_f32 v31, v54, v55
    s_cmp_eq_u32 s43, 0
    s_cbranch_scc1 .Ls38
    buffer_store_dwordx4 v[28:31], v4, s[4:7], s72 offen
.Ls39:
    v_cvt_pk_bf16_f32 v46, v40, v41
    v_cvt_pk_bf16_f32 v47, v42, v43
    v_cndmask_b32 v44, v46, v44, s[56:57]
    v_cndmask_b32 v45, v47, v45, s[56:57]
    s_cmp_eq_u32 s43, 0
    s_cbranch_scc1 .Ls40
    buffer_store_dwordx2 v[44:45], v136, s[4:7], s74 offen
.Ls41:
    s_mul_i32 s97, s63, 20480
    s_add_u32 s97, s97, s42
    s_add_u32 s97, s97, 0x28000
    s_add_u32 s95, s97, 20480
    s_mov_b32 s84, s97
    s_lshl_b32 s85, s63, 7
    s_add_u32 s85, s85, s42
    s_add_u32 s85, s85, 0xb0400
    v_add_u32 v112, 0, v4
    v_lshlrev_b32 v113, 2, v1
    s_waitcnt vmcnt(0)
    buffer_store_dword v7, v11, s[4:7], s76 offen offset:0
    v_lshlrev_b32 v28, 16, v12
    v_and_b32 v29, 0xffff0000, v12
    v_lshlrev_b32 v30, 16, v13
    v_and_b32 v31, 0xffff0000, v13
    v_lshlrev_b32 v32, 16, v14
    v_and_b32 v33, 0xffff0000, v14
    v_lshlrev_b32 v34, 16, v15
    v_and_b32 v35, 0xffff0000, v15
    v_lshlrev_b32 v36, 16, v16
    v_and_b32 v37, 0xffff0000, v16
    v_lshlrev_b32 v38, 16, v17
    v_and_b32 v39, 0xffff0000, v17
    v_lshlrev_b32 v40, 16, v18
    v_and_b32 v41, 0xffff0000, v18
    v_lshlrev_b32 v42, 16, v19
    v_and_b32 v43, 0xffff0000, v19
    v_lshlrev_b32 v44, 16, v20
    v_and_b32 v45, 0xffff0000, v20
    v_lshlrev_b32 v46, 16, v21
    v_and_b32 v47, 0xffff0000, v21
    s_cmpk_ge_i32 s44, 218
    s_cbranch_scc0 .Lcf42
.Lcr43:
    ds_read_b128 v[52:55], v112 offset:0
    ds_read_b128 v[56:59], v112 offset:1024
    ds_read_b128 v[60:63], v112 offset:2048
    ds_read_b128 v[64:67], v112 offset:3072
    ds_read_b128 v[68:71], v112 offset:4096
    ds_read_b128 v[72:75], v112 offset:5120
    ds_read_b128 v[76:79], v112 offset:6144
    ds_read_b128 v[80:83], v112 offset:7168
    ds_read_b128 v[84:87], v112 offset:8192
    ds_read_b128 v[88:91], v112 offset:9216
    ds_read_b128 v[92:95], v112 offset:10240
    ds_read_b128 v[96:99], v112 offset:11264
    ds_read_b128 v[100:103], v112 offset:12288
    ds_read_b128 v[104:107], v112 offset:13312
    ds_read_b128 v[108:111], v112 offset:14336
    s_mov_b32 exec_lo, 0xffff
    s_mov_b32 exec_hi, 0x0
.Lp44:
    buffer_load_dword v9, v113, s[4:7], s85 offen sc1
    s_waitcnt vmcnt(0)
    v_cmp_ne_u32 vcc, s41, v9
    s_nop 0
    s_cbranch_vccz .Lpd45
    s_sub_u32 s88, s88, 1
    s_cbranch_scc1 .Lend
    s_branch .Lp44
.Lpd45:
    s_mov_b64 exec, -1
    buffer_load_dwordx4 v[116:119], v4, s[4:7], s84 offen offset:0 sc1
    buffer_load_dwordx4 v[120:123], v4, s[4:7], s84 offen offset:1024 sc1
    buffer_load_dwordx4 v[124:127], v4, s[4:7], s84 offen offset:2048 sc1
    buffer_load_dwordx4 v[128:131], v4, s[4:7], s84 offen offset:3072 sc1
    s_add_u32 s84, s84, 4096
    buffer_load_dwordx4 v[132:135], v4, s[4:7], s84 offen offset:0 sc1
    buffer_load_dwordx4 v[136:139], v4, s[4:7], s84 offen offset:1024 sc1
    buffer_load_dwordx4 v[140:143], v4, s[4:7], s84 offen offset:2048 sc1
    buffer_load_dwordx4 v[144:147], v4, s[4:7], s84 offen offset:3072 sc1
    s_add_u32 s84, s84, 4096
    buffer_load_dwordx4 v[148:151], v4, s[4:7], s84 offen offset:0 sc1
    buffer_load_dwordx4 v[152:155], v4, s[4:7], s84 offen offset:1024 sc1
    s_waitcnt vmcnt(9) lgkmcnt(10)
    v_mfma_f32_16x16x32_bf16 v[28:31], v[52:55], v[116:119], v[28:31]
    ds_read_b128 v[52:55], v112 offset:15360
    v_mfma_f32_16x16x32_bf16 v[32:35], v[56:59], v[116:119], v[32:35]
    buffer_load_dwordx4 v[156:159], v4, s[4:7], s84 offen offset:2048 sc1
    v_mfma_f32_16x16x32_bf16 v[36:39], v[60:63], v[116:119], v[36:39]
    ds_read_b128 v[56:59], v112 offset:16384
    buffer_load_dwordx4 v[160:163], v4, s[4:7], s84 offen offset:3072 sc1
    v_mfma_f32_16x16x32_bf16 v[40:43], v[64:67], v[116:119], v[40:43]
    ds_read_b128 v[60:63], v112 offset:17408
    s_add_u32 s84, s84, 4096
    v_mfma_f32_16x16x32_bf16 v[44:47], v[68:71], v[116:119], v[44:47]
    ds_read_b128 v[64:67], v112 offset:18432
    s_waitcnt vmcnt(10) lgkmcnt(9)
    v_mfma_f32_16x16x32_bf16 v[28:31], v[72:75], v[120:123], v[28:31]
    ds_read_b128 v[68:71], v112 offset:19456
    s_mul_i32 s68, s63, 20480
    v_mfma_f32_16x16x32_bf16 v[32:35], v[76:79], v[120:123], v[32:35]
    ds_read_b128 v[72:75], v112 offset:20480
    buffer_load_dwordx4 v[164:167], v4, s[4:7], s84 offen offset:0 sc1
    v_mfma_f32_16x16x32_bf16 v[36:39], v[80:83], v[120:123], v[36:39]
    ds_read_b128 v[76:79], v112 offset:21504
    s_add_u32 s68, s68, s42
    v_mfma_f32_16x16x32_bf16 v[40:43], v[84:87], v[120:123], v[40:43]
    ds_read_b128 v[80:83], v112 offset:22528
    buffer_load_dwordx4 v[168:171], v4, s[4:7], s84 offen offset:1024 sc1
    v_mfma_f32_16x16x32_bf16 v[44:47], v[88:91], v[120:123], v[44:47]
    ds_read_b128 v[84:87], v112 offset:23552
    s_waitcnt vmcnt(11) lgkmcnt(9)
    v_mfma_f32_16x16x32_bf16 v[28:31], v[92:95], v[124:127], v[28:31]
    ds_read_b128 v[88:91], v112 offset:24576
    s_add_u32 s68, s68, 0x0
    v_mfma_f32_16x16x32_bf16 v[32:35], v[96:99], v[124:127], v[32:35]
    ds_read_b128 v[92:95], v112 offset:25600
    buffer_load_dwordx4 v[172:175], v4, s[4:7], s84 offen offset:2048 sc1
    v_mfma_f32_16x16x32_bf16 v[36:39], v[100:103], v[124:127], v[36:39]
    ds_read_b128 v[96:99], v112 offset:26624
    buffer_load_dwordx4 v[176:179], v4, s[4:7], s84 offen offset:3072 sc1
    v_mfma_f32_16x16x32_bf16 v[40:43], v[104:107], v[124:127], v[40:43]
    ds_read_b128 v[100:103], v112 offset:27648
    s_add_u32 s84, s84, 4096
    v_mfma_f32_16x16x32_bf16 v[44:47], v[108:111], v[124:127], v[44:47]
    ds_read_b128 v[104:107], v112 offset:28672
    s_waitcnt vmcnt(12) lgkmcnt(9)
    v_mfma_f32_16x16x32_bf16 v[28:31], v[52:55], v[128:131], v[28:31]
    ds_read_b128 v[108:111], v112 offset:29696
    s_add_u32 s69, s68, s67
    v_mfma_f32_16x16x32_bf16 v[32:35], v[56:59], v[128:131], v[32:35]
    ds_read_b128 v[52:55], v112 offset:30720
    buffer_load_dwordx4 v[180:183], v4, s[4:7], s84 offen offset:0 sc1
    v_mfma_f32_16x16x32_bf16 v[36:39], v[60:63], v[128:131], v[36:39]
    ds_read_b128 v[56:59], v112 offset:31744
    s_add_u32 s68, s68, s66
    v_mfma_f32_16x16x32_bf16 v[40:43], v[64:67], v[128:131], v[40:43]
    ds_read_b128 v[60:63], v112 offset:32768
    buffer_load_dwordx4 v[184:187], v4, s[4:7], s84 offen offset:1024 sc1
    v_mfma_f32_16x16x32_bf16 v[44:47], v[68:71], v[128:131], v[44:47]
    ds_read_b128 v[64:67], v112 offset:33792
    s_waitcnt vmcnt(13) lgkmcnt(9)
    v_mfma_f32_16x16x32_bf16 v[28:31], v[72:75], v[132:135], v[28:31]
    ds_read_b128 v[68:71], v112 offset:34816
    s_lshl_b32 s70, s63, 10
    v_mfma_f32_16x16x32_bf16 v[32:35], v[76:79], v[132:135], v[32:35]
    ds_read_b128 v[72:75], v112 offset:35840
    buffer_load_dwordx4 v[188:191], v4, s[4:7], s84 offen offset:2048 sc1
    v_mfma_f32_16x16x32_bf16 v[36:39], v[80:83], v[132:135], v[36:39]
    ds_read_b128 v[76:79], v112 offset:36864
    s_add_u32 s70, s70, s42
    v_mfma_f32_16x16x32_bf16 v[40:43], v[84:87], v[132:135], v[40:43]
    ds_read_b128 v[80:83], v112 offset:37888
    buffer_load_dwordx4 v[192:195], v4, s[4:7], s84 offen offset:3072 sc1
    v_mfma_f32_16x16x32_bf16 v[44:47], v[88:91], v[132:135], v[44:47]
    ds_read_b128 v[84:87], v112 offset:38912
    s_waitcnt vmcnt(14) lgkmcnt(9)
    v_mfma_f32_16x16x32_bf16 v[28:31], v[92:95], v[136:139], v[28:31]
    ds_read_b128 v[88:91], v112 offset:39936
    s_add_u32 s70, s70, 0xb1000
    v_mfma_f32_16x16x32_bf16 v[32:35], v[96:99], v[136:139], v[32:35]
    ds_read_b128 v[92:95], v112 offset:40960
    ds_read_b32 v10, v6
    v_mfma_f32_16x16x32_bf16 v[36:39], v[100:103], v[136:139], v[36:39]
    ds_read_b128 v[96:99], v112 offset:41984
    s_lshl_b32 s71, s63, 5
    v_mfma_f32_16x16x32_bf16 v[40:43], v[104:107], v[136:139], v[40:43]
    ds_read_b128 v[100:103], v112 offset:43008
    s_add_u32 s71, s71, s60
    v_mfma_f32_16x16x32_bf16 v[44:47], v[108:111], v[136:139], v[44:47]
    ds_read_b128 v[104:107], v112 offset:44032
    s_waitcnt vmcnt(13) lgkmcnt(10)
    v_mfma_f32_16x16x32_bf16 v[28:31], v[52:55], v[140:143], v[28:31]
    ds_read_b128 v[108:111], v112 offset:45056
    s_lshl_b32 s71, s71, 2
    v_mfma_f32_16x16x32_bf16 v[32:35], v[56:59], v[140:143], v[32:35]
    ds_read_b128 v[52:55], v112 offset:46080
    s_add_u32 s71, s71, s42
    v_mfma_f32_16x16x32_bf16 v[36:39], v[60:63], v[140:143], v[36:39]
    ds_read_b128 v[56:59], v112 offset:47104
    s_add_u32 s71, s71, 0xb0800
    v_mfma_f32_16x16x32_bf16 v[40:43], v[64:67], v[140:143], v[40:43]
    ds_read_b128 v[60:63], v112 offset:48128
    v_mfma_f32_16x16x32_bf16 v[44:47], v[68:71], v[140:143], v[44:47]
    ds_read_b128 v[64:67], v112 offset:49152
    s_waitcnt vmcnt(12) lgkmcnt(10)
    v_mfma_f32_16x16x32_bf16 v[28:31], v[72:75], v[144:147], v[28:31]
    ds_read_b128 v[68:71], v112 offset:50176
    v_mfma_f32_16x16x32_bf16 v[32:35], v[76:79], v[144:147], v[32:35]
    ds_read_b128 v[72:75], v112 offset:51200
    v_mfma_f32_16x16x32_bf16 v[36:39], v[80:83], v[144:147], v[36:39]
    ds_read_b128 v[76:79], v112 offset:52224
    s_waitcnt lgkmcnt(11)
    v_readfirstlane_b32 s94, v10
    v_mfma_f32_16x16x32_bf16 v[40:43], v[84:87], v[144:147], v[40:43]
    ds_read_b128 v[80:83], v112 offset:53248
    v_mfma_f32_16x16x32_bf16 v[44:47], v[88:91], v[144:147], v[44:47]
    ds_read_b128 v[84:87], v112 offset:54272
    s_waitcnt vmcnt(11) lgkmcnt(9)
    v_mfma_f32_16x16x32_bf16 v[28:31], v[92:95], v[148:151], v[28:31]
    ds_read_b128 v[88:91], v112 offset:55296
    s_sub_u32 s44, s94, s43
    v_mfma_f32_16x16x32_bf16 v[32:35], v[96:99], v[148:151], v[32:35]
    ds_read_b128 v[92:95], v112 offset:56320
    v_mfma_f32_16x16x32_bf16 v[36:39], v[100:103], v[148:151], v[36:39]
    ds_read_b128 v[96:99], v112 offset:57344
    v_mfma_f32_16x16x32_bf16 v[40:43], v[104:107], v[148:151], v[40:43]
    ds_read_b128 v[100:103], v112 offset:58368
    v_mfma_f32_16x16x32_bf16 v[44:47], v[108:111], v[148:151], v[44:47]
    ds_read_b128 v[104:107], v112 offset:59392
    ds_read_b128 v[108:111], v112 offset:60416
    v_add_u32 v9, 218, v8
    ds_write_b32 v5, v9
    s_waitcnt vmcnt(10) lgkmcnt(11)
    v_mfma_f32_16x16x32_bf16 v[28:31], v[52:55], v[152:155], v[28:31]
    s_cmpk_ge_i32 s44, 258
    s_cbranch_scc0 .Lcf46
.Lcr47:
    v_mfma_f32_16x16x32_bf16 v[32:35], v[56:59], v[152:155], v[32:35]
    ds_read_b128 v[52:55], v112 offset:61440
    v_mfma_f32_16x16x32_bf16 v[36:39], v[60:63], v[152:155], v[36:39]
    ds_read_b128 v[56:59], v112 offset:62464
    ds_read_b128 v[60:63], v112 offset:63488
    v_mfma_f32_16x16x32_bf16 v[40:43], v[64:67], v[152:155], v[40:43]
    ds_read_b128 v[64:67], v112 offset:64512
    v_mfma_f32_16x16x32_bf16 v[44:47], v[68:71], v[152:155], v[44:47]
    v_add_u32 v112, 65536, v4
    s_waitcnt vmcnt(9) lgkmcnt(10)
    v_mfma_f32_16x16x32_bf16 v[28:31], v[72:75], v[156:159], v[28:31]
    ds_read_b128 v[68:71], v112 offset:0
    v_mfma_f32_16x16x32_bf16 v[32:35], v[76:79], v[156:159], v[32:35]
    ds_read_b128 v[72:75], v112 offset:1024
    v_mfma_f32_16x16x32_bf16 v[36:39], v[80:83], v[156:159], v[36:39]
    ds_read_b128 v[76:79], v112 offset:2048
    v_mfma_f32_16x16x32_bf16 v[40:43], v[84:87], v[156:159], v[40:43]
    ds_read_b128 v[80:83], v112 offset:3072
    v_mfma_f32_16x16x32_bf16 v[44:47], v[88:91], v[156:159], v[44:47]
    ds_read_b128 v[84:87], v112 offset:4096
    s_waitcnt vmcnt(8) lgkmcnt(10)
    v_mfma_f32_16x16x32_bf16 v[28:31], v[92:95], v[160:163], v[28:31]
    ds_read_b128 v[88:91], v112 offset:5120
    v_mfma_f32_16x16x32_bf16 v[32:35], v[96:99], v[160:163], v[32:35]
    ds_read_b128 v[92:95], v112 offset:6144
    v_mfma_f32_16x16x32_bf16 v[36:39], v[100:103], v[160:163], v[36:39]
    ds_read_b128 v[96:99], v112 offset:7168
    v_mfma_f32_16x16x32_bf16 v[40:43], v[104:107], v[160:163], v[40:43]
    ds_read_b128 v[100:103], v112 offset:8192
    v_mfma_f32_16x16x32_bf16 v[44:47], v[108:111], v[160:163], v[44:47]
    ds_read_b128 v[104:107], v112 offset:9216
    s_waitcnt vmcnt(7) lgkmcnt(9)
    v_mfma_f32_16x16x32_bf16 v[28:31], v[52:55], v[164:167], v[28:31]
    ds_read_b128 v[108:111], v112 offset:10240
    v_mfma_f32_16x16x32_bf16 v[32:35], v[56:59], v[164:167], v[32:35]
    ds_read_b128 v[52:55], v112 offset:11264
    v_mfma_f32_16x16x32_bf16 v[36:39], v[60:63], v[164:167], v[36:39]
    ds_read_b128 v[56:59], v112 offset:12288
    v_mfma_f32_16x16x32_bf16 v[40:43], v[64:67], v[164:167], v[40:43]
    ds_read_b128 v[60:63], v112 offset:13312
    v_mfma_f32_16x16x32_bf16 v[44:47], v[68:71], v[164:167], v[44:47]
    ds_read_b128 v[64:67], v112 offset:14336
    ds_read_b128 v[68:71], v112 offset:15360
    v_add_u32 v9, 238, v8
    s_waitcnt vmcnt(6) lgkmcnt(10)
    v_mfma_f32_16x16x32_bf16 v[28:31], v[72:75], v[168:171], v[28:31]
    ds_write_b32 v5, v9
    v_mfma_f32_16x16x32_bf16 v[32:35], v[76:79], v[168:171], v[32:35]
    ds_read_b128 v[72:75], v112 offset:16384
    v_mfma_f32_16x16x32_bf16 v[36:39], v[80:83], v[168:171], v[36:39]
    ds_read_b128 v[76:79], v112 offset:17408
    v_mfma_f32_16x16x32_bf16 v[40:43], v[84:87], v[168:171], v[40:43]
    ds_read_b128 v[80:83], v112 offset:18432
    v_mfma_f32_16x16x32_bf16 v[44:47], v[88:91], v[168:171], v[44:47]
    ds_read_b128 v[84:87], v112 offset:19456
    s_waitcnt vmcnt(5) lgkmcnt(10)
    v_mfma_f32_16x16x32_bf16 v[28:31], v[92:95], v[172:175], v[28:31]
    ds_read_b128 v[88:91], v112 offset:20480
    v_mfma_f32_16x16x32_bf16 v[32:35], v[96:99], v[172:175], v[32:35]
    ds_read_b128 v[92:95], v112 offset:21504
    v_mfma_f32_16x16x32_bf16 v[36:39], v[100:103], v[172:175], v[36:39]
    ds_read_b128 v[96:99], v112 offset:22528
    v_mfma_f32_16x16x32_bf16 v[40:43], v[104:107], v[172:175], v[40:43]
    ds_read_b128 v[100:103], v112 offset:23552
    v_mfma_f32_16x16x32_bf16 v[44:47], v[108:111], v[172:175], v[44:47]
    ds_read_b128 v[104:107], v112 offset:24576
    s_waitcnt vmcnt(4) lgkmcnt(10)
    v_mfma_f32_16x16x32_bf16 v[28:31], v[52:55], v[176:179], v[28:31]
    ds_read_b128 v[108:111], v112 offset:25600
    v_mfma_f32_16x16x32_bf16 v[32:35], v[56:59], v[176:179], v[32:35]
    ds_read_b128 v[52:55], v112 offset:26624
    v_mfma_f32_16x16x32_bf16 v[36:39], v[60:63], v[176:179], v[36:39]
    ds_read_b128 v[56:59], v112 offset:27648
    v_mfma_f32_16x16x32_bf16 v[40:43], v[64:67], v[176:179], v[40:43]
    ds_read_b128 v[60:63], v112 offset:28672
    v_mfma_f32_16x16x32_bf16 v[44:47], v[68:71], v[176:179], v[44:47]
    ds_read_b128 v[64:67], v112 offset:29696
    s_waitcnt vmcnt(3) lgkmcnt(9)
    v_mfma_f32_16x16x32_bf16 v[28:31], v[72:75], v[180:183], v[28:31]
    ds_read_b128 v[68:71], v112 offset:30720
    v_mfma_f32_16x16x32_bf16 v[32:35], v[76:79], v[180:183], v[32:35]
    ds_read_b128 v[72:75], v112 offset:31744
    v_mfma_f32_16x16x32_bf16 v[36:39], v[80:83], v[180:183], v[36:39]
    ds_read_b128 v[76:79], v112 offset:32768
    v_mfma_f32_16x16x32_bf16 v[40:43], v[84:87], v[180:183], v[40:43]
    ds_read_b128 v[80:83], v112 offset:33792
    v_mfma_f32_16x16x32_bf16 v[44:47], v[88:91], v[180:183], v[44:47]
    ds_read_b128 v[84:87], v112 offset:34816
    s_waitcnt vmcnt(2) lgkmcnt(9)
    v_mfma_f32_16x16x32_bf16 v[28:31], v[92:95], v[184:187], v[28:31]
    ds_read_b128 v[88:91], v112 offset:35840
    v_add_u32 v9, 258, v8
    v_mfma_f32_16x16x32_bf16 v[32:35], v[96:99], v[184:187], v[32:35]
    ds_write_b32 v5, v9
    v_mfma_f32_16x16x32_bf16 v[36:39], v[100:103], v[184:187], v[36:39]
    v_mfma_f32_16x16x32_bf16 v[40:43], v[104:107], v[184:187], v[40:43]
    v_mfma_f32_16x16x32_bf16 v[44:47], v[108:111], v[184:187], v[44:47]
    s_waitcnt vmcnt(1) lgkmcnt(6)
    v_mfma_f32_16x16x32_bf16 v[28:31], v[52:55], v[188:191], v[28:31]
    v_mfma_f32_16x16x32_bf16 v[32:35], v[56:59], v[188:191], v[32:35]
    v_mfma_f32_16x16x32_bf16 v[36:39], v[60:63], v[188:191], v[36:39]
    v_mfma_f32_16x16x32_bf16 v[40:43], v[64:67], v[188:191], v[40:43]
    v_mfma_f32_16x16x32_bf16 v[44:47], v[68:71], v[188:191], v[44:47]
    s_waitcnt vmcnt(0) lgkmcnt(1)
    v_mfma_f32_16x16x32_bf16 v[28:31], v[72:75], v[192:195], v[28:31]
    v_mfma_f32_16x16x32_bf16 v[32:35], v[76:79], v[192:195], v[32:35]
    v_mfma_f32_16x16x32_bf16 v[36:39], v[80:83], v[192:195], v[36:39]
    v_mfma_f32_16x16x32_bf16 v[40:43], v[84:87], v[192:195], v[40:43]
    v_mfma_f32_16x16x32_bf16 v[44:47], v[88:91], v[192:195], v[44:47]
    s_nop 3
    v_cvt_pk_bf16_f32 v12, v28, v29
    v_cvt_pk_bf16_f32 v13, v30, v31
    v_cvt_pk_bf16_f32 v14, v32, v33
    v_cvt_pk_bf16_f32 v15, v34, v35
    buffer_store_dwordx4 v[12:15], v4, s[4:7], s68 offen
    v_cvt_pk_bf16_f32 v16, v36, v37
    v_cvt_pk_bf16_f32 v17, v38, v39
    v_cvt_pk_bf16_f32 v18, v40, v41
    v_cvt_pk_bf16_f32 v19, v42, v43
    buffer_store_dwordx4 v[16:19], v4, s[4:7], s68 offen offset:1024
    v_cvt_pk_bf16_f32 v20, v44, v45
    v_cvt_pk_bf16_f32 v21, v46, v47
    buffer_store_dwordx2 v[20:21], v4, s[4:7], s69 offen
    v_pk_add_f32 v[24:25], v[28:29], v[30:31]
    v_pk_mul_f32 v[26:27], v[28:29], v[28:29]
    v_pk_fma_f32 v[26:27], v[30:31], v[30:31], v[26:27]
    v_pk_add_f32 v[24:25], v[24:25], v[32:33]
    v_pk_fma_f32 v[26:27], v[32:33], v[32:33], v[26:27]
    v_pk_add_f32 v[24:25], v[24:25], v[34:35]
    v_pk_fma_f32 v[26:27], v[34:35], v[34:35], v[26:27]
    v_pk_add_f32 v[24:25], v[24:25], v[36:37]
    v_pk_fma_f32 v[26:27], v[36:37], v[36:37], v[26:27]
    v_pk_add_f32 v[24:25], v[24:25], v[38:39]
    v_pk_fma_f32 v[26:27], v[38:39], v[38:39], v[26:27]
    v_pk_add_f32 v[24:25], v[24:25], v[40:41]
    v_pk_fma_f32 v[26:27], v[40:41], v[40:41], v[26:27]
    v_pk_add_f32 v[24:25], v[24:25], v[42:43]
    v_pk_fma_f32 v[26:27], v[42:43], v[42:43], v[26:27]
    v_pk_add_f32 v[24:25], v[24:25], v[44:45]
    v_pk_fma_f32 v[26:27], v[44:45], v[44:45], v[26:27]
    v_pk_add_f32 v[24:25], v[24:25], v[46:47]
    v_pk_fma_f32 v[26:27], v[46:47], v[46:47], v[26:27]
    v_add_f32 v24, v24, v25
    v_add_f32 v26, v26, v27
    s_nop 1
    v_permlane32_swap_b32 v24, v26
    v_add_f32 v24, v24, v26
    v_mov_b32 v26, v24
    s_nop 1
    v_permlane16_swap_b32 v24, v26
    v_add_f32 v24, v24, v26
    buffer_store_dword v24, v22, s[4:7], s70 offen
    v_add_u32 v176, 102400, v4
    s_mul_i32 s97, s38, 40960
    s_add_u32 s97, s97, s42
    s_add_u32 s97, s97, 0x0
    s_add_u32 s95, s97, 20480
    s_mov_b32 s84, s97
    v_add_u32 v252, 20480, v4
    s_lshl_b32 s77, s38, 11
    s_add_u32 s77, s77, s42
    s_add_u32 s77, s77, 0xb1000
    s_lshl_b32 s78, s38, 8
    s_add_u32 s78, s78, s42
    s_add_u32 s79, s78, 0xb0c00
    s_add_u32 s78, s78, 0xb0800
    v_and_b32 v177, 7, v1
    v_lshlrev_b32 v177, 2, v177
    v_and_b32 v10, 8, v1
    v_lshl_add_u32 v177, v10, 4, v177
    v_lshlrev_b32 v179, 4, v3
    v_add_u32 v179, 162400, v179
    s_waitcnt vmcnt(0)
    buffer_store_dword v7, v11, s[4:7], s71 offen offset:0
    s_cmpk_ge_i32 s44, 294
    s_cbranch_scc0 .Lcf48
.Lcr49:
    ds_read_b128 v[96:99], v179 offset:0
    ds_read_b128 v[120:123], v179 offset:384
    ds_read_b128 v[100:103], v179 offset:64
    ds_read_b128 v[124:127], v179 offset:448
    ds_read_b128 v[104:107], v179 offset:128
    ds_read_b128 v[128:131], v179 offset:512
    ds_read_b128 v[108:111], v179 offset:192
    ds_read_b128 v[132:135], v179 offset:576
    ds_read_b128 v[112:115], v179 offset:256
    ds_read_b128 v[136:139], v179 offset:640
    ds_read_b128 v[116:119], v179 offset:320
    ds_read_b128 v[140:143], v179 offset:704
    ds_read_b128 v[144:147], v176 offset:0
    ds_read_b128 v[148:151], v176 offset:1024
    ds_read_b128 v[152:155], v176 offset:2048
    ds_read_b128 v[156:159], v176 offset:3072
    ds_read_b128 v[160:163], v176 offset:4096
    ds_read_b128 v[164:167], v176 offset:5120
    s_mov_b32 exec_lo, 0xffff
    s_mov_b32 exec_hi, 0x0
.Lp50:
    buffer_load_dword v9, v177, s[4:7], s78 offen sc1
    s_waitcnt vmcnt(0)
    v_cmp_ne_u32 vcc, s41, v9
    s_nop 0
    s_cbranch_vccz .Lpd51
    s_sub_u32 s88, s88, 1
    s_cbranch_scc1 .Lend
    s_branch .Lp50
.Lpd51:
    s_mov_b64 exec, -1
    buffer_load_dwordx4 v[180:183], v4, s[4:7], s84 offen offset:0 sc1
    buffer_load_dwordx4 v[184:187], v252, s[4:7], s84 offen offset:0 sc1
    buffer_load_dwordx4 v[168:171], v4, s[4:7], s77 offen sc1
    buffer_load_dwordx4 v[172:175], v4, s[4:7], s77 offen offset:1024 sc1
    buffer_load_dwordx4 v[188:191], v4, s[4:7], s84 offen offset:1024 sc1
    buffer_load_dwordx4 v[192:195], v252, s[4:7], s84 offen offset:1024 sc1
    buffer_load_dwordx4 v[196:199], v4, s[4:7], s84 offen offset:2048 sc1
    buffer_load_dwordx4 v[200:203], v252, s[4:7], s84 offen offset:2048 sc1
    s_waitcnt vmcnt(6) lgkmcnt(4)
    v_mfma_f32_16x16x32_bf16 v[48:51], v[144:147], v[180:183], 0
    buffer_load_dwordx4 v[204:207], v4, s[4:7], s84 offen offset:3072 sc1
    v_mfma_f32_16x16x32_bf16 v[72:75], v[144:147], v[184:187], 0
    ds_read_b128 v[144:147], v176 offset:6144
    v_mfma_f32_16x16x32_bf16 v[52:55], v[148:151], v[180:183], 0
    buffer_load_dwordx4 v[208:211], v252, s[4:7], s84 offen offset:3072 sc1
    v_mfma_f32_16x16x32_bf16 v[76:79], v[148:151], v[184:187], 0
    ds_read_b128 v[148:151], v176 offset:7168
    s_waitcnt lgkmcnt(4)
    v_mfma_f32_16x16x32_bf16 v[56:59], v[152:155], v[180:183], 0
    s_add_u32 s84, s84, 4096
    ds_read_b32 v10, v6
    v_mfma_f32_16x16x32_bf16 v[80:83], v[152:155], v[184:187], 0
    ds_read_b128 v[152:155], v176 offset:8192
    s_mul_i32 s68, s38, 98304
    v_mfma_f32_16x16x32_bf16 v[60:63], v[156:159], v[180:183], 0
    s_mul_i32 s69, s40, 3072
    s_add_u32 s68, s68, s69
    s_add_u32 s68, s68, s42
    v_mfma_f32_16x16x32_bf16 v[84:87], v[156:159], v[184:187], 0
    ds_read_b128 v[156:159], v176 offset:9216
    s_waitcnt lgkmcnt(5)
    v_mfma_f32_16x16x32_bf16 v[64:67], v[160:163], v[180:183], 0
    buffer_load_dwordx4 v[212:215], v4, s[4:7], s84 offen offset:0 sc1
    v_mfma_f32_16x16x32_bf16 v[88:91], v[160:163], v[184:187], 0
    buffer_load_dwordx4 v[216:219], v252, s[4:7], s84 offen offset:0 sc1
    v_mfma_f32_16x16x32_bf16 v[68:71], v[164:167], v[180:183], 0
    v_add_u32 v9, 270, v8
    ds_read_b128 v[160:163], v176 offset:10240
    v_mfma_f32_16x16x32_bf16 v[92:95], v[164:167], v[184:187], 0
    ds_read_b128 v[164:167], v176 offset:11264
    s_waitcnt vmcnt(6) lgkmcnt(5)
    v_mfma_f32_16x16x32_bf16 v[48:51], v[144:147], v[188:191], v[48:51]
    ds_write_b32 v5, v9
    s_add_u32 s68, s68, 0x50000
    v_mfma_f32_16x16x32_bf16 v[72:75], v[144:147], v[192:195], v[72:75]
    s_cmpk_ge_i32 s44, 282
    s_cbranch_scc0 .Lcf52
.Lcr53:
    v_mfma_f32_16x16x32_bf16 v[52:55], v[148:151], v[188:191], v[52:55]
    ds_read_b128 v[144:147], v176 offset:12288
    s_add_u32 s69, s68, 49152
    v_mfma_f32_16x16x32_bf16 v[76:79], v[148:151], v[192:195], v[76:79]
    ds_read_b128 v[148:151], v176 offset:13312
    s_waitcnt lgkmcnt(5)
    v_mfma_f32_16x16x32_bf16 v[56:59], v[152:155], v[188:191], v[56:59]
    buffer_load_dwordx4 v[220:223], v4, s[4:7], s84 offen offset:1024 sc1
    v_mfma_f32_16x16x32_bf16 v[80:83], v[152:155], v[192:195], v[80:83]
    ds_read_b128 v[152:155], v176 offset:14336
    s_lshl_b32 s70, s40, 2
    v_mfma_f32_16x16x32_bf16 v[60:63], v[156:159], v[188:191], v[60:63]
    buffer_load_dwordx4 v[224:227], v252, s[4:7], s84 offen offset:1024 sc1
    v_mfma_f32_16x16x32_bf16 v[84:87], v[156:159], v[192:195], v[84:87]
    ds_read_b128 v[156:159], v176 offset:15360
    s_waitcnt lgkmcnt(5)
    v_mfma_f32_16x16x32_bf16 v[64:67], v[160:163], v[188:191], v[64:67]
    s_add_u32 s76, s79, s70
    v_readfirstlane_b32 s94, v10
    v_mfma_f32_16x16x32_bf16 v[88:91], v[160:163], v[192:195], v[88:91]
    ds_read_b128 v[160:163], v176 offset:16384
    v_mfma_f32_16x16x32_bf16 v[68:71], v[164:167], v[188:191], v[68:71]
    s_sub_u32 s44, s94, s43
    v_mfma_f32_16x16x32_bf16 v[92:95], v[164:167], v[192:195], v[92:95]
    ds_read_b128 v[164:167], v176 offset:17408
    s_waitcnt vmcnt(6) lgkmcnt(4)
    v_mfma_f32_16x16x32_bf16 v[48:51], v[144:147], v[196:199], v[48:51]
    buffer_load_dwordx4 v[228:231], v4, s[4:7], s84 offen offset:2048 sc1
    v_mfma_f32_16x16x32_bf16 v[72:75], v[144:147], v[200:203], v[72:75]
    ds_read_b128 v[144:147], v176 offset:18432
    v_mfma_f32_16x16x32_bf16 v[52:55], v[148:151], v[196:199], v[52:55]
    buffer_load_dwordx4 v[232:235], v252, s[4:7], s84 offen offset:2048 sc1
    v_mfma_f32_16x16x32_bf16 v[76:79], v[148:151], v[200:203], v[76:79]
    ds_read_b128 v[148:151], v176 offset:19456
    s_waitcnt lgkmcnt(4)
    v_mfma_f32_16x16x32_bf16 v[56:59], v[152:155], v[196:199], v[56:59]
    v_mfma_f32_16x16x32_bf16 v[80:83], v[152:155], v[200:203], v[80:83]
    ds_read_b128 v[152:155], v176 offset:20480
    v_mfma_f32_16x16x32_bf16 v[60:63], v[156:159], v[196:199], v[60:63]
    v_mfma_f32_16x16x32_bf16 v[84:87], v[156:159], v[200:203], v[84:87]
    ds_read_b128 v[156:159], v176 offset:21504
    s_waitcnt lgkmcnt(4)
    v_mfma_f32_16x16x32_bf16 v[64:67], v[160:163], v[196:199], v[64:67]
    buffer_load_dwordx4 v[236:239], v4, s[4:7], s84 offen offset:3072 sc1
    v_mfma_f32_16x16x32_bf16 v[88:91], v[160:163], v[200:203], v[88:91]
    buffer_load_dwordx4 v[240:243], v252, s[4:7], s84 offen offset:3072 sc1
    v_mfma_f32_16x16x32_bf16 v[68:71], v[164:167], v[196:199], v[68:71]
    v_add_u32 v9, 282, v8
    ds_read_b128 v[160:163], v176 offset:22528
    v_mfma_f32_16x16x32_bf16 v[92:95], v[164:167], v[200:203], v[92:95]
    ds_read_b128 v[164:167], v176 offset:23552
    s_waitcnt vmcnt(8) lgkmcnt(4)
    v_mfma_f32_16x16x32_bf16 v[48:51], v[144:147], v[204:207], v[48:51]
    ds_write_b32 v5, v9
    s_add_u32 s84, s84, 4096
    v_mfma_f32_16x16x32_bf16 v[72:75], v[144:147], v[208:211], v[72:75]
    s_cmpk_ge_i32 s44, 294
    s_cbranch_scc0 .Lcf54
.Lcr55:
    v_mfma_f32_16x16x32_bf16 v[52:55], v[148:151], v[204:207], v[52:55]
    ds_read_b128 v[144:147], v176 offset:24576
    v_mfma_f32_16x16x32_bf16 v[76:79], v[148:151], v[208:211], v[76:79]
    ds_read_b128 v[148:151], v176 offset:25600
    s_waitcnt lgkmcnt(5)
    v_mfma_f32_16x16x32_bf16 v[56:59], v[152:155], v[204:207], v[56:59]
    buffer_load_dwordx4 v[244:247], v4, s[4:7], s84 offen offset:0 sc1
    v_mfma_f32_16x16x32_bf16 v[80:83], v[152:155], v[208:211], v[80:83]
    ds_read_b128 v[152:155], v176 offset:26624
    v_mfma_f32_16x16x32_bf16 v[60:63], v[156:159], v[204:207], v[60:63]
    buffer_load_dwordx4 v[248:251], v252, s[4:7], s84 offen offset:0 sc1
    v_mfma_f32_16x16x32_bf16 v[84:87], v[156:159], v[208:211], v[84:87]
    ds_read_b128 v[156:159], v176 offset:27648
    s_waitcnt lgkmcnt(5)
    v_mfma_f32_16x16x32_bf16 v[64:67], v[160:163], v[204:207], v[64:67]
    v_mfma_f32_16x16x32_bf16 v[88:91], v[160:163], v[208:211], v[88:91]
    ds_read_b128 v[160:163], v176 offset:28672
    v_mfma_f32_16x16x32_bf16 v[68:71], v[164:167], v[204:207], v[68:71]
    v_mfma_f32_16x16x32_bf16 v[92:95], v[164:167], v[208:211], v[92:95]
    ds_read_b128 v[164:167], v176 offset:29696
    s_waitcnt vmcnt(8) lgkmcnt(4)
    v_mfma_f32_16x16x32_bf16 v[48:51], v[144:147], v[212:215], v[48:51]
    buffer_load_dwordx4 v[180:183], v4, s[4:7], s84 offen offset:1024 sc1
    v_mfma_f32_16x16x32_bf16 v[72:75], v[144:147], v[216:219], v[72:75]
    ds_read_b128 v[144:147], v176 offset:30720
    v_mfma_f32_16x16x32_bf16 v[52:55], v[148:151], v[212:215], v[52:55]
    buffer_load_dwordx4 v[184:187], v252, s[4:7], s84 offen offset:1024 sc1
    v_mfma_f32_16x16x32_bf16 v[76:79], v[148:151], v[216:219], v[76:79]
    ds_read_b128 v[148:151], v176 offset:31744
    s_waitcnt lgkmcnt(4)
    v_mfma_f32_16x16x32_bf16 v[56:59], v[152:155], v[212:215], v[56:59]
    s_add_u32 s84, s84, 2048
    ds_read_b32 v10, v6
    v_mfma_f32_16x16x32_bf16 v[80:83], v[152:155], v[216:219], v[80:83]
    ds_read_b128 v[152:155], v176 offset:32768
    v_mfma_f32_16x16x32_bf16 v[60:63], v[156:159], v[212:215], v[60:63]
    v_mfma_f32_16x16x32_bf16 v[84:87], v[156:159], v[216:219], v[84:87]
    ds_read_b128 v[156:159], v176 offset:33792
    s_waitcnt lgkmcnt(5)
    v_mfma_f32_16x16x32_bf16 v[64:67], v[160:163], v[212:215], v[64:67]
    buffer_load_dwordx4 v[188:191], v4, s[4:7], s84 offen offset:0 sc1
    v_mfma_f32_16x16x32_bf16 v[88:91], v[160:163], v[216:219], v[88:91]
    buffer_load_dwordx4 v[192:195], v252, s[4:7], s84 offen offset:0 sc1
    v_mfma_f32_16x16x32_bf16 v[68:71], v[164:167], v[212:215], v[68:71]
    v_add_u32 v9, 294, v8
    ds_read_b128 v[160:163], v176 offset:34816
    v_mfma_f32_16x16x32_bf16 v[92:95], v[164:167], v[216:219], v[92:95]
    ds_read_b128 v[164:167], v176 offset:35840
    s_waitcnt vmcnt(10) lgkmcnt(5)
    v_mfma_f32_16x16x32_bf16 v[48:51], v[144:147], v[220:223], v[48:51]
    ds_write_b32 v5, v9
    v_add_f32 v168, v168, v170
    v_mfma_f32_16x16x32_bf16 v[72:75], v[144:147], v[224:227], v[72:75]
    s_cmpk_ge_i32 s44, 306
    s_cbranch_scc0 .Lcf56
.Lcr57:
    v_mfma_f32_16x16x32_bf16 v[52:55], v[148:151], v[220:223], v[52:55]
    ds_read_b128 v[144:147], v176 offset:36864
    v_add_f32 v169, v169, v171
    v_mfma_f32_16x16x32_bf16 v[76:79], v[148:151], v[224:227], v[76:79]
    ds_read_b128 v[148:151], v176 offset:37888
    s_waitcnt lgkmcnt(5)
    v_mfma_f32_16x16x32_bf16 v[56:59], v[152:155], v[220:223], v[56:59]
    buffer_load_dwordx4 v[196:199], v4, s[4:7], s84 offen offset:1024 sc1
    v_mfma_f32_16x16x32_bf16 v[80:83], v[152:155], v[224:227], v[80:83]
    ds_read_b128 v[152:155], v176 offset:38912
    v_readfirstlane_b32 s94, v10
    v_mfma_f32_16x16x32_bf16 v[60:63], v[156:159], v[220:223], v[60:63]
    buffer_load_dwordx4 v[200:203], v252, s[4:7], s84 offen offset:1024 sc1
    v_mfma_f32_16x16x32_bf16 v[84:87], v[156:159], v[224:227], v[84:87]
    ds_read_b128 v[156:159], v176 offset:39936
    s_waitcnt lgkmcnt(5)
    v_mfma_f32_16x16x32_bf16 v[64:67], v[160:163], v[220:223], v[64:67]
    s_sub_u32 s44, s94, s43
    v_permlane32_swap_b32 v168, v169
    v_mfma_f32_16x16x32_bf16 v[88:91], v[160:163], v[224:227], v[88:91]
    ds_read_b128 v[160:163], v176 offset:40960
    v_add_f32 v168, v168, v169
    v_mfma_f32_16x16x32_bf16 v[68:71], v[164:167], v[220:223], v[68:71]
    v_mov_b32 v169, v168
    v_mfma_f32_16x16x32_bf16 v[92:95], v[164:167], v[224:227], v[92:95]
    ds_read_b128 v[164:167], v176 offset:41984
    s_waitcnt vmcnt(10) lgkmcnt(4)
    v_mfma_f32_16x16x32_bf16 v[48:51], v[144:147], v[228:231], v[48:51]
    buffer_load_dwordx4 v[204:207], v4, s[4:7], s84 offen offset:2048 sc1
    v_mfma_f32_16x16x32_bf16 v[72:75], v[144:147], v[232:235], v[72:75]
    ds_read_b128 v[144:147], v176 offset:43008
    v_permlane16_swap_b32 v168, v169
    v_mfma_f32_16x16x32_bf16 v[52:55], v[148:151], v[228:231], v[52:55]
    buffer_load_dwordx4 v[208:211], v252, s[4:7], s84 offen offset:2048 sc1
    v_mfma_f32_16x16x32_bf16 v[76:79], v[148:151], v[232:235], v[76:79]
    ds_read_b128 v[148:151], v176 offset:44032
    s_waitcnt lgkmcnt(4)
    v_mfma_f32_16x16x32_bf16 v[56:59], v[152:155], v[228:231], v[56:59]
    v_add_f32 v168, v168, v169
    v_mfma_f32_16x16x32_bf16 v[80:83], v[152:155], v[232:235], v[80:83]
    ds_read_b128 v[152:155], v176 offset:45056
    v_mul_f32 v168, 0x3acccccd, v168
    v_mfma_f32_16x16x32_bf16 v[60:63], v[156:159], v[228:231], v[60:63]
    v_mov_b32 v169, v168
    v_mfma_f32_16x16x32_bf16 v[84:87], v[156:159], v[232:235], v[84:87]
    ds_read_b128 v[156:159], v176 offset:46080
    s_waitcnt lgkmcnt(4)
    v_mfma_f32_16x16x32_bf16 v[64:67], v[160:163], v[228:231], v[64:67]
    buffer_load_dwordx4 v[212:215], v4, s[4:7], s84 offen offset:3072 sc1
    v_mfma_f32_16x16x32_bf16 v[88:91], v[160:163], v[232:235], v[88:91]
    buffer_load_dwordx4 v[216:219], v252, s[4:7], s84 offen offset:3072 sc1
    v_mfma_f32_16x16x32_bf16 v[68:71], v[164:167], v[228:231], v[68:71]
    v_add_u32 v9, 306, v8
    ds_read_b128 v[160:163], v176 offset:47104
    v_mfma_f32_16x16x32_bf16 v[92:95], v[164:167], v[232:235], v[92:95]
    ds_read_b128 v[164:167], v176 offset:48128
    s_waitcnt vmcnt(12) lgkmcnt(4)
    v_mfma_f32_16x16x32_bf16 v[48:51], v[144:147], v[236:239], v[48:51]
    ds_write_b32 v5, v9
    s_add_u32 s84, s84, 4096
    v_mfma_f32_16x16x32_bf16 v[72:75], v[144:147], v[240:243], v[72:75]
    s_cmpk_ge_i32 s44, 318
    s_cbranch_scc0 .Lcf58
.Lcr59:
    v_mfma_f32_16x16x32_bf16 v[52:55], v[148:151], v[236:239], v[52:55]
    ds_read_b128 v[144:147], v176 offset:49152
    v_permlane32_swap_b32 v168, v169
    v_mfma_f32_16x16x32_bf16 v[76:79], v[148:151], v[240:243], v[76:79]
    ds_read_b128 v[148:151], v176 offset:50176
    s_waitcnt lgkmcnt(5)
    v_mfma_f32_16x16x32_bf16 v[56:59], v[152:155], v[236:239], v[56:59]
    buffer_load_dwordx4 v[220:223], v4, s[4:7], s84 offen offset:0 sc1
    v_mfma_f32_16x16x32_bf16 v[80:83], v[152:155], v[240:243], v[80:83]
    ds_read_b128 v[152:155], v176 offset:51200
    v_fma_f32 v170, -v168, v168, v169
    v_mfma_f32_16x16x32_bf16 v[60:63], v[156:159], v[236:239], v[60:63]
    buffer_load_dwordx4 v[224:227], v252, s[4:7], s84 offen offset:0 sc1
    v_mfma_f32_16x16x32_bf16 v[84:87], v[156:159], v[240:243], v[84:87]
    ds_read_b128 v[156:159], v176 offset:52224
    s_waitcnt lgkmcnt(5)
    v_mfma_f32_16x16x32_bf16 v[64:67], v[160:163], v[236:239], v[64:67]
    v_max_f32 v170, 0, v170
    v_mfma_f32_16x16x32_bf16 v[88:91], v[160:163], v[240:243], v[88:91]
    ds_read_b128 v[160:163], v176 offset:53248
    v_add_f32 v170, 0x3727c5ac, v170
    v_mfma_f32_16x16x32_bf16 v[68:71], v[164:167], v[236:239], v[68:71]
    v_rsq_f32 v171, v170
    v_mfma_f32_16x16x32_bf16 v[92:95], v[164:167], v[240:243], v[92:95]
    ds_read_b128 v[164:167], v176 offset:54272
    s_waitcnt vmcnt(12) lgkmcnt(4)
    v_mfma_f32_16x16x32_bf16 v[48:51], v[144:147], v[244:247], v[48:51]
    buffer_load_dwordx4 v[228:231], v4, s[4:7], s84 offen offset:1024 sc1
    v_mfma_f32_16x16x32_bf16 v[72:75], v[144:147], v[248:251], v[72:75]
    ds_read_b128 v[144:147], v176 offset:55296
    v_mul_f32_e64 v169, -v168, v171
    v_mfma_f32_16x16x32_bf16 v[52:55], v[148:151], v[244:247], v[52:55]
    buffer_load_dwordx4 v[232:235], v252, s[4:7], s84 offen offset:1024 sc1
    v_mfma_f32_16x16x32_bf16 v[76:79], v[148:151], v[248:251], v[76:79]
    ds_read_b128 v[148:151], v176 offset:56320
    s_waitcnt lgkmcnt(4)
    v_mfma_f32_16x16x32_bf16 v[56:59], v[152:155], v[244:247], v[56:59]
    ds_read_b32 v10, v6
    v_mov_b32 v168, v171
    v_mfma_f32_16x16x32_bf16 v[80:83], v[152:155], v[248:251], v[80:83]
    ds_read_b128 v[152:155], v176 offset:57344
    v_add_f32 v172, v172, v174
    v_mfma_f32_16x16x32_bf16 v[60:63], v[156:159], v[244:247], v[60:63]
    v_add_f32 v173, v173, v175
    v_mfma_f32_16x16x32_bf16 v[84:87], v[156:159], v[248:251], v[84:87]
    ds_read_b128 v[156:159], v176 offset:58368
    s_waitcnt lgkmcnt(5)
    v_mfma_f32_16x16x32_bf16 v[64:67], v[160:163], v[244:247], v[64:67]
    buffer_load_dwordx4 v[236:239], v4, s[4:7], s84 offen offset:2048 sc1
    v_mfma_f32_16x16x32_bf16 v[88:91], v[160:163], v[248:251], v[88:91]
    v_add_u32 v176, 0, v4
    v_mfma_f32_16x16x32_bf16 v[68:71], v[164:167], v[244:247], v[68:71]
    v_add_u32 v9, 318, v8
    ds_read_b128 v[160:163], v176 offset:0
    v_mfma_f32_16x16x32_bf16 v[92:95], v[164:167], v[248:251], v[92:95]
    ds_read_b128 v[164:167], v176 offset:1024
    s_waitcnt vmcnt(13) lgkmcnt(5)
    v_mfma_f32_16x16x32_bf16 v[48:51], v[144:147], v[180:183], v[48:51]
    ds_write_b32 v5, v9
    v_permlane32_swap_b32 v172, v173
    v_mfma_f32_16x16x32_bf16 v[72:75], v[144:147], v[184:187], v[72:75]
    s_cmpk_ge_i32 s44, 330
    s_cbranch_scc0 .Lcf60
.Lcr61:
    v_mfma_f32_16x16x32_bf16 v[52:55], v[148:151], v[180:183], v[52:55]
    buffer_load_dwordx4 v[240:243], v252, s[4:7], s84 offen offset:2048 sc1
    v_mfma_f32_16x16x32_bf16 v[76:79], v[148:151], v[184:187], v[76:79]
    ds_read_b128 v[144:147], v176 offset:2048
    s_waitcnt lgkmcnt(4)
    v_mfma_f32_16x16x32_bf16 v[56:59], v[152:155], v[180:183], v[56:59]
    ds_read_b128 v[148:151], v176 offset:3072
    v_readfirstlane_b32 s94, v10
    v_mfma_f32_16x16x32_bf16 v[80:83], v[152:155], v[184:187], v[80:83]
    ds_read_b128 v[152:155], v176 offset:4096
    v_add_f32 v172, v172, v173
    v_mfma_f32_16x16x32_bf16 v[60:63], v[156:159], v[180:183], v[60:63]
    buffer_load_dwordx4 v[244:247], v4, s[4:7], s84 offen offset:3072 sc1
    v_mfma_f32_16x16x32_bf16 v[84:87], v[156:159], v[184:187], v[84:87]
    ds_read_b128 v[156:159], v176 offset:5120
    s_waitcnt lgkmcnt(5)
    v_mfma_f32_16x16x32_bf16 v[64:67], v[160:163], v[180:183], v[64:67]
    buffer_load_dwordx4 v[248:251], v252, s[4:7], s84 offen offset:3072 sc1
    v_mfma_f32_16x16x32_bf16 v[88:91], v[160:163], v[184:187], v[88:91]
    s_add_u32 s84, s84, 4096
    s_sub_u32 s44, s94, s43
    v_mov_b32 v173, v172
    v_mfma_f32_16x16x32_bf16 v[68:71], v[164:167], v[180:183], v[68:71]
    ds_read_b128 v[160:163], v176 offset:6144
    v_permlane16_swap_b32 v172, v173
    v_mfma_f32_16x16x32_bf16 v[92:95], v[164:167], v[184:187], v[92:95]
    ds_read_b128 v[164:167], v176 offset:7168
    s_waitcnt vmcnt(14) lgkmcnt(4)
    v_mfma_f32_16x16x32_bf16 v[48:51], v[144:147], v[188:191], v[48:51]
    buffer_load_dwordx4 v[180:183], v4, s[4:7], s84 offen offset:0 sc1
    v_mfma_f32_16x16x32_bf16 v[72:75], v[144:147], v[192:195], v[72:75]
    ds_read_b128 v[144:147], v176 offset:8192
    v_add_f32 v172, v172, v173
    v_mfma_f32_16x16x32_bf16 v[52:55], v[148:151], v[188:191], v[52:55]
    buffer_load_dwordx4 v[184:187], v252, s[4:7], s84 offen offset:0 sc1
    v_mfma_f32_16x16x32_bf16 v[76:79], v[148:151], v[192:195], v[76:79]
    ds_read_b128 v[148:151], v176 offset:9216
    s_waitcnt lgkmcnt(4)
    v_mfma_f32_16x16x32_bf16 v[56:59], v[152:155], v[188:191], v[56:59]
    v_mul_f32 v172, 0x3acccccd, v172
    v_mfma_f32_16x16x32_bf16 v[80:83], v[152:155], v[192:195], v[80:83]
    ds_read_b128 v[152:155], v176 offset:10240
    v_mov_b32 v173, v172
    v_mfma_f32_16x16x32_bf16 v[60:63], v[156:159], v[188:191], v[60:63]
    s_nop 0
    v_permlane32_swap_b32 v172, v173
    v_mfma_f32_16x16x32_bf16 v[84:87], v[156:159], v[192:195], v[84:87]
    ds_read_b128 v[156:159], v176 offset:11264
    s_waitcnt lgkmcnt(4)
    v_mfma_f32_16x16x32_bf16 v[64:67], v[160:163], v[188:191], v[64:67]
    v_add_u32 v9, 330, v8
    v_mfma_f32_16x16x32_bf16 v[88:91], v[160:163], v[192:195], v[88:91]
    ds_read_b128 v[160:163], v176 offset:12288
    v_fma_f32 v174, -v172, v172, v173
    v_mfma_f32_16x16x32_bf16 v[68:71], v[164:167], v[188:191], v[68:71]
    v_max_f32 v174, 0, v174
    v_mfma_f32_16x16x32_bf16 v[92:95], v[164:167], v[192:195], v[92:95]
    ds_read_b128 v[164:167], v176 offset:13312
    s_waitcnt vmcnt(14) lgkmcnt(4)
    v_mfma_f32_16x16x32_bf16 v[48:51], v[144:147], v[196:199], v[48:51]
    ds_write_b32 v5, v9
    v_add_f32 v174, 0x3727c5ac, v174
    v_mfma_f32_16x16x32_bf16 v[72:75], v[144:147], v[200:203], v[72:75]
    s_cmpk_ge_i32 s44, 342
    s_cbranch_scc0 .Lcf62
.Lcr63:
    v_mfma_f32_16x16x32_bf16 v[52:55], v[148:151], v[196:199], v[52:55]
    ds_read_b128 v[144:147], v176 offset:14336
    v_mfma_f32_16x16x32_bf16 v[76:79], v[148:151], v[200:203], v[76:79]
    ds_read_b128 v[148:151], v176 offset:15360
    s_waitcnt lgkmcnt(5)
    v_mfma_f32_16x16x32_bf16 v[56:59], v[152:155], v[196:199], v[56:59]
    buffer_load_dwordx4 v[188:191], v4, s[4:7], s84 offen offset:1024 sc1
    v_mfma_f32_16x16x32_bf16 v[80:83], v[152:155], v[200:203], v[80:83]
    buffer_load_dwordx4 v[192:195], v252, s[4:7], s84 offen offset:1024 sc1
    v_mfma_f32_16x16x32_bf16 v[60:63], v[156:159], v[196:199], v[60:63]
    ds_read_b128 v[152:155], v176 offset:16384
    v_mfma_f32_16x16x32_bf16 v[84:87], v[156:159], v[200:203], v[84:87]
    ds_read_b128 v[156:159], v176 offset:17408
    s_waitcnt lgkmcnt(5)
    v_mfma_f32_16x16x32_bf16 v[64:67], v[160:163], v[196:199], v[64:67]
    v_rsq_f32 v175, v174
    v_mfma_f32_16x16x32_bf16 v[88:91], v[160:163], v[200:203], v[88:91]
    ds_read_b128 v[160:163], v176 offset:18432
    v_mul_f32_e64 v173, -v172, v175
    v_mfma_f32_16x16x32_bf16 v[68:71], v[164:167], v[196:199], v[68:71]
    v_mov_b32 v172, v175
    v_mfma_f32_16x16x32_bf16 v[92:95], v[164:167], v[200:203], v[92:95]
    ds_read_b128 v[164:167], v176 offset:19456
    s_waitcnt vmcnt(14) lgkmcnt(4)
    v_mfma_f32_16x16x32_bf16 v[48:51], v[144:147], v[204:207], v[48:51]
    v_lshrrev_b32 v179, 5, v1
    v_mfma_f32_16x16x32_bf16 v[72:75], v[144:147], v[208:211], v[72:75]
    ds_read_b128 v[144:147], v176 offset:20480
    v_mul_u32_u24 v179, 49152, v179
    v_mfma_f32_16x16x32_bf16 v[52:55], v[148:151], v[204:207], v[52:55]
    ds_read_b32 v10, v6
    v_and_b32 v178, 31, v1
    v_mfma_f32_16x16x32_bf16 v[76:79], v[148:151], v[208:211], v[76:79]
    ds_read_b128 v[148:151], v176 offset:21504
    s_waitcnt lgkmcnt(5)
    v_mfma_f32_16x16x32_bf16 v[56:59], v[152:155], v[204:207], v[56:59]
    v_min_u32 v178, 23, v178
    v_mfma_f32_16x16x32_bf16 v[80:83], v[152:155], v[208:211], v[80:83]
    ds_read_b128 v[152:155], v176 offset:22528
    v_lshl_add_u32 v178, v178, 7, v179
    v_mfma_f32_16x16x32_bf16 v[60:63], v[156:159], v[204:207], v[60:63]
    v_or_b32 v178, s90, v178
    v_mfma_f32_16x16x32_bf16 v[84:87], v[156:159], v[208:211], v[84:87]
    ds_read_b128 v[156:159], v176 offset:23552
    s_waitcnt lgkmcnt(5)
    v_mfma_f32_16x16x32_bf16 v[64:67], v[160:163], v[204:207], v[64:67]
    buffer_load_dword v179, v178, s[4:7], s68 offen sc1
    v_mfma_f32_16x16x32_bf16 v[88:91], v[160:163], v[208:211], v[88:91]
    v_add_u32 v9, 342, v8
    v_mfma_f32_16x16x32_bf16 v[68:71], v[164:167], v[204:207], v[68:71]
    ds_read_b128 v[160:163], v176 offset:24576
    v_fma_f32 v24, v96, v169, v120
    v_mfma_f32_16x16x32_bf16 v[92:95], v[164:167], v[208:211], v[92:95]
    ds_read_b128 v[164:167], v176 offset:25600
    s_waitcnt vmcnt(13) lgkmcnt(4)
    v_mfma_f32_16x16x32_bf16 v[48:51], v[144:147], v[212:215], v[48:51]
    ds_write_b32 v5, v9
    v_fma_f32 v120, v96, v173, v120
    v_mfma_f32_16x16x32_bf16 v[72:75], v[144:147], v[216:219], v[72:75]
    s_cmpk_ge_i32 s44, 354
    s_cbranch_scc0 .Lcf64
.Lcr65:
    v_mfma_f32_16x16x32_bf16 v[52:55], v[148:151], v[212:215], v[52:55]
    ds_read_b128 v[144:147], v176 offset:26624
    v_fma_f32 v25, v97, v169, v121
    v_mfma_f32_16x16x32_bf16 v[76:79], v[148:151], v[216:219], v[76:79]
    ds_read_b128 v[148:151], v176 offset:27648
    s_waitcnt lgkmcnt(5)
    v_mfma_f32_16x16x32_bf16 v[56:59], v[152:155], v[212:215], v[56:59]
    v_readfirstlane_b32 s94, v10
    v_mfma_f32_16x16x32_bf16 v[80:83], v[152:155], v[216:219], v[80:83]
    ds_read_b128 v[152:155], v176 offset:28672
    v_fma_f32 v121, v97, v173, v121
    v_mfma_f32_16x16x32_bf16 v[60:63], v[156:159], v[212:215], v[60:63]
    s_sub_u32 s44, s94, s43
    v_fma_f32 v26, v98, v169, v122
    v_mfma_f32_16x16x32_bf16 v[84:87], v[156:159], v[216:219], v[84:87]
    ds_read_b128 v[156:159], v176 offset:29696
    s_waitcnt lgkmcnt(5)
    v_mfma_f32_16x16x32_bf16 v[64:67], v[160:163], v[212:215], v[64:67]
    v_fma_f32 v122, v98, v173, v122
    v_mfma_f32_16x16x32_bf16 v[88:91], v[160:163], v[216:219], v[88:91]
    ds_read_b128 v[160:163], v176 offset:30720
    v_fma_f32 v27, v99, v169, v123
    v_mfma_f32_16x16x32_bf16 v[68:71], v[164:167], v[212:215], v[68:71]
    v_fma_f32 v123, v99, v173, v123
    v_mfma_f32_16x16x32_bf16 v[92:95], v[164:167], v[216:219], v[92:95]
    ds_read_b128 v[164:167], v176 offset:31744
    s_waitcnt vmcnt(11) lgkmcnt(4)
    v_mfma_f32_16x16x32_bf16 v[48:51], v[144:147], v[220:223], v[48:51]
    v_fma_f32 v28, v100, v169, v124
    v_mfma_f32_16x16x32_bf16 v[72:75], v[144:147], v[224:227], v[72:75]
    ds_read_b128 v[144:147], v176 offset:32768
    v_fma_f32 v124, v100, v173, v124
    v_mfma_f32_16x16x32_bf16 v[52:55], v[148:151], v[220:223], v[52:55]
    v_fma_f32 v29, v101, v169, v125
    v_mfma_f32_16x16x32_bf16 v[76:79], v[148:151], v[224:227], v[76:79]
    ds_read_b128 v[148:151], v176 offset:33792
    s_waitcnt lgkmcnt(4)
    v_mfma_f32_16x16x32_bf16 v[56:59], v[152:155], v[220:223], v[56:59]
    v_fma_f32 v125, v101, v173, v125
    v_mfma_f32_16x16x32_bf16 v[80:83], v[152:155], v[224:227], v[80:83]
    ds_read_b128 v[152:155], v176 offset:34816
    v_fma_f32 v30, v102, v169, v126
    v_mfma_f32_16x16x32_bf16 v[60:63], v[156:159], v[220:223], v[60:63]
    v_fma_f32 v126, v102, v173, v126
    v_mfma_f32_16x16x32_bf16 v[84:87], v[156:159], v[224:227], v[84:87]
    ds_read_b128 v[156:159], v176 offset:35840
    s_waitcnt lgkmcnt(4)
    v_mfma_f32_16x16x32_bf16 v[64:67], v[160:163], v[220:223], v[64:67]
    v_add_u32 v9, 354, v8
    v_mfma_f32_16x16x32_bf16 v[88:91], v[160:163], v[224:227], v[88:91]
    ds_read_b128 v[160:163], v176 offset:36864
    v_fma_f32 v31, v103, v169, v127
    v_mfma_f32_16x16x32_bf16 v[68:71], v[164:167], v[220:223], v[68:71]
    v_fma_f32 v127, v103, v173, v127
    v_mfma_f32_16x16x32_bf16 v[92:95], v[164:167], v[224:227], v[92:95]
    ds_read_b128 v[164:167], v176 offset:37888
    s_waitcnt vmcnt(9) lgkmcnt(4)
    v_mfma_f32_16x16x32_bf16 v[48:51], v[144:147], v[228:231], v[48:51]
    ds_write_b32 v5, v9
    v_fma_f32 v32, v104, v169, v128
    v_mfma_f32_16x16x32_bf16 v[72:75], v[144:147], v[232:235], v[72:75]
    s_cmpk_ge_i32 s44, 366
    s_cbranch_scc0 .Lcf66
.Lcr67:
    v_mfma_f32_16x16x32_bf16 v[52:55], v[148:151], v[228:231], v[52:55]
    ds_read_b128 v[144:147], v176 offset:38912
    v_fma_f32 v128, v104, v173, v128
    v_mfma_f32_16x16x32_bf16 v[76:79], v[148:151], v[232:235], v[76:79]
    ds_read_b128 v[148:151], v176 offset:39936
    s_waitcnt lgkmcnt(5)
    v_mfma_f32_16x16x32_bf16 v[56:59], v[152:155], v[228:231], v[56:59]
    v_fma_f32 v33, v105, v169, v129
    v_mfma_f32_16x16x32_bf16 v[80:83], v[152:155], v[232:235], v[80:83]
    ds_read_b128 v[152:155], v176 offset:40960
    v_fma_f32 v129, v105, v173, v129
    v_mfma_f32_16x16x32_bf16 v[60:63], v[156:159], v[228:231], v[60:63]
    v_fma_f32 v34, v106, v169, v130
    v_mfma_f32_16x16x32_bf16 v[84:87], v[156:159], v[232:235], v[84:87]
    ds_read_b128 v[156:159], v176 offset:41984
    s_waitcnt lgkmcnt(5)
    v_mfma_f32_16x16x32_bf16 v[64:67], v[160:163], v[228:231], v[64:67]
    v_fma_f32 v130, v106, v173, v130
    v_mfma_f32_16x16x32_bf16 v[88:91], v[160:163], v[232:235], v[88:91]
    ds_read_b128 v[160:163], v176 offset:43008
    v_fma_f32 v35, v107, v169, v131
    v_mfma_f32_16x16x32_bf16 v[68:71], v[164:167], v[228:231], v[68:71]
    v_fma_f32 v131, v107, v173, v131
    v_mfma_f32_16x16x32_bf16 v[92:95], v[164:167], v[232:235], v[92:95]
    ds_read_b128 v[164:167], v176 offset:44032
    s_waitcnt vmcnt(7) lgkmcnt(4)
    v_mfma_f32_16x16x32_bf16 v[48:51], v[144:147], v[236:239], v[48:51]
    v_fma_f32 v36, v108, v169, v132
    v_mfma_f32_16x16x32_bf16 v[72:75], v[144:147], v[240:243], v[72:75]
    ds_read_b128 v[144:147], v176 offset:45056
    v_fma_f32 v132, v108, v173, v132
    v_mfma_f32_16x16x32_bf16 v[52:55], v[148:151], v[236:239], v[52:55]
    ds_read_b32 v10, v6
    v_fma_f32 v37, v109, v169, v133
    v_mfma_f32_16x16x32_bf16 v[76:79], v[148:151], v[240:243], v[76:79]
    ds_read_b128 v[148:151], v176 offset:46080
    s_waitcnt lgkmcnt(5)
    v_mfma_f32_16x16x32_bf16 v[56:59], v[152:155], v[236:239], v[56:59]
    v_fma_f32 v133, v109, v173, v133
    v_mfma_f32_16x16x32_bf16 v[80:83], v[152:155], v[240:243], v[80:83]
    ds_read_b128 v[152:155], v176 offset:47104
    v_fma_f32 v38, v110, v169, v134
    v_mfma_f32_16x16x32_bf16 v[60:63], v[156:159], v[236:239], v[60:63]
    v_fma_f32 v134, v110, v173, v134
    v_mfma_f32_16x16x32_bf16 v[84:87], v[156:159], v[240:243], v[84:87]
    ds_read_b128 v[156:159], v176 offset:48128
    s_waitcnt lgkmcnt(5)
    v_mfma_f32_16x16x32_bf16 v[64:67], v[160:163], v[236:239], v[64:67]
    v_fma_f32 v39, v111, v169, v135
    v_mfma_f32_16x16x32_bf16 v[88:91], v[160:163], v[240:243], v[88:91]
    ds_read_b128 v[160:163], v176 offset:49152
    v_fma_f32 v135, v111, v173, v135
    v_mfma_f32_16x16x32_bf16 v[68:71], v[164:167], v[236:239], v[68:71]
    v_fma_f32 v40, v112, v169, v136
    v_mfma_f32_16x16x32_bf16 v[92:95], v[164:167], v[240:243], v[92:95]
    ds_read_b128 v[164:167], v176 offset:50176
    s_waitcnt vmcnt(5) lgkmcnt(4)
    v_mfma_f32_16x16x32_bf16 v[48:51], v[144:147], v[244:247], v[48:51]
    s_cmpk_ge_i32 s44, 378
    s_cbranch_scc0 .Lcf68
.Lcr69:
    v_mfma_f32_16x16x32_bf16 v[72:75], v[144:147], v[248:251], v[72:75]
    ds_read_b128 v[144:147], v176 offset:51200
    v_fma_f32 v136, v112, v173, v136
    v_mfma_f32_16x16x32_bf16 v[52:55], v[148:151], v[244:247], v[52:55]
    v_fma_f32 v41, v113, v169, v137
    v_mfma_f32_16x16x32_bf16 v[76:79], v[148:151], v[248:251], v[76:79]
    ds_read_b128 v[148:151], v176 offset:52224
    s_waitcnt lgkmcnt(4)
    v_mfma_f32_16x16x32_bf16 v[56:59], v[152:155], v[244:247], v[56:59]
    v_readfirstlane_b32 s94, v10
    v_mfma_f32_16x16x32_bf16 v[80:83], v[152:155], v[248:251], v[80:83]
    ds_read_b128 v[152:155], v176 offset:53248
    v_fma_f32 v137, v113, v173, v137
    v_mfma_f32_16x16x32_bf16 v[60:63], v[156:159], v[244:247], v[60:63]
    s_sub_u32 s44, s94, s43
    v_fma_f32 v42, v114, v169, v138
    v_mfma_f32_16x16x32_bf16 v[84:87], v[156:159], v[248:251], v[84:87]
    ds_read_b128 v[156:159], v176 offset:54272
    s_waitcnt lgkmcnt(4)
    v_mfma_f32_16x16x32_bf16 v[64:67], v[160:163], v[244:247], v[64:67]
    v_fma_f32 v138, v114, v173, v138
    v_mfma_f32_16x16x32_bf16 v[88:91], v[160:163], v[248:251], v[88:91]
    ds_read_b128 v[160:163], v176 offset:55296
    v_fma_f32 v43, v115, v169, v139
    v_mfma_f32_16x16x32_bf16 v[68:71], v[164:167], v[244:247], v[68:71]
    v_fma_f32 v139, v115, v173, v139
    v_mfma_f32_16x16x32_bf16 v[92:95], v[164:167], v[248:251], v[92:95]
    ds_read_b128 v[164:167], v176 offset:56320
    s_waitcnt vmcnt(3) lgkmcnt(4)
    v_mfma_f32_16x16x32_bf16 v[48:51], v[144:147], v[180:183], v[48:51]
    v_fma_f32 v44, v116, v169, v140
    v_mfma_f32_16x16x32_bf16 v[72:75], v[144:147], v[184:187], v[72:75]
    ds_read_b128 v[144:147], v176 offset:57344
    v_fma_f32 v140, v116, v173, v140
    v_mfma_f32_16x16x32_bf16 v[52:55], v[148:151], v[180:183], v[52:55]
    v_fma_f32 v45, v117, v169, v141
    v_mfma_f32_16x16x32_bf16 v[76:79], v[148:151], v[184:187], v[76:79]
    ds_read_b128 v[148:151], v176 offset:58368
    s_waitcnt lgkmcnt(4)
    v_mfma_f32_16x16x32_bf16 v[56:59], v[152:155], v[180:183], v[56:59]
    v_fma_f32 v141, v117, v173, v141
    v_mfma_f32_16x16x32_bf16 v[80:83], v[152:155], v[184:187], v[80:83]
    ds_read_b128 v[152:155], v176 offset:59392
    v_fma_f32 v46, v118, v169, v142
    v_mfma_f32_16x16x32_bf16 v[60:63], v[156:159], v[180:183], v[60:63]
    v_fma_f32 v142, v118, v173, v142
    v_mfma_f32_16x16x32_bf16 v[84:87], v[156:159], v[184:187], v[84:87]
    ds_read_b128 v[156:159], v176 offset:60416
    s_waitcnt lgkmcnt(4)
    v_mfma_f32_16x16x32_bf16 v[64:67], v[160:163], v[180:183], v[64:67]
    v_add_u32 v9, 384, v8
    v_mfma_f32_16x16x32_bf16 v[88:91], v[160:163], v[184:187], v[88:91]
    ds_read_b128 v[160:163], v176 offset:61440
    v_fma_f32 v47, v119, v169, v143
    v_mfma_f32_16x16x32_bf16 v[68:71], v[164:167], v[180:183], v[68:71]
    v_fma_f32 v143, v119, v173, v143
    v_mfma_f32_16x16x32_bf16 v[92:95], v[164:167], v[184:187], v[92:95]
    ds_read_b128 v[164:167], v176 offset:62464
    s_waitcnt vmcnt(1) lgkmcnt(4)
    v_mfma_f32_16x16x32_bf16 v[48:51], v[144:147], v[188:191], v[48:51]
    ds_write_b32 v5, v9
    v_mfma_f32_16x16x32_bf16 v[72:75], v[144:147], v[192:195], v[72:75]
    v_mfma_f32_16x16x32_bf16 v[52:55], v[148:151], v[188:191], v[52:55]
    v_mfma_f32_16x16x32_bf16 v[76:79], v[148:151], v[192:195], v[76:79]
    s_waitcnt lgkmcnt(3)
    v_mfma_f32_16x16x32_bf16 v[56:59], v[152:155], v[188:191], v[56:59]
    v_mfma_f32_16x16x32_bf16 v[80:83], v[152:155], v[192:195], v[80:83]
    v_mfma_f32_16x16x32_bf16 v[60:63], v[156:159], v[188:191], v[60:63]
    v_mfma_f32_16x16x32_bf16 v[84:87], v[156:159], v[192:195], v[84:87]
    s_waitcnt lgkmcnt(1)
    v_mfma_f32_16x16x32_bf16 v[64:67], v[160:163], v[188:191], v[64:67]
    v_mfma_f32_16x16x32_bf16 v[88:91], v[160:163], v[192:195], v[88:91]
    v_mfma_f32_16x16x32_bf16 v[68:71], v[164:167], v[188:191], v[68:71]
    v_mfma_f32_16x16x32_bf16 v[92:95], v[164:167], v[192:195], v[92:95]
    v_pk_fma_f32 v[48:49], v[48:49], v[168:169], v[24:25] op_sel_hi:[1,0,1]
    v_pk_fma_f32 v[50:51], v[50:51], v[168:169], v[26:27] op_sel_hi:[1,0,1]
    v_max_f32 v48, 0, v48
    v_max_f32 v49, 0, v49
    v_max_f32 v50, 0, v50
    v_max_f32 v51, 0, v51
    v_pk_mul_f32 v[48:49], v[48:49], v[48:49]
    v_pk_mul_f32 v[50:51], v[50:51], v[50:51]
    v_cvt_pk_bf16_f32 v144, v48, v49
    v_cvt_pk_bf16_f32 v145, v50, v51
    v_pk_fma_f32 v[52:53], v[52:53], v[168:169], v[28:29] op_sel_hi:[1,0,1]
    v_pk_fma_f32 v[54:55], v[54:55], v[168:169], v[30:31] op_sel_hi:[1,0,1]
    v_max_f32 v52, 0, v52
    v_max_f32 v53, 0, v53
    v_max_f32 v54, 0, v54
    v_max_f32 v55, 0, v55
    v_pk_mul_f32 v[52:53], v[52:53], v[52:53]
    v_pk_mul_f32 v[54:55], v[54:55], v[54:55]
    v_cvt_pk_bf16_f32 v146, v52, v53
    v_cvt_pk_bf16_f32 v147, v54, v55
    s_cmp_eq_u32 s43, 0
    s_cbranch_scc1 .Ls70
    buffer_store_dwordx4 v[144:147], v4, s[4:7], s68 offen offset:0
.Ls71:
    v_pk_fma_f32 v[56:57], v[56:57], v[168:169], v[32:33] op_sel_hi:[1,0,1]
    v_pk_fma_f32 v[58:59], v[58:59], v[168:169], v[34:35] op_sel_hi:[1,0,1]
    v_max_f32 v56, 0, v56
    v_max_f32 v57, 0, v57
    v_max_f32 v58, 0, v58
    v_max_f32 v59, 0, v59
    v_pk_mul_f32 v[56:57], v[56:57], v[56:57]
    v_pk_mul_f32 v[58:59], v[58:59], v[58:59]
    v_cvt_pk_bf16_f32 v148, v56, v57
    v_cvt_pk_bf16_f32 v149, v58, v59
    v_pk_fma_f32 v[60:61], v[60:61], v[168:169], v[36:37] op_sel_hi:[1,0,1]
    v_pk_fma_f32 v[62:63], v[62:63], v[168:169], v[38:39] op_sel_hi:[1,0,1]
    v_max_f32 v60, 0, v60
    v_max_f32 v61, 0, v61
    v_max_f32 v62, 0, v62
    v_max_f32 v63, 0, v63
    v_pk_mul_f32 v[60:61], v[60:61], v[60:61]
    v_pk_mul_f32 v[62:63], v[62:63], v[62:63]
    v_cvt_pk_bf16_f32 v150, v60, v61
    v_cvt_pk_bf16_f32 v151, v62, v63
    s_cmp_eq_u32 s43, 0
    s_cbranch_scc1 .Ls72
    buffer_store_dwordx4 v[148:151], v4, s[4:7], s68 offen offset:1024
.Ls73:
    v_pk_fma_f32 v[64:65], v[64:65], v[168:169], v[40:41] op_sel_hi:[1,0,1]
    v_pk_fma_f32 v[66:67], v[66:67], v[168:169], v[42:43] op_sel_hi:[1,0,1]
    v_max_f32 v64, 0, v64
    v_max_f32 v65, 0, v65
    v_max_f32 v66, 0, v66
    v_max_f32 v67, 0, v67
    v_pk_mul_f32 v[64:65], v[64:65], v[64:65]
    v_pk_mul_f32 v[66:67], v[66:67], v[66:67]
    v_cvt_pk_bf16_f32 v152, v64, v65
    v_cvt_pk_bf16_f32 v153, v66, v67
    v_pk_fma_f32 v[68:69], v[68:69], v[168:169], v[44:45] op_sel_hi:[1,0,1]
    v_pk_fma_f32 v[70:71], v[70:71], v[168:169], v[46:47] op_sel_hi:[1,0,1]
    v_max_f32 v68, 0, v68
    v_max_f32 v69, 0, v69
    v_max_f32 v70, 0, v70
    v_max_f32 v71, 0, v71
    v_pk_mul_f32 v[68:69], v[68:69], v[68:69]
    v_pk_mul_f32 v[70:71], v[70:71], v[70:71]
    v_cvt_pk_bf16_f32 v154, v68, v69
    v_cvt_pk_bf16_f32 v155, v70, v71
    s_cmp_eq_u32 s43, 0
    s_cbranch_scc1 .Ls74
    buffer_store_dwordx4 v[152:155], v4, s[4:7], s68 offen offset:2048
.Ls75:
    v_pk_fma_f32 v[72:73], v[72:73], v[172:173], v[120:121] op_sel_hi:[1,0,1]
    v_pk_fma_f32 v[74:75], v[74:75], v[172:173], v[122:123] op_sel_hi:[1,0,1]
    v_max_f32 v72, 0, v72
    v_max_f32 v73, 0, v73
    v_max_f32 v74, 0, v74
    v_max_f32 v75, 0, v75
    v_pk_mul_f32 v[72:73], v[72:73], v[72:73]
    v_pk_mul_f32 v[74:75], v[74:75], v[74:75]
    v_cvt_pk_bf16_f32 v156, v72, v73
    v_cvt_pk_bf16_f32 v157, v74, v75
    v_pk_fma_f32 v[76:77], v[76:77], v[172:173], v[124:125] op_sel_hi:[1,0,1]
    v_pk_fma_f32 v[78:79], v[78:79], v[172:173], v[126:127] op_sel_hi:[1,0,1]
    v_max_f32 v76, 0, v76
    v_max_f32 v77, 0, v77
    v_max_f32 v78, 0, v78
    v_max_f32 v79, 0, v79
    v_pk_mul_f32 v[76:77], v[76:77], v[76:77]
    v_pk_mul_f32 v[78:79], v[78:79], v[78:79]
    v_cvt_pk_bf16_f32 v158, v76, v77
    v_cvt_pk_bf16_f32 v159, v78, v79
    s_cmp_eq_u32 s43, 0
    s_cbranch_scc1 .Ls76
    buffer_store_dwordx4 v[156:159], v4, s[4:7], s69 offen offset:0
.Ls77:
    v_pk_fma_f32 v[80:81], v[80:81], v[172:173], v[128:129] op_sel_hi:[1,0,1]
    v_pk_fma_f32 v[82:83], v[82:83], v[172:173], v[130:131] op_sel_hi:[1,0,1]
    v_max_f32 v80, 0, v80
    v_max_f32 v81, 0, v81
    v_max_f32 v82, 0, v82
    v_max_f32 v83, 0, v83
    v_pk_mul_f32 v[80:81], v[80:81], v[80:81]
    v_pk_mul_f32 v[82:83], v[82:83], v[82:83]
    v_cvt_pk_bf16_f32 v160, v80, v81
    v_cvt_pk_bf16_f32 v161, v82, v83
    v_pk_fma_f32 v[84:85], v[84:85], v[172:173], v[132:133] op_sel_hi:[1,0,1]
    v_pk_fma_f32 v[86:87], v[86:87], v[172:173], v[134:135] op_sel_hi:[1,0,1]
    v_max_f32 v84, 0, v84
    v_max_f32 v85, 0, v85
    v_max_f32 v86, 0, v86
    v_max_f32 v87, 0, v87
    v_pk_mul_f32 v[84:85], v[84:85], v[84:85]
    v_pk_mul_f32 v[86:87], v[86:87], v[86:87]
    v_cvt_pk_bf16_f32 v162, v84, v85
    v_cvt_pk_bf16_f32 v163, v86, v87
    s_cmp_eq_u32 s43, 0
    s_cbranch_scc1 .Ls78
    buffer_store_dwordx4 v[160:163], v4, s[4:7], s69 offen offset:1024
.Ls79:
    v_pk_fma_f32 v[88:89], v[88:89], v[172:173], v[136:137] op_sel_hi:[1,0,1]
    v_pk_fma_f32 v[90:91], v[90:91], v[172:173], v[138:139] op_sel_hi:[1,0,1]
    v_max_f32 v88, 0, v88
    v_max_f32 v89, 0, v89
    v_max_f32 v90, 0, v90
    v_max_f32 v91, 0, v91
    v_pk_mul_f32 v[88:89], v[88:89], v[88:89]
    v_pk_mul_f32 v[90:91], v[90:91], v[90:91]
    v_cvt_pk_bf16_f32 v164, v88, v89
    v_cvt_pk_bf16_f32 v165, v90, v91
    v_pk_fma_f32 v[92:93], v[92:93], v[172:173], v[140:141] op_sel_hi:[1,0,1]
    v_pk_fma_f32 v[94:95], v[94:95], v[172:173], v[142:143] op_sel_hi:[1,0,1]
    v_max_f32 v92, 0, v92
    v_max_f32 v93, 0, v93
    v_max_f32 v94, 0, v94
    v_max_f32 v95, 0, v95
    v_pk_mul_f32 v[92:93], v[92:93], v[92:93]
    v_pk_mul_f32 v[94:95], v[94:95], v[94:95]
    v_cvt_pk_bf16_f32 v166, v92, v93
    v_cvt_pk_bf16_f32 v167, v94, v95
    s_cmp_eq_u32 s43, 0
    s_cbranch_scc1 .Ls80
    buffer_store_dwordx4 v[164:167], v4, s[4:7], s69 offen offset:2048
.Ls81:
    s_mul_i32 s84, s38, 98304
    s_mul_i32 s85, s61, 24576
    s_add_u32 s84, s84, s85
    s_add_u32 s84, s84, s42
    s_add_u32 s84, s84, 0x50000
    s_lshl_b32 s85, s38, 3
    s_add_u32 s85, s85, s61
    s_lshl_b32 s85, s85, 5
    s_add_u32 s85, s85, s42
    s_add_u32 s85, s85, 0xb0c00
    v_add_u32 v108, 69632, v4
    s_mul_i32 s81, s61, 49152
    v_add_u32 v110, s81, v4
    s_sub_u32 s81, 49152, s81
    v_add_u32 v111, s81, v4
    v_mov_b32 v109, v177
    v_lshlrev_b32 v24, 4, v3
    v_add_u32 v24, 163168, v24
    ds_read_b128 v[48:51], v24 offset:0
    ds_read_b128 v[52:55], v24 offset:64
    ds_read_b128 v[56:59], v24 offset:128
    ds_read_b128 v[60:63], v24 offset:192
    ds_read_b128 v[64:67], v24 offset:256
    v_lshlrev_b32 v28, 16, v12
    v_and_b32 v29, 0xffff0000, v12
    v_lshlrev_b32 v30, 16, v13
    v_and_b32 v31, 0xffff0000, v13
    v_lshlrev_b32 v32, 16, v14
    v_and_b32 v33, 0xffff0000, v14
    v_lshlrev_b32 v34, 16, v15
    v_and_b32 v35, 0xffff0000, v15
    v_lshlrev_b32 v36, 16, v16
    v_and_b32 v37, 0xffff0000, v16
    v_lshlrev_b32 v38, 16, v17
    v_and_b32 v39, 0xffff0000, v17
    v_lshlrev_b32 v40, 16, v18
    v_and_b32 v41, 0xffff0000, v18
    v_lshlrev_b32 v42, 16, v19
    v_and_b32 v43, 0xffff0000, v19
    v_lshlrev_b32 v44, 16, v20
    v_and_b32 v45, 0xffff0000, v20
    v_lshlrev_b32 v46, 16, v21
    v_and_b32 v47, 0xffff0000, v21
    s_waitcnt vmcnt(3)
    buffer_store_dword v7, v11, s[4:7], s76 offen offset:0
    s_waitcnt vmcnt(1)
    buffer_store_dword v7, v11, s[4:7], s76 offen offset:128
    s_waitcnt lgkmcnt(4)
    v_pk_add_f32 v[28:29], v[28:29], v[48:49]
    v_pk_add_f32 v[30:31], v[30:31], v[50:51]
    s_waitcnt lgkmcnt(3)
    v_pk_add_f32 v[32:33], v[32:33], v[52:53]
    v_pk_add_f32 v[34:35], v[34:35], v[54:55]
    s_waitcnt lgkmcnt(2)
    v_pk_add_f32 v[36:37], v[36:37], v[56:57]
    v_pk_add_f32 v[38:39], v[38:39], v[58:59]
    s_waitcnt lgkmcnt(1)
    v_pk_add_f32 v[40:41], v[40:41], v[60:61]
    v_pk_add_f32 v[42:43], v[42:43], v[62:63]
    s_waitcnt lgkmcnt(0)
    v_pk_add_f32 v[44:45], v[44:45], v[64:65]
    v_pk_add_f32 v[46:47], v[46:47], v[66:67]
    s_cmpk_ge_i32 s44, 414
    s_cbranch_scc0 .Lcf82
.Lcr83:
    ds_read_b128 v[68:71], v108 offset:0
    ds_read_b128 v[72:75], v108 offset:1024
    ds_read_b128 v[76:79], v108 offset:2048
    ds_read_b128 v[80:83], v108 offset:3072
    ds_read_b128 v[84:87], v108 offset:4096
    ds_read_b128 v[88:91], v108 offset:5120
    ds_read_b128 v[92:95], v108 offset:6144
    ds_read_b128 v[96:99], v108 offset:7168
    ds_read_b128 v[100:103], v108 offset:8192
    ds_read_b128 v[104:107], v108 offset:9216
    s_mov_b32 exec_lo, 0xffff
    s_mov_b32 exec_hi, 0x0
.Lp84:
    buffer_load_dword v9, v109, s[4:7], s85 offen sc1
    s_waitcnt vmcnt(0)
    v_cmp_ne_u32 vcc, s41, v9
    s_nop 0
    s_cbranch_vccz .Lpd85
    s_sub_u32 s88, s88, 1
    s_cbranch_scc1 .Lend
    s_branch .Lp84
.Lpd85:
    s_mov_b64 exec, -1
    buffer_load_dwordx4 v[112:115], v110, s[4:7], s84 offen offset:0 sc1
    buffer_load_dwordx4 v[116:119], v111, s[4:7], s84 offen offset:0 sc1
    buffer_load_dwordx4 v[120:123], v110, s[4:7], s84 offen offset:1024 sc1
    buffer_load_dwordx4 v[124:127], v111, s[4:7], s84 offen offset:1024 sc1
    buffer_load_dwordx4 v[128:131], v110, s[4:7], s84 offen offset:2048 sc1
    buffer_load_dwordx4 v[132:135], v111, s[4:7], s84 offen offset:2048 sc1
    buffer_load_dwordx4 v[136:139], v110, s[4:7], s84 offen offset:3072 sc1
    buffer_load_dwordx4 v[140:143], v111, s[4:7], s84 offen offset:3072 sc1
    s_add_u32 s84, s84, 4096
    s_waitcnt vmcnt(6) lgkmcnt(5)
    v_mfma_f32_16x16x32_bf16 v[28:31], v[68:71], v[112:115], v[28:31]
    buffer_load_dwordx4 v[144:147], v110, s[4:7], s84 offen offset:0 sc1
    v_mfma_f32_16x16x32_bf16 v[48:51], v[68:71], v[116:119], 0
    buffer_load_dwordx4 v[148:151], v111, s[4:7], s84 offen offset:0 sc1
    v_mfma_f32_16x16x32_bf16 v[32:35], v[72:75], v[112:115], v[32:35]
    ds_read_b32 v10, v6
    v_mfma_f32_16x16x32_bf16 v[52:55], v[72:75], v[116:119], 0
    ds_read_b128 v[68:71], v108 offset:10240
    v_mfma_f32_16x16x32_bf16 v[36:39], v[76:79], v[112:115], v[36:39]
    ds_read_b128 v[72:75], v108 offset:11264
    v_mfma_f32_16x16x32_bf16 v[56:59], v[76:79], v[116:119], 0
    ds_read_b128 v[76:79], v108 offset:12288
    v_mfma_f32_16x16x32_bf16 v[40:43], v[80:83], v[112:115], v[40:43]
    v_mfma_f32_16x16x32_bf16 v[60:63], v[80:83], v[116:119], 0
    ds_read_b128 v[80:83], v108 offset:13312
    v_mfma_f32_16x16x32_bf16 v[44:47], v[84:87], v[112:115], v[44:47]
    buffer_load_dwordx4 v[152:155], v110, s[4:7], s84 offen offset:1024 sc1
    v_mfma_f32_16x16x32_bf16 v[64:67], v[84:87], v[116:119], 0
    ds_read_b128 v[84:87], v108 offset:14336
    s_waitcnt vmcnt(7) lgkmcnt(6)
    v_mfma_f32_16x16x32_bf16 v[28:31], v[88:91], v[120:123], v[28:31]
    buffer_load_dwordx4 v[156:159], v111, s[4:7], s84 offen offset:1024 sc1
    v_mfma_f32_16x16x32_bf16 v[48:51], v[88:91], v[124:127], v[48:51]
    ds_read_b128 v[88:91], v108 offset:15360
    v_mfma_f32_16x16x32_bf16 v[32:35], v[92:95], v[120:123], v[32:35]
    v_mfma_f32_16x16x32_bf16 v[52:55], v[92:95], v[124:127], v[52:55]
    ds_read_b128 v[92:95], v108 offset:16384
    v_mfma_f32_16x16x32_bf16 v[36:39], v[96:99], v[120:123], v[36:39]
    v_mfma_f32_16x16x32_bf16 v[56:59], v[96:99], v[124:127], v[56:59]
    ds_read_b128 v[96:99], v108 offset:17408
    v_mfma_f32_16x16x32_bf16 v[40:43], v[100:103], v[120:123], v[40:43]
    buffer_load_dwordx4 v[160:163], v110, s[4:7], s84 offen offset:2048 sc1
    v_mfma_f32_16x16x32_bf16 v[60:63], v[100:103], v[124:127], v[60:63]
    buffer_load_dwordx4 v[164:167], v111, s[4:7], s84 offen offset:2048 sc1
    v_mfma_f32_16x16x32_bf16 v[44:47], v[104:107], v[120:123], v[44:47]
    ds_read_b128 v[100:103], v108 offset:18432
    v_mfma_f32_16x16x32_bf16 v[64:67], v[104:107], v[124:127], v[64:67]
    ds_read_b128 v[104:107], v108 offset:19456
    s_waitcnt vmcnt(8) lgkmcnt(5)
    v_mfma_f32_16x16x32_bf16 v[28:31], v[68:71], v[128:131], v[28:31]
    v_mfma_f32_16x16x32_bf16 v[48:51], v[68:71], v[132:135], v[48:51]
    ds_read_b128 v[68:71], v108 offset:20480
    v_readfirstlane_b32 s94, v10
    v_mfma_f32_16x16x32_bf16 v[32:35], v[72:75], v[128:131], v[32:35]
    v_mfma_f32_16x16x32_bf16 v[52:55], v[72:75], v[132:135], v[52:55]
    s_sub_u32 s44, s94, s43
    ds_read_b128 v[72:75], v108 offset:21504
    v_mfma_f32_16x16x32_bf16 v[36:39], v[76:79], v[128:131], v[36:39]
    buffer_load_dwordx4 v[168:171], v110, s[4:7], s84 offen offset:3072 sc1
    v_mfma_f32_16x16x32_bf16 v[56:59], v[76:79], v[132:135], v[56:59]
    buffer_load_dwordx4 v[172:175], v111, s[4:7], s84 offen offset:3072 sc1
    v_mfma_f32_16x16x32_bf16 v[40:43], v[80:83], v[128:131], v[40:43]
    s_add_u32 s84, s84, 4096
    ds_read_b128 v[76:79], v108 offset:22528
    v_mfma_f32_16x16x32_bf16 v[60:63], v[80:83], v[132:135], v[60:63]
    ds_read_b128 v[80:83], v108 offset:23552
    v_mfma_f32_16x16x32_bf16 v[44:47], v[84:87], v[128:131], v[44:47]
    v_mfma_f32_16x16x32_bf16 v[64:67], v[84:87], v[132:135], v[64:67]
    ds_read_b128 v[84:87], v108 offset:24576
    s_waitcnt vmcnt(8) lgkmcnt(5)
    v_mfma_f32_16x16x32_bf16 v[28:31], v[88:91], v[136:139], v[28:31]
    s_mul_i32 s68, s63, 20480
    s_add_u32 s68, s68, s42
    s_add_u32 s68, s68, 0x0
    v_mfma_f32_16x16x32_bf16 v[48:51], v[88:91], v[140:143], v[48:51]
    ds_read_b128 v[88:91], v108 offset:25600
    s_add_u32 s69, s68, s67
    v_mfma_f32_16x16x32_bf16 v[32:35], v[92:95], v[136:139], v[32:35]
    buffer_load_dwordx4 v[176:179], v110, s[4:7], s84 offen offset:0 sc1
    v_mfma_f32_16x16x32_bf16 v[52:55], v[92:95], v[140:143], v[52:55]
    buffer_load_dwordx4 v[180:183], v111, s[4:7], s84 offen offset:0 sc1
    v_mfma_f32_16x16x32_bf16 v[36:39], v[96:99], v[136:139], v[36:39]
    ds_read_b128 v[92:95], v108 offset:26624
    s_add_u32 s68, s68, s66
    v_mfma_f32_16x16x32_bf16 v[56:59], v[96:99], v[140:143], v[56:59]
    ds_read_b128 v[96:99], v108 offset:27648
    s_lshl_b32 s70, s63, 10
    v_mfma_f32_16x16x32_bf16 v[40:43], v[100:103], v[136:139], v[40:43]
    s_add_u32 s70, s70, s42
    s_add_u32 s70, s70, 0xb1000
    s_lshl_b32 s71, s63, 5
    v_mfma_f32_16x16x32_bf16 v[60:63], v[100:103], v[140:143], v[60:63]
    ds_read_b128 v[100:103], v108 offset:28672
    s_add_u32 s71, s71, s60
    v_mfma_f32_16x16x32_bf16 v[44:47], v[104:107], v[136:139], v[44:47]
    s_lshl_b32 s71, s71, 2
    s_add_u32 s71, s71, s42
    s_add_u32 s71, s71, 0xb0000
    v_mfma_f32_16x16x32_bf16 v[64:67], v[104:107], v[140:143], v[64:67]
    ds_read_b128 v[104:107], v108 offset:29696
    s_waitcnt vmcnt(8) lgkmcnt(5)
    v_mfma_f32_16x16x32_bf16 v[28:31], v[68:71], v[144:147], v[28:31]
    buffer_load_dwordx4 v[184:187], v110, s[4:7], s84 offen offset:1024 sc1
    v_mfma_f32_16x16x32_bf16 v[48:51], v[68:71], v[148:151], v[48:51]
    buffer_load_dwordx4 v[188:191], v111, s[4:7], s84 offen offset:1024 sc1
    v_mfma_f32_16x16x32_bf16 v[32:35], v[72:75], v[144:147], v[32:35]
    s_cmpk_ge_i32 s44, 444
    s_cbranch_scc0 .Lcf86
.Lcr87:
    v_mfma_f32_16x16x32_bf16 v[52:55], v[72:75], v[148:151], v[52:55]
    ds_read_b128 v[68:71], v108 offset:30720
    s_lshl_b32 s72, s40, 2
    v_mfma_f32_16x16x32_bf16 v[36:39], v[76:79], v[144:147], v[36:39]
    ds_read_b128 v[72:75], v108 offset:31744
    s_add_u32 s72, s72, s38
    v_mfma_f32_16x16x32_bf16 v[56:59], v[76:79], v[148:151], v[56:59]
    ds_read_b128 v[76:79], v108 offset:32768
    s_lshl_b32 s72, s72, 11
    v_mfma_f32_16x16x32_bf16 v[40:43], v[80:83], v[144:147], v[40:43]
    s_xor_b32 s73, s72, 65536
    s_add_u32 s76, s42, s89
    s_add_u32 s72, s72, s76
    v_mfma_f32_16x16x32_bf16 v[60:63], v[80:83], v[148:151], v[60:63]
    ds_read_b128 v[80:83], v108 offset:33792
    s_add_u32 s73, s73, s76
    v_mfma_f32_16x16x32_bf16 v[44:47], v[84:87], v[144:147], v[44:47]
    buffer_load_dwordx4 v[192:195], v110, s[4:7], s84 offen offset:2048 sc1
    v_mfma_f32_16x16x32_bf16 v[64:67], v[84:87], v[148:151], v[64:67]
    ds_read_b128 v[84:87], v108 offset:34816
    s_waitcnt vmcnt(9) lgkmcnt(5)
    v_mfma_f32_16x16x32_bf16 v[28:31], v[88:91], v[152:155], v[28:31]
    buffer_load_dwordx4 v[196:199], v111, s[4:7], s84 offen offset:2048 sc1
    v_mfma_f32_16x16x32_bf16 v[48:51], v[88:91], v[156:159], v[48:51]
    ds_read_b128 v[88:91], v108 offset:35840
    s_mul_i32 s76, s38, 40960
    v_mfma_f32_16x16x32_bf16 v[32:35], v[92:95], v[152:155], v[32:35]
    s_add_u32 s76, s76, s42
    s_add_u32 s76, s76, 0x28000
    s_lshl_b32 s74, s40, 11
    v_mfma_f32_16x16x32_bf16 v[52:55], v[92:95], v[156:159], v[52:55]
    ds_read_b128 v[92:95], v108 offset:36864
    s_xor_b32 s75, s74, 16384
    v_mfma_f32_16x16x32_bf16 v[36:39], v[96:99], v[152:155], v[36:39]
    s_add_u32 s74, s74, s76
    s_add_u32 s75, s75, s76
    v_xor_b32 v24, 0x5a5a5a5a, v7
    v_mfma_f32_16x16x32_bf16 v[56:59], v[96:99], v[156:159], v[56:59]
    ds_read_b128 v[96:99], v108 offset:37888
    v_lshlrev_b32 v25, 5, v1
    v_mfma_f32_16x16x32_bf16 v[40:43], v[100:103], v[152:155], v[40:43]
    buffer_load_dwordx4 v[200:203], v110, s[4:7], s84 offen offset:3072 sc1
    v_mfma_f32_16x16x32_bf16 v[60:63], v[100:103], v[156:159], v[60:63]
    buffer_load_dwordx4 v[204:207], v111, s[4:7], s84 offen offset:3072 sc1
    v_mfma_f32_16x16x32_bf16 v[44:47], v[104:107], v[152:155], v[44:47]
    s_add_u32 s84, s84, 4096
    ds_read_b128 v[100:103], v108 offset:38912
    v_mfma_f32_16x16x32_bf16 v[64:67], v[104:107], v[156:159], v[64:67]
    ds_read_b128 v[104:107], v108 offset:39936
    s_waitcnt vmcnt(10) lgkmcnt(5)
    v_mfma_f32_16x16x32_bf16 v[28:31], v[68:71], v[160:163], v[28:31]
    v_mfma_f32_16x16x32_bf16 v[48:51], v[68:71], v[164:167], v[48:51]
    ds_read_b128 v[68:71], v108 offset:40960
    v_mfma_f32_16x16x32_bf16 v[32:35], v[72:75], v[160:163], v[32:35]
    ds_read_b32 v10, v6
    v_mfma_f32_16x16x32_bf16 v[52:55], v[72:75], v[164:167], v[52:55]
    ds_read_b128 v[72:75], v108 offset:41984
    v_mfma_f32_16x16x32_bf16 v[36:39], v[76:79], v[160:163], v[36:39]
    buffer_load_dwordx4 v[208:211], v110, s[4:7], s84 offen offset:0 sc1
    v_mfma_f32_16x16x32_bf16 v[56:59], v[76:79], v[164:167], v[56:59]
    buffer_load_dwordx4 v[212:215], v111, s[4:7], s84 offen offset:0 sc1
    v_mfma_f32_16x16x32_bf16 v[40:43], v[80:83], v[160:163], v[40:43]
    ds_read_b128 v[76:79], v108 offset:43008
    v_mfma_f32_16x16x32_bf16 v[60:63], v[80:83], v[164:167], v[60:63]
    ds_read_b128 v[80:83], v108 offset:44032
    v_mfma_f32_16x16x32_bf16 v[44:47], v[84:87], v[160:163], v[44:47]
    v_mfma_f32_16x16x32_bf16 v[64:67], v[84:87], v[164:167], v[64:67]
    ds_read_b128 v[84:87], v108 offset:45056
    s_waitcnt vmcnt(10) lgkmcnt(6)
    v_mfma_f32_16x16x32_bf16 v[28:31], v[88:91], v[168:171], v[28:31]
    v_mfma_f32_16x16x32_bf16 v[48:51], v[88:91], v[172:175], v[48:51]
    ds_read_b128 v[88:91], v108 offset:46080
    v_mfma_f32_16x16x32_bf16 v[32:35], v[92:95], v[168:171], v[32:35]
    buffer_load_dwordx4 v[216:219], v110, s[4:7], s84 offen offset:1024 sc1
    v_mfma_f32_16x16x32_bf16 v[52:55], v[92:95], v[172:175], v[52:55]
    buffer_load_dwordx4 v[220:223], v111, s[4:7], s84 offen offset:1024 sc1
    v_mfma_f32_16x16x32_bf16 v[36:39], v[96:99], v[168:171], v[36:39]
    ds_read_b128 v[92:95], v108 offset:47104
    v_mfma_f32_16x16x32_bf16 v[56:59], v[96:99], v[172:175], v[56:59]
    ds_read_b128 v[96:99], v108 offset:48128
    v_mfma_f32_16x16x32_bf16 v[40:43], v[100:103], v[168:171], v[40:43]
    v_mfma_f32_16x16x32_bf16 v[60:63], v[100:103], v[172:175], v[60:63]
    ds_read_b128 v[100:103], v108 offset:49152
    v_mfma_f32_16x16x32_bf16 v[44:47], v[104:107], v[168:171], v[44:47]
    v_mfma_f32_16x16x32_bf16 v[64:67], v[104:107], v[172:175], v[64:67]
    ds_read_b128 v[104:107], v108 offset:50176
    s_waitcnt vmcnt(10) lgkmcnt(5)
    v_mfma_f32_16x16x32_bf16 v[28:31], v[68:71], v[176:179], v[28:31]
    buffer_load_dwordx4 v[224:227], v110, s[4:7], s84 offen offset:2048 sc1
    v_mfma_f32_16x16x32_bf16 v[48:51], v[68:71], v[180:183], v[48:51]
    buffer_load_dwordx4 v[228:231], v111, s[4:7], s84 offen offset:2048 sc1
    v_mfma_f32_16x16x32_bf16 v[32:35], v[72:75], v[176:179], v[32:35]
    ds_read_b128 v[68:71], v108 offset:51200
    v_readfirstlane_b32 s94, v10
    v_mfma_f32_16x16x32_bf16 v[52:55], v[72:75], v[180:183], v[52:55]
    ds_read_b128 v[72:75], v108 offset:52224
    v_mfma_f32_16x16x32_bf16 v[36:39], v[76:79], v[176:179], v[36:39]
    s_sub_u32 s44, s94, s43
    v_mfma_f32_16x16x32_bf16 v[56:59], v[76:79], v[180:183], v[56:59]
    ds_read_b128 v[76:79], v108 offset:53248
    v_mfma_f32_16x16x32_bf16 v[40:43], v[80:83], v[176:179], v[40:43]
    v_mfma_f32_16x16x32_bf16 v[60:63], v[80:83], v[180:183], v[60:63]
    ds_read_b128 v[80:83], v108 offset:54272
    v_mfma_f32_16x16x32_bf16 v[44:47], v[84:87], v[176:179], v[44:47]
    buffer_load_dwordx4 v[232:235], v110, s[4:7], s84 offen offset:3072 sc1
    v_mfma_f32_16x16x32_bf16 v[64:67], v[84:87], v[180:183], v[64:67]
    ds_read_b128 v[84:87], v108 offset:55296
    s_waitcnt vmcnt(11) lgkmcnt(5)
    v_mfma_f32_16x16x32_bf16 v[28:31], v[88:91], v[184:187], v[28:31]
    buffer_load_dwordx4 v[236:239], v111, s[4:7], s84 offen offset:3072 sc1
    v_mfma_f32_16x16x32_bf16 v[48:51], v[88:91], v[188:191], v[48:51]
    s_add_u32 s84, s84, 4096
    ds_read_b128 v[88:91], v108 offset:56320
    v_mfma_f32_16x16x32_bf16 v[32:35], v[92:95], v[184:187], v[32:35]
    v_mfma_f32_16x16x32_bf16 v[52:55], v[92:95], v[188:191], v[52:55]
    ds_read_b128 v[92:95], v108 offset:57344
    v_mfma_f32_16x16x32_bf16 v[36:39], v[96:99], v[184:187], v[36:39]
    v_mfma_f32_16x16x32_bf16 v[56:59], v[96:99], v[188:191], v[56:59]
    ds_read_b128 v[96:99], v108 offset:58368
    v_mfma_f32_16x16x32_bf16 v[40:43], v[100:103], v[184:187], v[40:43]
    buffer_load_dwordx4 v[112:115], v110, s[4:7], s84 offen offset:0 sc1
    v_mfma_f32_16x16x32_bf16 v[60:63], v[100:103], v[188:191], v[60:63]
    buffer_load_dwordx4 v[116:119], v111, s[4:7], s84 offen offset:0 sc1
    v_mfma_f32_16x16x32_bf16 v[44:47], v[104:107], v[184:187], v[44:47]
    ds_read_b128 v[100:103], v108 offset:59392
    v_mfma_f32_16x16x32_bf16 v[64:67], v[104:107], v[188:191], v[64:67]
    ds_read_b128 v[104:107], v108 offset:60416
    s_waitcnt vmcnt(12) lgkmcnt(5)
    v_mfma_f32_16x16x32_bf16 v[28:31], v[68:71], v[192:195], v[28:31]
    s_cmpk_ge_i32 s44, 474
    s_cbranch_scc0 .Lcf88
.Lcr89:
    v_mfma_f32_16x16x32_bf16 v[48:51], v[68:71], v[196:199], v[48:51]
    ds_read_b128 v[68:71], v108 offset:61440
    v_mfma_f32_16x16x32_bf16 v[32:35], v[72:75], v[192:195], v[32:35]
    v_mfma_f32_16x16x32_bf16 v[52:55], v[72:75], v[196:199], v[52:55]
    ds_read_b128 v[72:75], v108 offset:62464
    v_mfma_f32_16x16x32_bf16 v[36:39], v[76:79], v[192:195], v[36:39]
    buffer_load_dwordx4 v[120:123], v110, s[4:7], s84 offen offset:1024 sc1
    v_mfma_f32_16x16x32_bf16 v[56:59], v[76:79], v[196:199], v[56:59]
    buffer_load_dwordx4 v[124:127], v111, s[4:7], s84 offen offset:1024 sc1
    v_mfma_f32_16x16x32_bf16 v[40:43], v[80:83], v[192:195], v[40:43]
    ds_read_b128 v[76:79], v108 offset:63488
    v_mfma_f32_16x16x32_bf16 v[60:63], v[80:83], v[196:199], v[60:63]
    ds_read_b128 v[80:83], v108 offset:64512
    v_mfma_f32_16x16x32_bf16 v[44:47], v[84:87], v[192:195], v[44:47]
    v_mfma_f32_16x16x32_bf16 v[64:67], v[84:87], v[196:199], v[64:67]
    v_add_u32 v108, 135168, v4
    s_waitcnt vmcnt(12) lgkmcnt(4)
    v_mfma_f32_16x16x32_bf16 v[28:31], v[88:91], v[200:203], v[28:31]
    ds_read_b128 v[84:87], v108 offset:0
    v_mfma_f32_16x16x32_bf16 v[48:51], v[88:91], v[204:207], v[48:51]
    ds_read_b128 v[88:91], v108 offset:1024
    v_mfma_f32_16x16x32_bf16 v[32:35], v[92:95], v[200:203], v[32:35]
    buffer_load_dwordx4 v[128:131], v110, s[4:7], s84 offen offset:2048 sc1
    v_mfma_f32_16x16x32_bf16 v[52:55], v[92:95], v[204:207], v[52:55]
    buffer_load_dwordx4 v[132:135], v111, s[4:7], s84 offen offset:2048 sc1
    v_mfma_f32_16x16x32_bf16 v[36:39], v[96:99], v[200:203], v[36:39]
    ds_read_b128 v[92:95], v108 offset:2048
    v_mfma_f32_16x16x32_bf16 v[56:59], v[96:99], v[204:207], v[56:59]
    ds_read_b128 v[96:99], v108 offset:3072
    v_mfma_f32_16x16x32_bf16 v[40:43], v[100:103], v[200:203], v[40:43]
    v_mfma_f32_16x16x32_bf16 v[60:63], v[100:103], v[204:207], v[60:63]
    ds_read_b128 v[100:103], v108 offset:4096
    v_mfma_f32_16x16x32_bf16 v[44:47], v[104:107], v[200:203], v[44:47]
    v_mfma_f32_16x16x32_bf16 v[64:67], v[104:107], v[204:207], v[64:67]
    ds_read_b128 v[104:107], v108 offset:5120
    s_waitcnt vmcnt(12) lgkmcnt(5)
    v_mfma_f32_16x16x32_bf16 v[28:31], v[68:71], v[208:211], v[28:31]
    buffer_load_dwordx4 v[136:139], v110, s[4:7], s84 offen offset:3072 sc1
    v_mfma_f32_16x16x32_bf16 v[48:51], v[68:71], v[212:215], v[48:51]
    buffer_load_dwordx4 v[140:143], v111, s[4:7], s84 offen offset:3072 sc1
    v_mfma_f32_16x16x32_bf16 v[32:35], v[72:75], v[208:211], v[32:35]
    s_add_u32 s84, s84, 4096
    ds_read_b32 v10, v6
    v_mfma_f32_16x16x32_bf16 v[52:55], v[72:75], v[212:215], v[52:55]
    ds_read_b128 v[68:71], v108 offset:6144
    v_mfma_f32_16x16x32_bf16 v[36:39], v[76:79], v[208:211], v[36:39]
    ds_read_b128 v[72:75], v108 offset:7168
    v_mfma_f32_16x16x32_bf16 v[56:59], v[76:79], v[212:215], v[56:59]
    ds_read_b128 v[76:79], v108 offset:8192
    v_mfma_f32_16x16x32_bf16 v[40:43], v[80:83], v[208:211], v[40:43]
    v_mfma_f32_16x16x32_bf16 v[60:63], v[80:83], v[212:215], v[60:63]
    ds_read_b128 v[80:83], v108 offset:9216
    v_mfma_f32_16x16x32_bf16 v[44:47], v[84:87], v[208:211], v[44:47]
    buffer_load_dwordx4 v[144:147], v110, s[4:7], s84 offen offset:0 sc1
    v_mfma_f32_16x16x32_bf16 v[64:67], v[84:87], v[212:215], v[64:67]
    ds_read_b128 v[84:87], v108 offset:10240
    s_waitcnt vmcnt(13) lgkmcnt(6)
    v_mfma_f32_16x16x32_bf16 v[28:31], v[88:91], v[216:219], v[28:31]
    buffer_load_dwordx4 v[148:151], v111, s[4:7], s84 offen offset:0 sc1
    v_mfma_f32_16x16x32_bf16 v[48:51], v[88:91], v[220:223], v[48:51]
    ds_read_b128 v[88:91], v108 offset:11264
    v_mfma_f32_16x16x32_bf16 v[32:35], v[92:95], v[216:219], v[32:35]
    v_mfma_f32_16x16x32_bf16 v[52:55], v[92:95], v[220:223], v[52:55]
    ds_read_b128 v[92:95], v108 offset:12288
    v_mfma_f32_16x16x32_bf16 v[36:39], v[96:99], v[216:219], v[36:39]
    v_mfma_f32_16x16x32_bf16 v[56:59], v[96:99], v[220:223], v[56:59]
    ds_read_b128 v[96:99], v108 offset:13312
    v_mfma_f32_16x16x32_bf16 v[40:43], v[100:103], v[216:219], v[40:43]
    buffer_load_dwordx4 v[152:155], v110, s[4:7], s84 offen offset:1024 sc1
    v_mfma_f32_16x16x32_bf16 v[60:63], v[100:103], v[220:223], v[60:63]
    buffer_load_dwordx4 v[156:159], v111, s[4:7], s84 offen offset:1024 sc1
    v_mfma_f32_16x16x32_bf16 v[44:47], v[104:107], v[216:219], v[44:47]
    ds_read_b128 v[100:103], v108 offset:14336
    v_mfma_f32_16x16x32_bf16 v[64:67], v[104:107], v[220:223], v[64:67]
    ds_read_b128 v[104:107], v108 offset:15360
    s_waitcnt vmcnt(14) lgkmcnt(5)
    v_mfma_f32_16x16x32_bf16 v[28:31], v[68:71], v[224:227], v[28:31]
    v_mfma_f32_16x16x32_bf16 v[48:51], v[68:71], v[228:231], v[48:51]
    ds_read_b128 v[68:71], v108 offset:16384
    v_readfirstlane_b32 s94, v10
    v_mfma_f32_16x16x32_bf16 v[32:35], v[72:75], v[224:227], v[32:35]
    v_mfma_f32_16x16x32_bf16 v[52:55], v[72:75], v[228:231], v[52:55]
    s_sub_u32 s44, s94, s43
    ds_read_b128 v[72:75], v108 offset:17408
    v_mfma_f32_16x16x32_bf16 v[36:39], v[76:79], v[224:227], v[36:39]
    buffer_load_dwordx4 v[160:163], v110, s[4:7], s84 offen offset:2048 sc1
    v_mfma_f32_16x16x32_bf16 v[56:59], v[76:79], v[228:231], v[56:59]
    buffer_load_dwordx4 v[164:167], v111, s[4:7], s84 offen offset:2048 sc1
    v_mfma_f32_16x16x32_bf16 v[40:43], v[80:83], v[224:227], v[40:43]
    ds_read_b128 v[76:79], v108 offset:18432
    v_mfma_f32_16x16x32_bf16 v[60:63], v[80:83], v[228:231], v[60:63]
    ds_read_b128 v[80:83], v108 offset:19456
    v_mfma_f32_16x16x32_bf16 v[44:47], v[84:87], v[224:227], v[44:47]
    v_mfma_f32_16x16x32_bf16 v[64:67], v[84:87], v[228:231], v[64:67]
    ds_read_b128 v[84:87], v108 offset:20480
    s_waitcnt vmcnt(14) lgkmcnt(5)
    v_mfma_f32_16x16x32_bf16 v[28:31], v[88:91], v[232:235], v[28:31]
    buffer_load_dword v26, v25, s[4:7], s72 offen sc1
    v_mfma_f32_16x16x32_bf16 v[48:51], v[88:91], v[236:239], v[48:51]
    ds_read_b128 v[88:91], v108 offset:21504
    v_mfma_f32_16x16x32_bf16 v[32:35], v[92:95], v[232:235], v[32:35]
    buffer_load_dwordx4 v[168:171], v110, s[4:7], s84 offen offset:3072 sc1
    v_mfma_f32_16x16x32_bf16 v[52:55], v[92:95], v[236:239], v[52:55]
    buffer_load_dwordx4 v[172:175], v111, s[4:7], s84 offen offset:3072 sc1
    v_mfma_f32_16x16x32_bf16 v[36:39], v[96:99], v[232:235], v[36:39]
    ds_read_b128 v[92:95], v108 offset:22528
    v_mfma_f32_16x16x32_bf16 v[56:59], v[96:99], v[236:239], v[56:59]
    ds_read_b128 v[96:99], v108 offset:23552
    v_mfma_f32_16x16x32_bf16 v[40:43], v[100:103], v[232:235], v[40:43]
    buffer_load_dword v27, v25, s[4:7], s74 offen sc1
    v_mfma_f32_16x16x32_bf16 v[60:63], v[100:103], v[236:239], v[60:63]
    ds_read_b128 v[100:103], v108 offset:24576
    v_mfma_f32_16x16x32_bf16 v[44:47], v[104:107], v[232:235], v[44:47]
    v_mfma_f32_16x16x32_bf16 v[64:67], v[104:107], v[236:239], v[64:67]
    ds_read_b128 v[104:107], v108 offset:25600
    s_waitcnt vmcnt(16) lgkmcnt(5)
    v_mfma_f32_16x16x32_bf16 v[28:31], v[68:71], v[112:115], v[28:31]
    s_cmpk_ge_i32 s44, 504
    s_cbranch_scc0 .Lcf90
.Lcr91:
    v_mfma_f32_16x16x32_bf16 v[48:51], v[68:71], v[116:119], v[48:51]
    v_add_u32 v108, 0, v4
    v_mfma_f32_16x16x32_bf16 v[32:35], v[72:75], v[112:115], v[32:35]
    ds_read_b128 v[68:71], v108 offset:0
    v_mfma_f32_16x16x32_bf16 v[52:55], v[72:75], v[116:119], v[52:55]
    ds_read_b128 v[72:75], v108 offset:1024
    v_mfma_f32_16x16x32_bf16 v[36:39], v[76:79], v[112:115], v[36:39]
    v_mfma_f32_16x16x32_bf16 v[56:59], v[76:79], v[116:119], v[56:59]
    ds_read_b128 v[76:79], v108 offset:2048
    v_mfma_f32_16x16x32_bf16 v[40:43], v[80:83], v[112:115], v[40:43]
    v_mfma_f32_16x16x32_bf16 v[60:63], v[80:83], v[116:119], v[60:63]
    ds_read_b128 v[80:83], v108 offset:3072
    v_mfma_f32_16x16x32_bf16 v[44:47], v[84:87], v[112:115], v[44:47]
    v_mfma_f32_16x16x32_bf16 v[64:67], v[84:87], v[116:119], v[64:67]
    ds_read_b128 v[84:87], v108 offset:4096
    s_waitcnt vmcnt(14) lgkmcnt(5)
    v_mfma_f32_16x16x32_bf16 v[28:31], v[88:91], v[120:123], v[28:31]
    v_mfma_f32_16x16x32_bf16 v[48:51], v[88:91], v[124:127], v[48:51]
    ds_read_b128 v[88:91], v108 offset:5120
    v_mfma_f32_16x16x32_bf16 v[32:35], v[92:95], v[120:123], v[32:35]
    v_mfma_f32_16x16x32_bf16 v[52:55], v[92:95], v[124:127], v[52:55]
    ds_read_b128 v[92:95], v108 offset:6144
    v_mfma_f32_16x16x32_bf16 v[36:39], v[96:99], v[120:123], v[36:39]
    v_mfma_f32_16x16x32_bf16 v[56:59], v[96:99], v[124:127], v[56:59]
    ds_read_b128 v[96:99], v108 offset:7168
    v_mfma_f32_16x16x32_bf16 v[40:43], v[100:103], v[120:123], v[40:43]
    v_mfma_f32_16x16x32_bf16 v[60:63], v[100:103], v[124:127], v[60:63]
    ds_read_b128 v[100:103], v108 offset:8192
    v_mfma_f32_16x16x32_bf16 v[44:47], v[104:107], v[120:123], v[44:47]
    v_mfma_f32_16x16x32_bf16 v[64:67], v[104:107], v[124:127], v[64:67]
    ds_read_b128 v[104:107], v108 offset:9216
    s_waitcnt vmcnt(12) lgkmcnt(5)
    v_mfma_f32_16x16x32_bf16 v[28:31], v[68:71], v[128:131], v[28:31]
    v_mfma_f32_16x16x32_bf16 v[48:51], v[68:71], v[132:135], v[48:51]
    ds_read_b128 v[68:71], v108 offset:10240
    v_mfma_f32_16x16x32_bf16 v[32:35], v[72:75], v[128:131], v[32:35]
    ds_read_b32 v10, v6
    v_mfma_f32_16x16x32_bf16 v[52:55], v[72:75], v[132:135], v[52:55]
    ds_read_b128 v[72:75], v108 offset:11264
    v_mfma_f32_16x16x32_bf16 v[36:39], v[76:79], v[128:131], v[36:39]
    v_mfma_f32_16x16x32_bf16 v[56:59], v[76:79], v[132:135], v[56:59]
    ds_read_b128 v[76:79], v108 offset:12288
    v_mfma_f32_16x16x32_bf16 v[40:43], v[80:83], v[128:131], v[40:43]
    v_mfma_f32_16x16x32_bf16 v[60:63], v[80:83], v[132:135], v[60:63]
    ds_read_b128 v[80:83], v108 offset:13312
    v_mfma_f32_16x16x32_bf16 v[44:47], v[84:87], v[128:131], v[44:47]
    v_mfma_f32_16x16x32_bf16 v[64:67], v[84:87], v[132:135], v[64:67]
    ds_read_b128 v[84:87], v108 offset:14336
    s_waitcnt vmcnt(10) lgkmcnt(6)
    v_mfma_f32_16x16x32_bf16 v[28:31], v[88:91], v[136:139], v[28:31]
    v_mfma_f32_16x16x32_bf16 v[48:51], v[88:91], v[140:143], v[48:51]
    ds_read_b128 v[88:91], v108 offset:15360
    v_mfma_f32_16x16x32_bf16 v[32:35], v[92:95], v[136:139], v[32:35]
    v_mfma_f32_16x16x32_bf16 v[52:55], v[92:95], v[140:143], v[52:55]
    ds_read_b128 v[92:95], v108 offset:16384
    v_mfma_f32_16x16x32_bf16 v[36:39], v[96:99], v[136:139], v[36:39]
    v_mfma_f32_16x16x32_bf16 v[56:59], v[96:99], v[140:143], v[56:59]
    ds_read_b128 v[96:99], v108 offset:17408
    v_mfma_f32_16x16x32_bf16 v[40:43], v[100:103], v[136:139], v[40:43]
    v_mfma_f32_16x16x32_bf16 v[60:63], v[100:103], v[140:143], v[60:63]
    ds_read_b128 v[100:103], v108 offset:18432
    v_mfma_f32_16x16x32_bf16 v[44:47], v[104:107], v[136:139], v[44:47]
    v_mfma_f32_16x16x32_bf16 v[64:67], v[104:107], v[140:143], v[64:67]
    ds_read_b128 v[104:107], v108 offset:19456
    s_waitcnt vmcnt(8) lgkmcnt(5)
    v_mfma_f32_16x16x32_bf16 v[28:31], v[68:71], v[144:147], v[28:31]
    v_mov_b32 v115, v24
    v_mfma_f32_16x16x32_bf16 v[48:51], v[68:71], v[148:151], v[48:51]
    ds_read_b128 v[68:71], v108 offset:20480
    v_readfirstlane_b32 s94, v10
    v_mfma_f32_16x16x32_bf16 v[32:35], v[72:75], v[144:147], v[32:35]
    v_mov_b32 v119, v24
    v_mfma_f32_16x16x32_bf16 v[52:55], v[72:75], v[148:151], v[52:55]
    ds_read_b128 v[72:75], v108 offset:21504
    s_sub_u32 s44, s94, s43
    v_mfma_f32_16x16x32_bf16 v[36:39], v[76:79], v[144:147], v[36:39]
    v_mov_b32 v123, v24
    v_mfma_f32_16x16x32_bf16 v[56:59], v[76:79], v[148:151], v[56:59]
    ds_read_b128 v[76:79], v108 offset:22528
    v_mov_b32 v127, v24
    v_mfma_f32_16x16x32_bf16 v[40:43], v[80:83], v[144:147], v[40:43]
    v_mfma_f32_16x16x32_bf16 v[60:63], v[80:83], v[148:151], v[60:63]
    ds_read_b128 v[80:83], v108 offset:23552
    v_mfma_f32_16x16x32_bf16 v[44:47], v[84:87], v[144:147], v[44:47]
    v_mfma_f32_16x16x32_bf16 v[64:67], v[84:87], v[148:151], v[64:67]
    ds_read_b128 v[84:87], v108 offset:24576
    s_waitcnt vmcnt(6) lgkmcnt(5)
    v_mfma_f32_16x16x32_bf16 v[28:31], v[88:91], v[152:155], v[28:31]
    v_mfma_f32_16x16x32_bf16 v[48:51], v[88:91], v[156:159], v[48:51]
    ds_read_b128 v[88:91], v108 offset:25600
    v_mfma_f32_16x16x32_bf16 v[32:35], v[92:95], v[152:155], v[32:35]
    v_mfma_f32_16x16x32_bf16 v[52:55], v[92:95], v[156:159], v[52:55]
    ds_read_b128 v[92:95], v108 offset:26624
    v_mfma_f32_16x16x32_bf16 v[36:39], v[96:99], v[152:155], v[36:39]
    v_mfma_f32_16x16x32_bf16 v[56:59], v[96:99], v[156:159], v[56:59]
    ds_read_b128 v[96:99], v108 offset:27648
    v_add_u32 v9, 632, v8
    v_mfma_f32_16x16x32_bf16 v[40:43], v[100:103], v[152:155], v[40:43]
    v_mfma_f32_16x16x32_bf16 v[60:63], v[100:103], v[156:159], v[60:63]
    ds_read_b128 v[100:103], v108 offset:28672
    v_mfma_f32_16x16x32_bf16 v[44:47], v[104:107], v[152:155], v[44:47]
    v_mfma_f32_16x16x32_bf16 v[64:67], v[104:107], v[156:159], v[64:67]
    ds_read_b128 v[104:107], v108 offset:29696
    s_waitcnt vmcnt(4) lgkmcnt(5)
    v_mfma_f32_16x16x32_bf16 v[48:51], v[68:71], v[164:167], v[48:51]
    ds_write_b32 v5, v9
    v_mfma_f32_16x16x32_bf16 v[52:55], v[72:75], v[164:167], v[52:55]
    v_mfma_f32_16x16x32_bf16 v[56:59], v[76:79], v[164:167], v[56:59]
    v_mfma_f32_16x16x32_bf16 v[60:63], v[80:83], v[164:167], v[60:63]
    v_mfma_f32_16x16x32_bf16 v[64:67], v[84:87], v[164:167], v[64:67]
    s_waitcnt vmcnt(1) lgkmcnt(1)
    v_mfma_f32_16x16x32_bf16 v[48:51], v[88:91], v[172:175], v[48:51]
    v_mfma_f32_16x16x32_bf16 v[52:55], v[92:95], v[172:175], v[52:55]
    v_mfma_f32_16x16x32_bf16 v[56:59], v[96:99], v[172:175], v[56:59]
    v_mfma_f32_16x16x32_bf16 v[60:63], v[100:103], v[172:175], v[60:63]
    v_mfma_f32_16x16x32_bf16 v[64:67], v[104:107], v[172:175], v[64:67]
    v_mfma_f32_16x16x32_bf16 v[28:31], v[68:71], v[160:163], v[28:31]
    s_nop 2
    v_cvt_pk_bf16_f32 v112, v48, v49
    v_mfma_f32_16x16x32_bf16 v[32:35], v[72:75], v[160:163], v[32:35]
    v_cvt_pk_bf16_f32 v113, v50, v51
    v_mfma_f32_16x16x32_bf16 v[36:39], v[76:79], v[160:163], v[36:39]
    v_cvt_pk_bf16_f32 v114, v52, v53
    v_mfma_f32_16x16x32_bf16 v[40:43], v[80:83], v[160:163], v[40:43]
    v_cvt_pk_bf16_f32 v116, v54, v55
    v_mfma_f32_16x16x32_bf16 v[44:47], v[84:87], v[160:163], v[44:47]
    v_cvt_pk_bf16_f32 v117, v56, v57
    v_mfma_f32_16x16x32_bf16 v[28:31], v[88:91], v[168:171], v[28:31]
    v_cvt_pk_bf16_f32 v118, v58, v59
    v_mfma_f32_16x16x32_bf16 v[32:35], v[92:95], v[168:171], v[32:35]
    v_cvt_pk_bf16_f32 v120, v60, v61
    v_mfma_f32_16x16x32_bf16 v[36:39], v[96:99], v[168:171], v[36:39]
    v_cvt_pk_bf16_f32 v121, v62, v63
    v_mfma_f32_16x16x32_bf16 v[40:43], v[100:103], v[168:171], v[40:43]
    v_cvt_pk_bf16_f32 v122, v64, v65
    v_mfma_f32_16x16x32_bf16 v[44:47], v[104:107], v[168:171], v[44:47]
    v_cvt_pk_bf16_f32 v124, v66, v67
    buffer_store_dwordx4 v[112:115], v4, s[4:7], s73 offen offset:0
    buffer_store_dwordx4 v[116:119], v4, s[4:7], s73 offen offset:1024
    buffer_store_dwordx4 v[120:123], v4, s[4:7], s75 offen offset:0
    buffer_store_dwordx4 v[124:127], v4, s[4:7], s75 offen offset:1024
.Lxw92:
    buffer_load_dwordx4 v[128:131], v4, s[4:7], s72 offen offset:0 sc1
    buffer_load_dwordx4 v[132:135], v4, s[4:7], s72 offen offset:1024 sc1
    buffer_load_dwordx4 v[136:139], v4, s[4:7], s74 offen offset:0 sc1
    buffer_load_dwordx4 v[140:143], v4, s[4:7], s74 offen offset:1024 sc1
    s_waitcnt vmcnt(0)
    v_xor_b32 v9, v131, v24
    v_xor_b32 v10, v135, v24
    v_xor_b32 v131, v139, v24
    v_xor_b32 v135, v143, v24
    v_or3_b32 v9, v9, v10, v131
    v_or_b32 v9, v9, v135
    v_cmp_ne_u32 vcc, 0, v9
    s_sub_u32 s88, s88, 1
    s_cbranch_scc1 .Lend
    s_cbranch_vccnz .Lxw92
    v_lshlrev_b32 v48, 16, v128
    v_and_b32 v49, 0xffff0000, v128
    v_lshlrev_b32 v50, 16, v129
    v_and_b32 v51, 0xffff0000, v129
    v_lshlrev_b32 v52, 16, v130
    v_and_b32 v53, 0xffff0000, v130
    v_lshlrev_b32 v54, 16, v132
    v_and_b32 v55, 0xffff0000, v132
    v_lshlrev_b32 v56, 16, v133
    v_and_b32 v57, 0xffff0000, v133
    v_lshlrev_b32 v58, 16, v134
    v_and_b32 v59, 0xffff0000, v134
    v_lshlrev_b32 v60, 16, v136
    v_and_b32 v61, 0xffff0000, v136
    v_lshlrev_b32 v62, 16, v137
    v_and_b32 v63, 0xffff0000, v137
    v_lshlrev_b32 v64, 16, v138
    v_and_b32 v65, 0xffff0000, v138
    v_lshlrev_b32 v66, 16, v140
    v_and_b32 v67, 0xffff0000, v140
    v_pk_add_f32 v[28:29], v[28:29], v[48:49]
    v_pk_add_f32 v[30:31], v[30:31], v[50:51]
    v_pk_add_f32 v[32:33], v[32:33], v[52:53]
    v_pk_add_f32 v[34:35], v[34:35], v[54:55]
    v_pk_add_f32 v[36:37], v[36:37], v[56:57]
    v_pk_add_f32 v[38:39], v[38:39], v[58:59]
    v_pk_add_f32 v[40:41], v[40:41], v[60:61]
    v_pk_add_f32 v[42:43], v[42:43], v[62:63]
    v_pk_add_f32 v[44:45], v[44:45], v[64:65]
    v_pk_add_f32 v[46:47], v[46:47], v[66:67]
    s_cmp_lg_u32 s43, 0
    s_cbranch_scc1 .Lfinal
    v_cvt_pk_bf16_f32 v12, v28, v29
    v_cvt_pk_bf16_f32 v13, v30, v31
    v_cvt_pk_bf16_f32 v14, v32, v33
    v_cvt_pk_bf16_f32 v15, v34, v35
    buffer_store_dwordx4 v[12:15], v4, s[4:7], s68 offen
    v_cvt_pk_bf16_f32 v16, v36, v37
    v_cvt_pk_bf16_f32 v17, v38, v39
    v_cvt_pk_bf16_f32 v18, v40, v41
    v_cvt_pk_bf16_f32 v19, v42, v43
    buffer_store_dwordx4 v[16:19], v4, s[4:7], s68 offen offset:1024
    v_cvt_pk_bf16_f32 v20, v44, v45
    v_cvt_pk_bf16_f32 v21, v46, v47
    buffer_store_dwordx2 v[20:21], v4, s[4:7], s69 offen
    v_pk_add_f32 v[24:25], v[28:29], v[30:31]
    v_pk_mul_f32 v[26:27], v[28:29], v[28:29]
    v_pk_fma_f32 v[26:27], v[30:31], v[30:31], v[26:27]
    v_pk_add_f32 v[24:25], v[24:25], v[32:33]
    v_pk_fma_f32 v[26:27], v[32:33], v[32:33], v[26:27]
    v_pk_add_f32 v[24:25], v[24:25], v[34:35]
    v_pk_fma_f32 v[26:27], v[34:35], v[34:35], v[26:27]
    v_pk_add_f32 v[24:25], v[24:25], v[36:37]
    v_pk_fma_f32 v[26:27], v[36:37], v[36:37], v[26:27]
    v_pk_add_f32 v[24:25], v[24:25], v[38:39]
    v_pk_fma_f32 v[26:27], v[38:39], v[38:39], v[26:27]
    v_pk_add_f32 v[24:25], v[24:25], v[40:41]
    v_pk_fma_f32 v[26:27], v[40:41], v[40:41], v[26:27]
    v_pk_add_f32 v[24:25], v[24:25], v[42:43]
    v_pk_fma_f32 v[26:27], v[42:43], v[42:43], v[26:27]
    v_pk_add_f32 v[24:25], v[24:25], v[44:45]
    v_pk_fma_f32 v[26:27], v[44:45], v[44:45], v[26:27]
    v_pk_add_f32 v[24:25], v[24:25], v[46:47]
    v_pk_fma_f32 v[26:27], v[46:47], v[46:47], v[26:27]
    v_add_f32 v24, v24, v25
    v_add_f32 v26, v26, v27
    s_nop 1
    v_permlane32_swap_b32 v24, v26
    v_add_f32 v24, v24, v26
    v_mov_b32 v26, v24
    s_nop 1
    v_permlane16_swap_b32 v24, v26
    v_add_f32 v24, v24, v26
    buffer_store_dword v24, v22, s[4:7], s70 offen
    s_add_u32 s89, s89, 0x20000
    s_add_u32 s41, s41, 1
    s_mov_b32 s90, 0
    s_mov_b32 s91, 0xffff
    v_mov_b32 v7, s41
    s_sub_u32 s44, s44, 632
    v_mov_b32 v8, 632
    s_waitcnt vmcnt(0)
    buffer_store_dword v7, v11, s[4:7], s71 offen offset:0
    s_movk_i32 s43, 632
    s_branch .Liter
.Lfinal:
    v_cvt_pk_bf16_f32 v12, v28, v29
    v_cvt_pk_bf16_f32 v13, v30, v31
    v_cvt_pk_bf16_f32 v14, v32, v33
    v_cvt_pk_bf16_f32 v15, v34, v35
    v_cvt_pk_bf16_f32 v16, v36, v37
    v_cvt_pk_bf16_f32 v17, v38, v39
    v_cvt_pk_bf16_f32 v18, v40, v41
    v_cvt_pk_bf16_f32 v19, v42, v43
    v_cvt_pk_bf16_f32 v20, v44, v45
    v_cvt_pk_bf16_f32 v21, v46, v47
    v_mul_u32_u24 v24, 2560, v2
    v_lshl_add_u32 v24, v3, 3, v24
    s_mov_b32 s12, s32
    s_and_b32 s13, s33, 0xffff
    s_mov_b32 s14, 0x280000
    s_mov_b32 s15, 0x20000
    buffer_store_dwordx2 v[12:13], v24, s[12:15], s64 offen offset:0
    buffer_store_dwordx2 v[14:15], v24, s[12:15], s64 offen offset:32
    buffer_store_dwordx2 v[16:17], v24, s[12:15], s64 offen offset:64
    buffer_store_dwordx2 v[18:19], v24, s[12:15], s64 offen offset:96
    buffer_store_dwordx2 v[20:21], v24, s[12:15], s65 offen
    s_branch .Lfin
.Lloader:
    v_mov_b32 v9, 1
    ds_max_i32 v5, v9
    s_mul_i32 s72, s40, 153600
    s_add_u32 s72, s72, 0x2201000
    s_mul_i32 s73, s60, 102400
    s_add_u32 s73, s73, 0x2480000
    s_mul_i32 s74, s40, 122880
    s_add_u32 s74, s74, 0x2580000
    s_mul_i32 s75, s60, 245760
    s_add_u32 s75, s75, 0x2780000
    s_mul_i32 s68, s61, 122880
    s_add_u32 s75, s75, s68
    s_and_b32 s68, s39, 1
    s_lshl_b32 s69, s68, 1
    s_add_u32 s69, s69, s61
    s_mul_i32 s76, s68, 0
    s_mul_i32 s77, s69, 0
    s_mul_i32 s78, s68, 0
    s_mul_i32 s79, s69, 0
    v_mov_b32 v12, 161792
    s_movk_i32 s44, -1000
    v_lshlrev_b32 v13, 2, v1
    v_lshlrev_b32 v14, 7, v1
    s_mov_b32 s8, s26
    s_and_b32 s9, s27, 0xffff
    s_mov_b32 s10, 0xc00
    s_mov_b32 s11, 0x20000
    s_mov_b32 s12, s30
    s_and_b32 s13, s31, 0xffff
    s_mov_b32 s14, 0x500
    s_mov_b32 s15, 0x20000
    s_mul_i32 s68, s40, 192
    buffer_load_dword v24, v13, s[8:11], s68 offen
    s_lshl_b32 s69, s62, 5
    v_add_u32 v26, s69, v13
    v_subrev_u32 v27, 160, v26
    v_min_u32 v26, v26, v27
    s_mul_i32 s68, s60, 160
    buffer_load_dword v28, v26, s[12:15], s68 offen
    v_lshlrev_b32 v30, 3, v1
    v_add_u32 v30, 162784, v30
    s_waitcnt vmcnt(1)
    v_and_b32 v25, 0xffff0000, v24
    v_lshlrev_b32 v24, 16, v24
    s_waitcnt vmcnt(0)
    v_and_b32 v29, 0xffff0000, v28
    v_lshlrev_b32 v28, 16, v28
    s_mov_b32 exec_hi, 0xffff
    ds_write_b64 v30, v[24:25]
    s_mov_b32 exec_hi, 0xff
    ds_write_b64 v30, v[28:29] offset:384
    s_mov_b64 exec, -1
    s_mul_i32 s68, s40, 2560
    s_add_u32 s68, s68, 0x29e0000
    s_mov_b32 exec_lo, 0xfffff
    s_mov_b32 exec_hi, 0x0
.Lp93:
    buffer_load_dword v9, v14, s[4:7], s68 offen sc1
    s_waitcnt vmcnt(0)
    v_cmp_ne_u32 vcc, s41, v9
    s_nop 0
    s_cbranch_vccz .Lpd94
    s_sleep 1
    s_sub_u32 s88, s88, 1
    s_cbranch_scc1 .Lend
    s_branch .Lp93
.Lpd94:
    s_mov_b64 exec, -1
    v_mov_b32 v9, 2
    ds_max_i32 v5, v9
    s_add_u32 s80, s72, s76
    s_add_u32 s81, s72, 153600
    s_cmpk_ge_i32 s44, -143
    s_cbranch_scc0 .Llf95
.Llr96:
    s_mov_b32 m0, 0
    s_nop 0
    buffer_load_dwordx4 v4, s[4:7], s80 offen offset:0 lds
    buffer_load_dwordx4 v4, s[4:7], s80 offen offset:1024 lds
    buffer_load_dwordx4 v4, s[4:7], s80 offen offset:2048 lds
    buffer_load_dwordx4 v4, s[4:7], s80 offen offset:3072 lds
    s_add_u32 s80, s80, 4096
    s_mov_b32 m0, 4096
    s_nop 0
    buffer_load_dwordx4 v4, s[4:7], s80 offen offset:0 lds
    buffer_load_dwordx4 v4, s[4:7], s80 offen offset:1024 lds
    buffer_load_dwordx4 v4, s[4:7], s80 offen offset:2048 lds
    buffer_load_dwordx4 v4, s[4:7], s80 offen offset:3072 lds
    s_add_u32 s80, s80, 4096
    s_movk_i32 s94, 8
    s_call_b64 s[46:47], .Lpubnow
    s_mov_b32 m0, 8192
    s_nop 0
    buffer_load_dwordx4 v4, s[4:7], s80 offen offset:0 lds
    buffer_load_dwordx4 v4, s[4:7], s80 offen offset:1024 lds
    buffer_load_dwordx4 v4, s[4:7], s80 offen offset:2048 lds
    buffer_load_dwordx4 v4, s[4:7], s80 offen offset:3072 lds
    s_add_u32 s80, s80, 4096
    s_mov_b32 m0, 12288
    s_nop 0
    buffer_load_dwordx4 v4, s[4:7], s80 offen offset:0 lds
    buffer_load_dwordx4 v4, s[4:7], s80 offen offset:1024 lds
    buffer_load_dwordx4 v4, s[4:7], s80 offen offset:2048 lds
    s_add_u32 s80, s80, 3072
    s_waitcnt vmcnt(45)
    s_movk_i32 s94, 15
    s_call_b64 s[46:47], .Lpubnow
    s_cmpk_ge_i32 s44, -128
    s_cbranch_scc0 .Llf97
.Llr98:
    s_mov_b32 m0, 15360
    s_nop 0
    buffer_load_dwordx4 v4, s[4:7], s80 offen offset:0 lds
    buffer_load_dwordx4 v4, s[4:7], s80 offen offset:1024 lds
    buffer_load_dwordx4 v4, s[4:7], s80 offen offset:2048 lds
    buffer_load_dwordx4 v4, s[4:7], s80 offen offset:3072 lds
    s_add_u32 s80, s80, 4096
    s_mov_b32 m0, 19456
    s_nop 0
    buffer_load_dwordx4 v4, s[4:7], s80 offen offset:0 lds
    buffer_load_dwordx4 v4, s[4:7], s80 offen offset:1024 lds
    buffer_load_dwordx4 v4, s[4:7], s80 offen offset:2048 lds
    buffer_load_dwordx4 v4, s[4:7], s80 offen offset:3072 lds
    s_add_u32 s80, s80, 4096
    s_movk_i32 s94, 23
    s_call_b64 s[46:47], .Lpubnow
    s_mov_b32 m0, 23552
    s_nop 0
    buffer_load_dwordx4 v4, s[4:7], s80 offen offset:0 lds
    buffer_load_dwordx4 v4, s[4:7], s80 offen offset:1024 lds
    buffer_load_dwordx4 v4, s[4:7], s80 offen offset:2048 lds
    buffer_load_dwordx4 v4, s[4:7], s80 offen offset:3072 lds
    s_add_u32 s80, s80, 4096
    s_mov_b32 m0, 27648
    s_nop 0
    buffer_load_dwordx4 v4, s[4:7], s80 offen offset:0 lds
    buffer_load_dwordx4 v4, s[4:7], s80 offen offset:1024 lds
    buffer_load_dwordx4 v4, s[4:7], s80 offen offset:2048 lds
    s_add_u32 s80, s80, 3072
    s_waitcnt vmcnt(45)
    s_movk_i32 s94, 30
    s_call_b64 s[46:47], .Lpubnow
    s_cmpk_ge_i32 s44, -113
    s_cbranch_scc0 .Llf99
.Llr100:
    s_mov_b32 m0, 30720
    s_nop 0
    buffer_load_dwordx4 v4, s[4:7], s80 offen offset:0 lds
    buffer_load_dwordx4 v4, s[4:7], s80 offen offset:1024 lds
    buffer_load_dwordx4 v4, s[4:7], s80 offen offset:2048 lds
    buffer_load_dwordx4 v4, s[4:7], s80 offen offset:3072 lds
    s_add_u32 s80, s80, 4096
    s_mov_b32 m0, 34816
    s_nop 0
    buffer_load_dwordx4 v4, s[4:7], s80 offen offset:0 lds
    buffer_load_dwordx4 v4, s[4:7], s80 offen offset:1024 lds
    buffer_load_dwordx4 v4, s[4:7], s80 offen offset:2048 lds
    buffer_load_dwordx4 v4, s[4:7], s80 offen offset:3072 lds
    s_add_u32 s80, s80, 4096
    s_movk_i32 s94, 38
    s_call_b64 s[46:47], .Lpubnow
    s_mov_b32 m0, 38912
    s_nop 0
    buffer_load_dwordx4 v4, s[4:7], s80 offen offset:0 lds
    buffer_load_dwordx4 v4, s[4:7], s80 offen offset:1024 lds
    buffer_load_dwordx4 v4, s[4:7], s80 offen offset:2048 lds
    buffer_load_dwordx4 v4, s[4:7], s80 offen offset:3072 lds
    s_add_u32 s80, s80, 4096
    s_mov_b32 m0, 43008
    s_nop 0
    buffer_load_dwordx4 v4, s[4:7], s80 offen offset:0 lds
    buffer_load_dwordx4 v4, s[4:7], s80 offen offset:1024 lds
    buffer_load_dwordx4 v4, s[4:7], s80 offen offset:2048 lds
    s_add_u32 s80, s80, 3072
    s_waitcnt vmcnt(45)
    s_movk_i32 s94, 45
    s_call_b64 s[46:47], .Lpubnow
    s_mul_i32 s69, s40, 10240
    s_add_u32 s69, s69, 0x2980000
    buffer_load_dwordx4 v[32:35], v4, s[4:7], s69 offen offset:0 sc1
    buffer_load_dwordx4 v[36:39], v4, s[4:7], s69 offen offset:1024 sc1
    buffer_load_dwordx4 v[40:43], v4, s[4:7], s69 offen offset:2048 sc1
    buffer_load_dwordx4 v[44:47], v4, s[4:7], s69 offen offset:3072 sc1
    s_add_u32 s69, s69, 4096
    buffer_load_dwordx4 v[48:51], v4, s[4:7], s69 offen offset:0 sc1
    buffer_load_dwordx4 v[52:55], v4, s[4:7], s69 offen offset:1024 sc1
    buffer_load_dwordx4 v[56:59], v4, s[4:7], s69 offen offset:2048 sc1
    buffer_load_dwordx4 v[60:63], v4, s[4:7], s69 offen offset:3072 sc1
    s_add_u32 s69, s69, 4096
    buffer_load_dwordx4 v[64:67], v4, s[4:7], s69 offen offset:0 sc1
    buffer_load_dwordx4 v[68:71], v4, s[4:7], s69 offen offset:1024 sc1
    s_cmpk_ge_i32 s44, -98
    s_cbranch_scc0 .Llf101
.Llr102:
    s_mov_b32 m0, 46080
    s_nop 0
    buffer_load_dwordx4 v4, s[4:7], s80 offen offset:0 lds
    buffer_load_dwordx4 v4, s[4:7], s80 offen offset:1024 lds
    buffer_load_dwordx4 v4, s[4:7], s80 offen offset:2048 lds
    buffer_load_dwordx4 v4, s[4:7], s80 offen offset:3072 lds
    s_add_u32 s80, s80, 4096
    s_mov_b32 m0, 50176
    s_nop 0
    buffer_load_dwordx4 v4, s[4:7], s80 offen offset:0 lds
    buffer_load_dwordx4 v4, s[4:7], s80 offen offset:1024 lds
    buffer_load_dwordx4 v4, s[4:7], s80 offen offset:2048 lds
    buffer_load_dwordx4 v4, s[4:7], s80 offen offset:3072 lds
    s_add_u32 s80, s80, 4096
    s_movk_i32 s94, 53
    s_call_b64 s[46:47], .Lpubnow
    s_mov_b32 m0, 54272
    s_nop 0
    buffer_load_dwordx4 v4, s[4:7], s80 offen offset:0 lds
    buffer_load_dwordx4 v4, s[4:7], s80 offen offset:1024 lds
    buffer_load_dwordx4 v4, s[4:7], s80 offen offset:2048 lds
    buffer_load_dwordx4 v4, s[4:7], s80 offen offset:3072 lds
    s_add_u32 s80, s80, 4096
    s_mov_b32 m0, 58368
    s_nop 0
    buffer_load_dwordx4 v4, s[4:7], s80 offen offset:0 lds
    buffer_load_dwordx4 v4, s[4:7], s80 offen offset:1024 lds
    buffer_load_dwordx4 v4, s[4:7], s80 offen offset:2048 lds
    s_add_u32 s80, s80, 3072
    s_waitcnt vmcnt(45)
    s_movk_i32 s94, 60
    s_call_b64 s[46:47], .Lpubnow
    s_cmpk_ge_i32 s44, -83
    s_cbranch_scc0 .Llf103
.Llr104:
    s_mov_b32 m0, 61440
    s_nop 0
    buffer_load_dwordx4 v4, s[4:7], s80 offen offset:0 lds
    buffer_load_dwordx4 v4, s[4:7], s80 offen offset:1024 lds
    buffer_load_dwordx4 v4, s[4:7], s80 offen offset:2048 lds
    buffer_load_dwordx4 v4, s[4:7], s80 offen offset:3072 lds
    s_add_u32 s80, s80, 4096
    s_mov_b32 m0, 65536
    s_nop 0
    buffer_load_dwordx4 v4, s[4:7], s80 offen offset:0 lds
    buffer_load_dwordx4 v4, s[4:7], s80 offen offset:1024 lds
    buffer_load_dwordx4 v4, s[4:7], s80 offen offset:2048 lds
    buffer_load_dwordx4 v4, s[4:7], s80 offen offset:3072 lds
    s_add_u32 s80, s80, 4096
    s_movk_i32 s94, 68
    s_call_b64 s[46:47], .Lpubnow
    s_mov_b32 m0, 69632
    s_nop 0
    buffer_load_dwordx4 v4, s[4:7], s80 offen offset:0 lds
    buffer_load_dwordx4 v4, s[4:7], s80 offen offset:1024 lds
    buffer_load_dwordx4 v4, s[4:7], s80 offen offset:2048 lds
    buffer_load_dwordx4 v4, s[4:7], s80 offen offset:3072 lds
    s_add_u32 s80, s80, 4096
    s_mov_b32 m0, 73728
    s_nop 0
    buffer_load_dwordx4 v4, s[4:7], s80 offen offset:0 lds
    buffer_load_dwordx4 v4, s[4:7], s80 offen offset:1024 lds
    buffer_load_dwordx4 v4, s[4:7], s80 offen offset:2048 lds
    s_add_u32 s80, s80, 3072
    s_waitcnt vmcnt(45)
    s_movk_i32 s94, 75
    s_call_b64 s[46:47], .Lpubnow
    s_cmpk_ge_i32 s44, -68
    s_cbranch_scc0 .Llf105
.Llr106:
    s_mov_b32 m0, 76800
    s_nop 0
    buffer_load_dwordx4 v4, s[4:7], s80 offen offset:0 lds
    buffer_load_dwordx4 v4, s[4:7], s80 offen offset:1024 lds
    buffer_load_dwordx4 v4, s[4:7], s80 offen offset:2048 lds
    buffer_load_dwordx4 v4, s[4:7], s80 offen offset:3072 lds
    s_add_u32 s80, s80, 4096
    s_mov_b32 m0, 80896
    s_nop 0
    buffer_load_dwordx4 v4, s[4:7], s80 offen offset:0 lds
    buffer_load_dwordx4 v4, s[4:7], s80 offen offset:1024 lds
    buffer_load_dwordx4 v4, s[4:7], s80 offen offset:2048 lds
    buffer_load_dwordx4 v4, s[4:7], s80 offen offset:3072 lds
    s_add_u32 s80, s80, 4096
    s_movk_i32 s94, 83
    s_call_b64 s[46:47], .Lpubnow
    s_mov_b32 m0, 84992
    s_nop 0
    buffer_load_dwordx4 v4, s[4:7], s80 offen offset:0 lds
    buffer_load_dwordx4 v4, s[4:7], s80 offen offset:1024 lds
    buffer_load_dwordx4 v4, s[4:7], s80 offen offset:2048 lds
    buffer_load_dwordx4 v4, s[4:7], s80 offen offset:3072 lds
    s_add_u32 s80, s80, 4096
    s_mov_b32 m0, 89088
    s_nop 0
    buffer_load_dwordx4 v4, s[4:7], s80 offen offset:0 lds
    buffer_load_dwordx4 v4, s[4:7], s80 offen offset:1024 lds
    buffer_load_dwordx4 v4, s[4:7], s80 offen offset:2048 lds
    s_add_u32 s80, s80, 3072
    s_waitcnt vmcnt(45)
    s_movk_i32 s94, 90
    s_call_b64 s[46:47], .Lpubnow
    s_waitcnt vmcnt(45)
    s_setprio 3
    v_add_f32 v32, v32, v36
    v_add_f32 v33, v33, v37
    v_add_f32 v34, v34, v38
    v_add_f32 v35, v35, v39
    v_add_f32 v32, v32, v40
    v_add_f32 v33, v33, v41
    v_add_f32 v34, v34, v42
    v_add_f32 v35, v35, v43
    v_add_f32 v32, v32, v44
    v_add_f32 v33, v33, v45
    v_add_f32 v34, v34, v46
    v_add_f32 v35, v35, v47
    v_add_f32 v32, v32, v48
    v_add_f32 v33, v33, v49
    v_add_f32 v34, v34, v50
    v_add_f32 v35, v35, v51
    v_add_f32 v32, v32, v52
    v_add_f32 v33, v33, v53
    v_add_f32 v34, v34, v54
    v_add_f32 v35, v35, v55
    v_add_f32 v32, v32, v56
    v_add_f32 v33, v33, v57
    v_add_f32 v34, v34, v58
    v_add_f32 v35, v35, v59
    v_add_f32 v32, v32, v60
    v_add_f32 v33, v33, v61
    v_add_f32 v34, v34, v62
    v_add_f32 v35, v35, v63
    v_add_f32 v32, v32, v64
    v_add_f32 v33, v33, v65
    v_add_f32 v34, v34, v66
    v_add_f32 v35, v35, v67
    v_add_f32 v32, v32, v68
    v_add_f32 v33, v33, v69
    v_add_f32 v34, v34, v70
    v_add_f32 v35, v35, v71
    v_mov_b32 v36, v32
    v_mov_b32 v37, v33
    v_mov_b32 v38, v34
    v_mov_b32 v39, v35
    v_permlane32_swap_b32 v32, v36
    v_permlane32_swap_b32 v33, v37
    v_permlane32_swap_b32 v34, v38
    v_permlane32_swap_b32 v35, v39
    v_add_f32 v32, v32, v36
    v_add_f32 v33, v33, v37
    v_add_f32 v34, v34, v38
    v_add_f32 v35, v35, v39
    v_add_u32 v14, 161888, v4
    s_mov_b32 exec_lo, 0xffffffff
    s_mov_b32 exec_hi, 0
    ds_write_b128 v14, v[32:35]
    s_mov_b64 exec, -1
    s_setprio 0
    s_cmpk_ge_i32 s44, -53
    s_cbranch_scc0 .Llf107
.Llr108:
    s_mov_b32 m0, 92160
    s_nop 0
    buffer_load_dwordx4 v4, s[4:7], s80 offen offset:0 lds
    buffer_load_dwordx4 v4, s[4:7], s80 offen offset:1024 lds
    buffer_load_dwordx4 v4, s[4:7], s80 offen offset:2048 lds
    buffer_load_dwordx4 v4, s[4:7], s80 offen offset:3072 lds
    s_add_u32 s80, s80, 4096
    s_mov_b32 m0, 96256
    s_nop 0
    buffer_load_dwordx4 v4, s[4:7], s80 offen offset:0 lds
    buffer_load_dwordx4 v4, s[4:7], s80 offen offset:1024 lds
    buffer_load_dwordx4 v4, s[4:7], s80 offen offset:2048 lds
    buffer_load_dwordx4 v4, s[4:7], s80 offen offset:3072 lds
    s_add_u32 s80, s80, 4096
    s_movk_i32 s94, 98
    s_call_b64 s[46:47], .Lpubnow
    s_mov_b32 m0, 100352
    s_nop 0
    buffer_load_dwordx4 v4, s[4:7], s80 offen offset:0 lds
    buffer_load_dwordx4 v4, s[4:7], s80 offen offset:1024 lds
    buffer_load_dwordx4 v4, s[4:7], s80 offen offset:2048 lds
    buffer_load_dwordx4 v4, s[4:7], s80 offen offset:3072 lds
    s_add_u32 s80, s80, 4096
    s_mov_b32 m0, 104448
    s_nop 0
    buffer_load_dwordx4 v4, s[4:7], s80 offen offset:0 lds
    buffer_load_dwordx4 v4, s[4:7], s80 offen offset:1024 lds
    buffer_load_dwordx4 v4, s[4:7], s80 offen offset:2048 lds
    s_add_u32 s80, s80, 3072
    s_waitcnt vmcnt(45)
    s_movk_i32 s94, 105
    s_call_b64 s[46:47], .Lpubnow
    s_cmpk_ge_i32 s44, -38
    s_cbranch_scc0 .Llf109
.Llr110:
    s_mov_b32 m0, 107520
    s_nop 0
    buffer_load_dwordx4 v4, s[4:7], s80 offen offset:0 lds
    buffer_load_dwordx4 v4, s[4:7], s80 offen offset:1024 lds
    buffer_load_dwordx4 v4, s[4:7], s80 offen offset:2048 lds
    buffer_load_dwordx4 v4, s[4:7], s80 offen offset:3072 lds
    s_add_u32 s80, s80, 4096
    s_mov_b32 m0, 111616
    s_nop 0
    buffer_load_dwordx4 v4, s[4:7], s80 offen offset:0 lds
    buffer_load_dwordx4 v4, s[4:7], s80 offen offset:1024 lds
    buffer_load_dwordx4 v4, s[4:7], s80 offen offset:2048 lds
    buffer_load_dwordx4 v4, s[4:7], s80 offen offset:3072 lds
    s_add_u32 s80, s80, 4096
    s_movk_i32 s94, 113
    s_call_b64 s[46:47], .Lpubnow
    s_mov_b32 m0, 115712
    s_nop 0
    buffer_load_dwordx4 v4, s[4:7], s80 offen offset:0 lds
    buffer_load_dwordx4 v4, s[4:7], s80 offen offset:1024 lds
    buffer_load_dwordx4 v4, s[4:7], s80 offen offset:2048 lds
    buffer_load_dwordx4 v4, s[4:7], s80 offen offset:3072 lds
    s_add_u32 s80, s80, 4096
    s_mov_b32 m0, 119808
    s_nop 0
    buffer_load_dwordx4 v4, s[4:7], s80 offen offset:0 lds
    buffer_load_dwordx4 v4, s[4:7], s80 offen offset:1024 lds
    buffer_load_dwordx4 v4, s[4:7], s80 offen offset:2048 lds
    s_add_u32 s80, s80, 3072
    s_waitcnt vmcnt(45)
    s_movk_i32 s94, 120
    s_call_b64 s[46:47], .Lpubnow
    s_cmpk_ge_i32 s44, -23
    s_cbranch_scc0 .Llf111
.Llr112:
    s_mov_b32 m0, 122880
    s_nop 0
    buffer_load_dwordx4 v4, s[4:7], s80 offen offset:0 lds
    buffer_load_dwordx4 v4, s[4:7], s80 offen offset:1024 lds
    buffer_load_dwordx4 v4, s[4:7], s80 offen offset:2048 lds
    buffer_load_dwordx4 v4, s[4:7], s80 offen offset:3072 lds
    s_add_u32 s80, s80, 4096
    s_mov_b32 m0, 126976
    s_nop 0
    buffer_load_dwordx4 v4, s[4:7], s80 offen offset:0 lds
    buffer_load_dwordx4 v4, s[4:7], s80 offen offset:1024 lds
    buffer_load_dwordx4 v4, s[4:7], s80 offen offset:2048 lds
    buffer_load_dwordx4 v4, s[4:7], s80 offen offset:3072 lds
    s_add_u32 s80, s80, 4096
    s_movk_i32 s94, 128
    s_call_b64 s[46:47], .Lpubnow
    s_mov_b32 m0, 131072
    s_nop 0
    buffer_load_dwordx4 v4, s[4:7], s80 offen offset:0 lds
    buffer_load_dwordx4 v4, s[4:7], s80 offen offset:1024 lds
    buffer_load_dwordx4 v4, s[4:7], s80 offen offset:2048 lds
    buffer_load_dwordx4 v4, s[4:7], s80 offen offset:3072 lds
    s_add_u32 s80, s80, 4096
    s_mov_b32 m0, 135168
    s_nop 0
    buffer_load_dwordx4 v4, s[4:7], s80 offen offset:0 lds
    buffer_load_dwordx4 v4, s[4:7], s80 offen offset:1024 lds
    buffer_load_dwordx4 v4, s[4:7], s80 offen offset:2048 lds
    s_add_u32 s80, s80, 3072
    s_waitcnt vmcnt(45)
    s_movk_i32 s94, 135
    s_call_b64 s[46:47], .Lpubnow
    s_cmpk_ge_i32 s44, -8
    s_cbranch_scc0 .Llf113
.Llr114:
    s_mov_b32 m0, 138240
    s_nop 0
    buffer_load_dwordx4 v4, s[4:7], s80 offen offset:0 lds
    buffer_load_dwordx4 v4, s[4:7], s80 offen offset:1024 lds
    buffer_load_dwordx4 v4, s[4:7], s80 offen offset:2048 lds
    buffer_load_dwordx4 v4, s[4:7], s80 offen offset:3072 lds
    s_add_u32 s80, s80, 4096
    s_mov_b32 m0, 142336
    s_nop 0
    buffer_load_dwordx4 v4, s[4:7], s80 offen offset:0 lds
    buffer_load_dwordx4 v4, s[4:7], s80 offen offset:1024 lds
    buffer_load_dwordx4 v4, s[4:7], s80 offen offset:2048 lds
    buffer_load_dwordx4 v4, s[4:7], s80 offen offset:3072 lds
    s_add_u32 s80, s80, 4096
    s_movk_i32 s94, 143
    s_call_b64 s[46:47], .Lpubnow
    s_mov_b32 m0, 146432
    s_nop 0
    buffer_load_dwordx4 v4, s[4:7], s80 offen offset:0 lds
    buffer_load_dwordx4 v4, s[4:7], s80 offen offset:1024 lds
    buffer_load_dwordx4 v4, s[4:7], s80 offen offset:2048 lds
    buffer_load_dwordx4 v4, s[4:7], s80 offen offset:3072 lds
    s_add_u32 s80, s80, 4096
    s_mov_b32 m0, 150528
    s_nop 0
    buffer_load_dwordx4 v4, s[4:7], s80 offen offset:0 lds
    buffer_load_dwordx4 v4, s[4:7], s80 offen offset:1024 lds
    buffer_load_dwordx4 v4, s[4:7], s80 offen offset:2048 lds
    s_add_u32 s80, s80, 3072
    s_waitcnt vmcnt(45)
    s_movk_i32 s94, 150
    s_call_b64 s[46:47], .Lpubnow
    s_movk_i32 s94, 150
    s_call_b64 s[46:47], .Ldrain
    s_lshl_b32 s69, s60, 7
    s_add_u32 s69, s69, 0x29ea800
    s_mov_b32 exec_lo, 0xfffff
    s_mov_b32 exec_hi, 0x0
.Lp115:
    buffer_load_dword v9, v13, s[4:7], s69 offen sc1
    s_waitcnt vmcnt(0)
    v_cmp_ne_u32 vcc, s41, v9
    s_nop 0
    s_cbranch_vccz .Lpd116
    s_sleep 4
    s_sub_u32 s88, s88, 1
    s_cbranch_scc1 .Lend
    s_branch .Lp115
.Lpd116:
    s_mov_b64 exec, -1
.Lwcap:
    ds_read_b128 v[248:251], v6
    s_waitcnt lgkmcnt(0)
    v_min3_i32 v248, v249, v250, v251
    s_nop 0
    v_readfirstlane_b32 s70, v248
    s_sub_u32 s88, s88, 1
    s_cbranch_scc1 .Lend
    s_cmpk_lt_i32 s70, 10000
    s_cbranch_scc1 .Lwcap
.Lloop_ld:
    s_add_u32 s80, s73, s77
    s_add_u32 s81, s73, 102400
    s_cmpk_ge_i32 s44, 10
    s_cbranch_scc0 .Llf117
.Llr118:
    s_mov_b32 m0, 0
    s_nop 0
    buffer_load_dwordx4 v4, s[4:7], s80 offen offset:0 lds
    buffer_load_dwordx4 v4, s[4:7], s80 offen offset:1024 lds
    buffer_load_dwordx4 v4, s[4:7], s80 offen offset:2048 lds
    buffer_load_dwordx4 v4, s[4:7], s80 offen offset:3072 lds
    s_add_u32 s80, s80, 4096
    s_mov_b32 m0, 4096
    s_nop 0
    buffer_load_dwordx4 v4, s[4:7], s80 offen offset:0 lds
    buffer_load_dwordx4 v4, s[4:7], s80 offen offset:1024 lds
    buffer_load_dwordx4 v4, s[4:7], s80 offen offset:2048 lds
    buffer_load_dwordx4 v4, s[4:7], s80 offen offset:3072 lds
    s_add_u32 s80, s80, 4096
    s_mov_b32 m0, 8192
    s_nop 0
    buffer_load_dwordx4 v4, s[4:7], s80 offen offset:0 lds
    buffer_load_dwordx4 v4, s[4:7], s80 offen offset:1024 lds
    s_add_u32 s80, s80, 2048
    s_waitcnt vmcnt(30)
    s_cmpk_ge_i32 s44, 20
    s_cbranch_scc0 .Llf119
.Llr120:
    s_mov_b32 m0, 10240
    s_nop 0
    buffer_load_dwordx4 v4, s[4:7], s80 offen offset:0 lds
    buffer_load_dwordx4 v4, s[4:7], s80 offen offset:1024 lds
    buffer_load_dwordx4 v4, s[4:7], s80 offen offset:2048 lds
    buffer_load_dwordx4 v4, s[4:7], s80 offen offset:3072 lds
    s_add_u32 s80, s80, 4096
    s_mov_b32 m0, 14336
    s_nop 0
    buffer_load_dwordx4 v4, s[4:7], s80 offen offset:0 lds
    buffer_load_dwordx4 v4, s[4:7], s80 offen offset:1024 lds
    buffer_load_dwordx4 v4, s[4:7], s80 offen offset:2048 lds
    buffer_load_dwordx4 v4, s[4:7], s80 offen offset:3072 lds
    s_add_u32 s80, s80, 4096
    s_mov_b32 m0, 18432
    s_nop 0
    buffer_load_dwordx4 v4, s[4:7], s80 offen offset:0 lds
    buffer_load_dwordx4 v4, s[4:7], s80 offen offset:1024 lds
    s_add_u32 s80, s80, 2048
    s_waitcnt vmcnt(30)
    s_cmpk_ge_i32 s44, 30
    s_cbranch_scc0 .Llf121
.Llr122:
    s_mov_b32 m0, 20480
    s_nop 0
    buffer_load_dwordx4 v4, s[4:7], s80 offen offset:0 lds
    buffer_load_dwordx4 v4, s[4:7], s80 offen offset:1024 lds
    buffer_load_dwordx4 v4, s[4:7], s80 offen offset:2048 lds
    buffer_load_dwordx4 v4, s[4:7], s80 offen offset:3072 lds
    s_add_u32 s80, s80, 4096
    s_mov_b32 m0, 24576
    s_nop 0
    buffer_load_dwordx4 v4, s[4:7], s80 offen offset:0 lds
    buffer_load_dwordx4 v4, s[4:7], s80 offen offset:1024 lds
    buffer_load_dwordx4 v4, s[4:7], s80 offen offset:2048 lds
    buffer_load_dwordx4 v4, s[4:7], s80 offen offset:3072 lds
    s_add_u32 s80, s80, 4096
    s_mov_b32 m0, 28672
    s_nop 0
    buffer_load_dwordx4 v4, s[4:7], s80 offen offset:0 lds
    buffer_load_dwordx4 v4, s[4:7], s80 offen offset:1024 lds
    s_add_u32 s80, s80, 2048
    s_waitcnt vmcnt(30)
    s_movk_i32 s94, 188
    s_call_b64 s[46:47], .Lpubnow
    s_cmpk_ge_i32 s44, 40
    s_cbranch_scc0 .Llf123
.Llr124:
    s_mov_b32 m0, 30720
    s_nop 0
    buffer_load_dwordx4 v4, s[4:7], s80 offen offset:0 lds
    buffer_load_dwordx4 v4, s[4:7], s80 offen offset:1024 lds
    buffer_load_dwordx4 v4, s[4:7], s80 offen offset:2048 lds
    buffer_load_dwordx4 v4, s[4:7], s80 offen offset:3072 lds
    s_add_u32 s80, s80, 4096
    s_mov_b32 m0, 34816
    s_nop 0
    buffer_load_dwordx4 v4, s[4:7], s80 offen offset:0 lds
    buffer_load_dwordx4 v4, s[4:7], s80 offen offset:1024 lds
    buffer_load_dwordx4 v4, s[4:7], s80 offen offset:2048 lds
    buffer_load_dwordx4 v4, s[4:7], s80 offen offset:3072 lds
    s_add_u32 s80, s80, 4096
    s_mov_b32 m0, 38912
    s_nop 0
    buffer_load_dwordx4 v4, s[4:7], s80 offen offset:0 lds
    buffer_load_dwordx4 v4, s[4:7], s80 offen offset:1024 lds
    s_add_u32 s80, s80, 2048
    s_waitcnt vmcnt(30)
    s_cmpk_ge_i32 s44, 50
    s_cbranch_scc0 .Llf125
.Llr126:
    s_mov_b32 m0, 40960
    s_nop 0
    buffer_load_dwordx4 v4, s[4:7], s80 offen offset:0 lds
    buffer_load_dwordx4 v4, s[4:7], s80 offen offset:1024 lds
    buffer_load_dwordx4 v4, s[4:7], s80 offen offset:2048 lds
    buffer_load_dwordx4 v4, s[4:7], s80 offen offset:3072 lds
    s_add_u32 s80, s80, 4096
    s_mov_b32 m0, 45056
    s_nop 0
    buffer_load_dwordx4 v4, s[4:7], s80 offen offset:0 lds
    buffer_load_dwordx4 v4, s[4:7], s80 offen offset:1024 lds
    buffer_load_dwordx4 v4, s[4:7], s80 offen offset:2048 lds
    buffer_load_dwordx4 v4, s[4:7], s80 offen offset:3072 lds
    s_add_u32 s80, s80, 4096
    s_mov_b32 m0, 49152
    s_nop 0
    buffer_load_dwordx4 v4, s[4:7], s80 offen offset:0 lds
    buffer_load_dwordx4 v4, s[4:7], s80 offen offset:1024 lds
    s_add_u32 s80, s80, 2048
    s_waitcnt vmcnt(30)
    s_cmpk_ge_i32 s44, 60
    s_cbranch_scc0 .Llf127
.Llr128:
    s_mov_b32 m0, 51200
    s_nop 0
    buffer_load_dwordx4 v4, s[4:7], s80 offen offset:0 lds
    buffer_load_dwordx4 v4, s[4:7], s80 offen offset:1024 lds
    buffer_load_dwordx4 v4, s[4:7], s80 offen offset:2048 lds
    buffer_load_dwordx4 v4, s[4:7], s80 offen offset:3072 lds
    s_add_u32 s80, s80, 4096
    s_mov_b32 m0, 55296
    s_nop 0
    buffer_load_dwordx4 v4, s[4:7], s80 offen offset:0 lds
    buffer_load_dwordx4 v4, s[4:7], s80 offen offset:1024 lds
    buffer_load_dwordx4 v4, s[4:7], s80 offen offset:2048 lds
    buffer_load_dwordx4 v4, s[4:7], s80 offen offset:3072 lds
    s_add_u32 s80, s80, 4096
    s_mov_b32 m0, 59392
    s_nop 0
    buffer_load_dwordx4 v4, s[4:7], s80 offen offset:0 lds
    buffer_load_dwordx4 v4, s[4:7], s80 offen offset:1024 lds
    s_add_u32 s80, s80, 2048
    s_waitcnt vmcnt(30)
    s_movk_i32 s94, 218
    s_call_b64 s[46:47], .Lpubnow
    s_cmpk_ge_i32 s44, 70
    s_cbranch_scc0 .Llf129
.Llr130:
    s_mov_b32 m0, 61440
    s_nop 0
    buffer_load_dwordx4 v4, s[4:7], s80 offen offset:0 lds
    buffer_load_dwordx4 v4, s[4:7], s80 offen offset:1024 lds
    buffer_load_dwordx4 v4, s[4:7], s80 offen offset:2048 lds
    buffer_load_dwordx4 v4, s[4:7], s80 offen offset:3072 lds
    s_add_u32 s80, s80, 4096
    s_mov_b32 m0, 65536
    s_nop 0
    buffer_load_dwordx4 v4, s[4:7], s80 offen offset:0 lds
    buffer_load_dwordx4 v4, s[4:7], s80 offen offset:1024 lds
    buffer_load_dwordx4 v4, s[4:7], s80 offen offset:2048 lds
    buffer_load_dwordx4 v4, s[4:7], s80 offen offset:3072 lds
    s_add_u32 s80, s80, 4096
    s_mov_b32 m0, 69632
    s_nop 0
    buffer_load_dwordx4 v4, s[4:7], s80 offen offset:0 lds
    buffer_load_dwordx4 v4, s[4:7], s80 offen offset:1024 lds
    s_add_u32 s80, s80, 2048
    s_waitcnt vmcnt(30)
    s_cmpk_ge_i32 s44, 80
    s_cbranch_scc0 .Llf131
.Llr132:
    s_mov_b32 m0, 71680
    s_nop 0
    buffer_load_dwordx4 v4, s[4:7], s80 offen offset:0 lds
    buffer_load_dwordx4 v4, s[4:7], s80 offen offset:1024 lds
    buffer_load_dwordx4 v4, s[4:7], s80 offen offset:2048 lds
    buffer_load_dwordx4 v4, s[4:7], s80 offen offset:3072 lds
    s_add_u32 s80, s80, 4096
    s_mov_b32 m0, 75776
    s_nop 0
    buffer_load_dwordx4 v4, s[4:7], s80 offen offset:0 lds
    buffer_load_dwordx4 v4, s[4:7], s80 offen offset:1024 lds
    buffer_load_dwordx4 v4, s[4:7], s80 offen offset:2048 lds
    buffer_load_dwordx4 v4, s[4:7], s80 offen offset:3072 lds
    s_add_u32 s80, s80, 4096
    s_mov_b32 m0, 79872
    s_nop 0
    buffer_load_dwordx4 v4, s[4:7], s80 offen offset:0 lds
    buffer_load_dwordx4 v4, s[4:7], s80 offen offset:1024 lds
    s_add_u32 s80, s80, 2048
    s_waitcnt vmcnt(30)
    s_cmpk_ge_i32 s44, 90
    s_cbranch_scc0 .Llf133
.Llr134:
    s_mov_b32 m0, 81920
    s_nop 0
    buffer_load_dwordx4 v4, s[4:7], s80 offen offset:0 lds
    buffer_load_dwordx4 v4, s[4:7], s80 offen offset:1024 lds
    buffer_load_dwordx4 v4, s[4:7], s80 offen offset:2048 lds
    buffer_load_dwordx4 v4, s[4:7], s80 offen offset:3072 lds
    s_add_u32 s80, s80, 4096
    s_mov_b32 m0, 86016
    s_nop 0
    buffer_load_dwordx4 v4, s[4:7], s80 offen offset:0 lds
    buffer_load_dwordx4 v4, s[4:7], s80 offen offset:1024 lds
    buffer_load_dwordx4 v4, s[4:7], s80 offen offset:2048 lds
    buffer_load_dwordx4 v4, s[4:7], s80 offen offset:3072 lds
    s_add_u32 s80, s80, 4096
    s_mov_b32 m0, 90112
    s_nop 0
    buffer_load_dwordx4 v4, s[4:7], s80 offen offset:0 lds
    buffer_load_dwordx4 v4, s[4:7], s80 offen offset:1024 lds
    s_add_u32 s80, s80, 2048
    s_waitcnt vmcnt(30)
    s_movk_i32 s94, 248
    s_call_b64 s[46:47], .Lpubnow
    s_cmpk_ge_i32 s44, 100
    s_cbranch_scc0 .Llf135
.Llr136:
    s_mov_b32 m0, 92160
    s_nop 0
    buffer_load_dwordx4 v4, s[4:7], s80 offen offset:0 lds
    buffer_load_dwordx4 v4, s[4:7], s80 offen offset:1024 lds
    buffer_load_dwordx4 v4, s[4:7], s80 offen offset:2048 lds
    buffer_load_dwordx4 v4, s[4:7], s80 offen offset:3072 lds
    s_add_u32 s80, s80, 4096
    s_mov_b32 m0, 96256
    s_nop 0
    buffer_load_dwordx4 v4, s[4:7], s80 offen offset:0 lds
    buffer_load_dwordx4 v4, s[4:7], s80 offen offset:1024 lds
    buffer_load_dwordx4 v4, s[4:7], s80 offen offset:2048 lds
    buffer_load_dwordx4 v4, s[4:7], s80 offen offset:3072 lds
    s_add_u32 s80, s80, 4096
    s_mov_b32 m0, 100352
    s_nop 0
    buffer_load_dwordx4 v4, s[4:7], s80 offen offset:0 lds
    buffer_load_dwordx4 v4, s[4:7], s80 offen offset:1024 lds
    s_add_u32 s80, s80, 2048
    s_waitcnt vmcnt(30)
    s_cmp_eq_u32 s43, 0
    s_cbranch_scc1 .Lld_c0
    s_movk_i32 s94, 258
    s_call_b64 s[46:47], .Ldrain
    s_cmpk_ge_i32 s44, 158
    s_cbranch_scc0 .Llf137
.Llr138:
    v_add_u32 v14, 102400, v4
    ds_write_b128 v14, v[16:19] offset:0
    ds_write_b128 v14, v[20:23] offset:1024
    ds_write_b128 v14, v[24:27] offset:2048
    ds_write_b128 v14, v[28:31] offset:3072
    ds_write_b128 v14, v[32:35] offset:4096
    ds_write_b128 v14, v[36:39] offset:5120
    ds_write_b128 v14, v[40:43] offset:6144
    ds_write_b128 v14, v[44:47] offset:7168
    ds_write_b128 v14, v[48:51] offset:8192
    ds_write_b128 v14, v[52:55] offset:9216
    ds_write_b128 v14, v[56:59] offset:10240
    ds_write_b128 v14, v[60:63] offset:11264
    ds_write_b128 v14, v[64:67] offset:12288
    ds_write_b128 v14, v[68:71] offset:13312
    ds_write_b128 v14, v[72:75] offset:14336
    ds_write_b128 v14, v[76:79] offset:15360
    ds_write_b128 v14, v[80:83] offset:16384
    ds_write_b128 v14, v[84:87] offset:17408
    ds_write_b128 v14, v[88:91] offset:18432
    ds_write_b128 v14, v[92:95] offset:19456
    ds_write_b128 v14, v[96:99] offset:20480
    ds_write_b128 v14, v[100:103] offset:21504
    ds_write_b128 v14, v[104:107] offset:22528
    ds_write_b128 v14, v[108:111] offset:23552
    ds_write_b128 v14, v[112:115] offset:24576
    ds_write_b128 v14, v[116:119] offset:25600
    ds_write_b128 v14, v[120:123] offset:26624
    ds_write_b128 v14, v[124:127] offset:27648
    ds_write_b128 v14, v[128:131] offset:28672
    ds_write_b128 v14, v[132:135] offset:29696
    ds_write_b128 v14, v[136:139] offset:30720
    ds_write_b128 v14, v[140:143] offset:31744
    ds_write_b128 v14, v[144:147] offset:32768
    ds_write_b128 v14, v[148:151] offset:33792
    ds_write_b128 v14, v[152:155] offset:34816
    ds_write_b128 v14, v[156:159] offset:35840
    ds_write_b128 v14, v[160:163] offset:36864
    ds_write_b128 v14, v[164:167] offset:37888
    ds_write_b128 v14, v[168:171] offset:38912
    ds_write_b128 v14, v[172:175] offset:39936
    ds_write_b128 v14, v[176:179] offset:40960
    ds_write_b128 v14, v[180:183] offset:41984
    ds_write_b128 v14, v[184:187] offset:43008
    ds_write_b128 v14, v[188:191] offset:44032
    ds_write_b128 v14, v[192:195] offset:45056
    ds_write_b128 v14, v[196:199] offset:46080
    ds_write_b128 v14, v[200:203] offset:47104
    ds_write_b128 v14, v[204:207] offset:48128
    ds_write_b128 v14, v[208:211] offset:49152
    ds_write_b128 v14, v[212:215] offset:50176
    ds_write_b128 v14, v[216:219] offset:51200
    ds_write_b128 v14, v[220:223] offset:52224
    ds_write_b128 v14, v[224:227] offset:53248
    ds_write_b128 v14, v[228:231] offset:54272
    ds_write_b128 v14, v[232:235] offset:55296
    ds_write_b128 v14, v[236:239] offset:56320
    ds_write_b128 v14, v[240:243] offset:57344
    ds_write_b128 v14, v[244:247] offset:58368
    v_add_u32 v9, 316, v8
    ds_max_i32 v5, v9
    s_add_u32 s80, s74, 59392
    s_branch .Lld_c1
.Lld_c0:
    s_cmp_lg_u32 s43, 0
    s_cbranch_scc1 .Lfo139
    s_movk_i32 s94, 258
    s_call_b64 s[46:47], .Ldrain
    s_lshl_b32 s69, s40, 7
    s_add_u32 s69, s69, 0x29eb000
    s_mov_b32 exec_lo, 0xfffff
    s_mov_b32 exec_hi, 0x0
.Lp140:
    buffer_load_dword v9, v13, s[4:7], s69 offen sc1
    s_waitcnt vmcnt(0)
    v_cmp_ne_u32 vcc, s41, v9
    s_nop 0
    s_cbranch_vccz .Lpd141
    s_sleep 4
    s_sub_u32 s88, s88, 1
    s_cbranch_scc1 .Lend
    s_branch .Lp140
.Lpd141:
    s_mov_b64 exec, -1
    s_mul_i32 s69, s40, 10240
    s_add_u32 s69, s69, 0x29b0000
    buffer_load_dwordx4 v[32:35], v4, s[4:7], s69 offen offset:0 sc1
    buffer_load_dwordx4 v[36:39], v4, s[4:7], s69 offen offset:1024 sc1
    buffer_load_dwordx4 v[40:43], v4, s[4:7], s69 offen offset:2048 sc1
    buffer_load_dwordx4 v[44:47], v4, s[4:7], s69 offen offset:3072 sc1
    s_add_u32 s69, s69, 4096
    buffer_load_dwordx4 v[48:51], v4, s[4:7], s69 offen offset:0 sc1
    buffer_load_dwordx4 v[52:55], v4, s[4:7], s69 offen offset:1024 sc1
    buffer_load_dwordx4 v[56:59], v4, s[4:7], s69 offen offset:2048 sc1
    buffer_load_dwordx4 v[60:63], v4, s[4:7], s69 offen offset:3072 sc1
    s_add_u32 s69, s69, 4096
    buffer_load_dwordx4 v[64:67], v4, s[4:7], s69 offen offset:0 sc1
    buffer_load_dwordx4 v[68:71], v4, s[4:7], s69 offen offset:1024 sc1
.Lfo139:
    s_add_u32 s80, s74, s78
    s_add_u32 s81, s74, 122880
    s_cmpk_ge_i32 s44, 112
    s_cbranch_scc0 .Llf142
.Llr143:
    s_mov_b32 m0, 102400
    s_nop 0
    buffer_load_dwordx4 v4, s[4:7], s80 offen offset:0 lds
    buffer_load_dwordx4 v4, s[4:7], s80 offen offset:1024 lds
    buffer_load_dwordx4 v4, s[4:7], s80 offen offset:2048 lds
    buffer_load_dwordx4 v4, s[4:7], s80 offen offset:3072 lds
    s_add_u32 s80, s80, 4096
    s_mov_b32 m0, 106496
    s_nop 0
    buffer_load_dwordx4 v4, s[4:7], s80 offen offset:0 lds
    buffer_load_dwordx4 v4, s[4:7], s80 offen offset:1024 lds
    buffer_load_dwordx4 v4, s[4:7], s80 offen offset:2048 lds
    buffer_load_dwordx4 v4, s[4:7], s80 offen offset:3072 lds
    s_add_u32 s80, s80, 4096
    s_mov_b32 m0, 110592
    s_nop 0
    buffer_load_dwordx4 v4, s[4:7], s80 offen offset:0 lds
    buffer_load_dwordx4 v4, s[4:7], s80 offen offset:1024 lds
    buffer_load_dwordx4 v4, s[4:7], s80 offen offset:2048 lds
    buffer_load_dwordx4 v4, s[4:7], s80 offen offset:3072 lds
    s_add_u32 s80, s80, 4096
    s_waitcnt vmcnt(30)
    s_cmpk_ge_i32 s44, 124
    s_cbranch_scc0 .Llf144
.Llr145:
    s_mov_b32 m0, 114688
    s_nop 0
    buffer_load_dwordx4 v4, s[4:7], s80 offen offset:0 lds
    buffer_load_dwordx4 v4, s[4:7], s80 offen offset:1024 lds
    buffer_load_dwordx4 v4, s[4:7], s80 offen offset:2048 lds
    buffer_load_dwordx4 v4, s[4:7], s80 offen offset:3072 lds
    s_add_u32 s80, s80, 4096
    s_mov_b32 m0, 118784
    s_nop 0
    buffer_load_dwordx4 v4, s[4:7], s80 offen offset:0 lds
    buffer_load_dwordx4 v4, s[4:7], s80 offen offset:1024 lds
    buffer_load_dwordx4 v4, s[4:7], s80 offen offset:2048 lds
    buffer_load_dwordx4 v4, s[4:7], s80 offen offset:3072 lds
    s_add_u32 s80, s80, 4096
    s_mov_b32 m0, 122880
    s_nop 0
    buffer_load_dwordx4 v4, s[4:7], s80 offen offset:0 lds
    buffer_load_dwordx4 v4, s[4:7], s80 offen offset:1024 lds
    buffer_load_dwordx4 v4, s[4:7], s80 offen offset:2048 lds
    buffer_load_dwordx4 v4, s[4:7], s80 offen offset:3072 lds
    s_add_u32 s80, s80, 4096
    s_waitcnt vmcnt(30)
    s_movk_i32 s94, 282
    s_call_b64 s[46:47], .Lpubnow
    s_cmp_lg_u32 s43, 0
    s_cbranch_scc1 .Lfo146
    s_waitcnt vmcnt(24)
    s_setprio 3
    v_add_f32 v32, v32, v36
    v_add_f32 v33, v33, v37
    v_add_f32 v34, v34, v38
    v_add_f32 v35, v35, v39
    v_add_f32 v32, v32, v40
    v_add_f32 v33, v33, v41
    v_add_f32 v34, v34, v42
    v_add_f32 v35, v35, v43
    v_add_f32 v32, v32, v44
    v_add_f32 v33, v33, v45
    v_add_f32 v34, v34, v46
    v_add_f32 v35, v35, v47
    v_add_f32 v32, v32, v48
    v_add_f32 v33, v33, v49
    v_add_f32 v34, v34, v50
    v_add_f32 v35, v35, v51
    v_add_f32 v32, v32, v52
    v_add_f32 v33, v33, v53
    v_add_f32 v34, v34, v54
    v_add_f32 v35, v35, v55
    v_add_f32 v32, v32, v56
    v_add_f32 v33, v33, v57
    v_add_f32 v34, v34, v58
    v_add_f32 v35, v35, v59
    v_add_f32 v32, v32, v60
    v_add_f32 v33, v33, v61
    v_add_f32 v34, v34, v62
    v_add_f32 v35, v35, v63
    v_add_f32 v32, v32, v64
    v_add_f32 v33, v33, v65
    v_add_f32 v34, v34, v66
    v_add_f32 v35, v35, v67
    v_add_f32 v32, v32, v68
    v_add_f32 v33, v33, v69
    v_add_f32 v34, v34, v70
    v_add_f32 v35, v35, v71
    v_mov_b32 v36, v32
    v_mov_b32 v37, v33
    v_mov_b32 v38, v34
    v_mov_b32 v39, v35
    v_permlane32_swap_b32 v32, v36
    v_permlane32_swap_b32 v33, v37
    v_permlane32_swap_b32 v34, v38
    v_permlane32_swap_b32 v35, v39
    v_add_f32 v32, v32, v36
    v_add_f32 v33, v33, v37
    v_add_f32 v34, v34, v38
    v_add_f32 v35, v35, v39
    v_add_u32 v14, 162400, v4
    s_mov_b32 exec_lo, 0xffffff
    s_mov_b32 exec_hi, 0
    ds_write_b128 v14, v[32:35]
    s_mov_b64 exec, -1
    s_setprio 0
.Lfo146:
    s_cmpk_ge_i32 s44, 136
    s_cbranch_scc0 .Llf147
.Llr148:
    s_mov_b32 m0, 126976
    s_nop 0
    buffer_load_dwordx4 v4, s[4:7], s80 offen offset:0 lds
    buffer_load_dwordx4 v4, s[4:7], s80 offen offset:1024 lds
    buffer_load_dwordx4 v4, s[4:7], s80 offen offset:2048 lds
    buffer_load_dwordx4 v4, s[4:7], s80 offen offset:3072 lds
    s_add_u32 s80, s80, 4096
    s_mov_b32 m0, 131072
    s_nop 0
    buffer_load_dwordx4 v4, s[4:7], s80 offen offset:0 lds
    buffer_load_dwordx4 v4, s[4:7], s80 offen offset:1024 lds
    buffer_load_dwordx4 v4, s[4:7], s80 offen offset:2048 lds
    buffer_load_dwordx4 v4, s[4:7], s80 offen offset:3072 lds
    s_add_u32 s80, s80, 4096
    s_mov_b32 m0, 135168
    s_nop 0
    buffer_load_dwordx4 v4, s[4:7], s80 offen offset:0 lds
    buffer_load_dwordx4 v4, s[4:7], s80 offen offset:1024 lds
    buffer_load_dwordx4 v4, s[4:7], s80 offen offset:2048 lds
    buffer_load_dwordx4 v4, s[4:7], s80 offen offset:3072 lds
    s_add_u32 s80, s80, 4096
    s_waitcnt vmcnt(30)
    s_cmpk_ge_i32 s44, 148
    s_cbranch_scc0 .Llf149
.Llr150:
    s_mov_b32 m0, 139264
    s_nop 0
    buffer_load_dwordx4 v4, s[4:7], s80 offen offset:0 lds
    buffer_load_dwordx4 v4, s[4:7], s80 offen offset:1024 lds
    buffer_load_dwordx4 v4, s[4:7], s80 offen offset:2048 lds
    buffer_load_dwordx4 v4, s[4:7], s80 offen offset:3072 lds
    s_add_u32 s80, s80, 4096
    s_mov_b32 m0, 143360
    s_nop 0
    buffer_load_dwordx4 v4, s[4:7], s80 offen offset:0 lds
    buffer_load_dwordx4 v4, s[4:7], s80 offen offset:1024 lds
    buffer_load_dwordx4 v4, s[4:7], s80 offen offset:2048 lds
    buffer_load_dwordx4 v4, s[4:7], s80 offen offset:3072 lds
    s_add_u32 s80, s80, 4096
    s_mov_b32 m0, 147456
    s_nop 0
    buffer_load_dwordx4 v4, s[4:7], s80 offen offset:0 lds
    buffer_load_dwordx4 v4, s[4:7], s80 offen offset:1024 lds
    buffer_load_dwordx4 v4, s[4:7], s80 offen offset:2048 lds
    buffer_load_dwordx4 v4, s[4:7], s80 offen offset:3072 lds
    s_add_u32 s80, s80, 4096
    s_waitcnt vmcnt(30)
    s_cmpk_ge_i32 s44, 158
    s_cbranch_scc0 .Llf151
.Llr152:
    s_mov_b32 m0, 151552
    s_nop 0
    buffer_load_dwordx4 v4, s[4:7], s80 offen offset:0 lds
    buffer_load_dwordx4 v4, s[4:7], s80 offen offset:1024 lds
    buffer_load_dwordx4 v4, s[4:7], s80 offen offset:2048 lds
    buffer_load_dwordx4 v4, s[4:7], s80 offen offset:3072 lds
    s_add_u32 s80, s80, 4096
    s_mov_b32 m0, 155648
    s_nop 0
    buffer_load_dwordx4 v4, s[4:7], s80 offen offset:0 lds
    buffer_load_dwordx4 v4, s[4:7], s80 offen offset:1024 lds
    buffer_load_dwordx4 v4, s[4:7], s80 offen offset:2048 lds
    buffer_load_dwordx4 v4, s[4:7], s80 offen offset:3072 lds
    s_add_u32 s80, s80, 4096
    s_mov_b32 m0, 159744
    s_nop 0
    buffer_load_dwordx4 v4, s[4:7], s80 offen offset:0 lds
    buffer_load_dwordx4 v4, s[4:7], s80 offen offset:1024 lds
    s_add_u32 s80, s80, 2048
    s_waitcnt vmcnt(30)
    s_movk_i32 s94, 316
    s_call_b64 s[46:47], .Lpubnow
    s_movk_i32 s94, 316
    s_call_b64 s[46:47], .Ldrain
    v_add_u32 v14, 102400, v4
    ds_read_b128 v[16:19], v14 offset:0
    ds_read_b128 v[20:23], v14 offset:1024
    ds_read_b128 v[24:27], v14 offset:2048
    ds_read_b128 v[28:31], v14 offset:3072
    ds_read_b128 v[32:35], v14 offset:4096
    ds_read_b128 v[36:39], v14 offset:5120
    ds_read_b128 v[40:43], v14 offset:6144
    ds_read_b128 v[44:47], v14 offset:7168
    ds_read_b128 v[48:51], v14 offset:8192
    ds_read_b128 v[52:55], v14 offset:9216
    ds_read_b128 v[56:59], v14 offset:10240
    ds_read_b128 v[60:63], v14 offset:11264
    ds_read_b128 v[64:67], v14 offset:12288
    ds_read_b128 v[68:71], v14 offset:13312
    ds_read_b128 v[72:75], v14 offset:14336
    ds_read_b128 v[76:79], v14 offset:15360
    ds_read_b128 v[80:83], v14 offset:16384
    ds_read_b128 v[84:87], v14 offset:17408
    ds_read_b128 v[88:91], v14 offset:18432
    ds_read_b128 v[92:95], v14 offset:19456
    ds_read_b128 v[96:99], v14 offset:20480
    ds_read_b128 v[100:103], v14 offset:21504
    ds_read_b128 v[104:107], v14 offset:22528
    ds_read_b128 v[108:111], v14 offset:23552
    ds_read_b128 v[112:115], v14 offset:24576
    ds_read_b128 v[116:119], v14 offset:25600
    ds_read_b128 v[120:123], v14 offset:26624
    ds_read_b128 v[124:127], v14 offset:27648
    ds_read_b128 v[128:131], v14 offset:28672
    ds_read_b128 v[132:135], v14 offset:29696
    ds_read_b128 v[136:139], v14 offset:30720
    ds_read_b128 v[140:143], v14 offset:31744
    ds_read_b128 v[144:147], v14 offset:32768
    ds_read_b128 v[148:151], v14 offset:33792
    ds_read_b128 v[152:155], v14 offset:34816
    ds_read_b128 v[156:159], v14 offset:35840
    ds_read_b128 v[160:163], v14 offset:36864
    ds_read_b128 v[164:167], v14 offset:37888
    ds_read_b128 v[168:171], v14 offset:38912
    ds_read_b128 v[172:175], v14 offset:39936
    ds_read_b128 v[176:179], v14 offset:40960
    ds_read_b128 v[180:183], v14 offset:41984
    ds_read_b128 v[184:187], v14 offset:43008
    ds_read_b128 v[188:191], v14 offset:44032
    ds_read_b128 v[192:195], v14 offset:45056
    ds_read_b128 v[196:199], v14 offset:46080
    ds_read_b128 v[200:203], v14 offset:47104
    ds_read_b128 v[204:207], v14 offset:48128
    ds_read_b128 v[208:211], v14 offset:49152
    ds_read_b128 v[212:215], v14 offset:50176
    ds_read_b128 v[216:219], v14 offset:51200
    ds_read_b128 v[220:223], v14 offset:52224
    ds_read_b128 v[224:227], v14 offset:53248
    ds_read_b128 v[228:231], v14 offset:54272
    ds_read_b128 v[232:235], v14 offset:55296
    ds_read_b128 v[236:239], v14 offset:56320
    ds_read_b128 v[240:243], v14 offset:57344
    ds_read_b128 v[244:247], v14 offset:58368
    s_waitcnt lgkmcnt(0)
.Lld_c1:
    s_cmpk_ge_i32 s44, 168
    s_cbranch_scc0 .Llf153
.Llr154:
    s_mov_b32 m0, 0
    s_nop 0
    buffer_load_dwordx4 v4, s[4:7], s80 offen offset:0 lds
    buffer_load_dwordx4 v4, s[4:7], s80 offen offset:1024 lds
    buffer_load_dwordx4 v4, s[4:7], s80 offen offset:2048 lds
    buffer_load_dwordx4 v4, s[4:7], s80 offen offset:3072 lds
    s_add_u32 s80, s80, 4096
    s_mov_b32 m0, 4096
    s_nop 0
    buffer_load_dwordx4 v4, s[4:7], s80 offen offset:0 lds
    buffer_load_dwordx4 v4, s[4:7], s80 offen offset:1024 lds
    buffer_load_dwordx4 v4, s[4:7], s80 offen offset:2048 lds
    buffer_load_dwordx4 v4, s[4:7], s80 offen offset:3072 lds
    s_add_u32 s80, s80, 4096
    s_mov_b32 m0, 8192
    s_nop 0
    buffer_load_dwordx4 v4, s[4:7], s80 offen offset:0 lds
    buffer_load_dwordx4 v4, s[4:7], s80 offen offset:1024 lds
    s_add_u32 s80, s80, 2048
    s_waitcnt vmcnt(30)
    s_cmpk_ge_i32 s44, 178
    s_cbranch_scc0 .Llf155
.Llr156:
    s_mov_b32 m0, 10240
    s_nop 0
    buffer_load_dwordx4 v4, s[4:7], s80 offen offset:0 lds
    buffer_load_dwordx4 v4, s[4:7], s80 offen offset:1024 lds
    buffer_load_dwordx4 v4, s[4:7], s80 offen offset:2048 lds
    buffer_load_dwordx4 v4, s[4:7], s80 offen offset:3072 lds
    s_add_u32 s80, s80, 4096
    s_mov_b32 m0, 14336
    s_nop 0
    buffer_load_dwordx4 v4, s[4:7], s80 offen offset:0 lds
    buffer_load_dwordx4 v4, s[4:7], s80 offen offset:1024 lds
    buffer_load_dwordx4 v4, s[4:7], s80 offen offset:2048 lds
    buffer_load_dwordx4 v4, s[4:7], s80 offen offset:3072 lds
    s_add_u32 s80, s80, 4096
    s_mov_b32 m0, 18432
    s_nop 0
    buffer_load_dwordx4 v4, s[4:7], s80 offen offset:0 lds
    buffer_load_dwordx4 v4, s[4:7], s80 offen offset:1024 lds
    s_add_u32 s80, s80, 2048
    s_waitcnt vmcnt(30)
    s_cmpk_ge_i32 s44, 188
    s_cbranch_scc0 .Llf157
.Llr158:
    s_mov_b32 m0, 20480
    s_nop 0
    buffer_load_dwordx4 v4, s[4:7], s80 offen offset:0 lds
    buffer_load_dwordx4 v4, s[4:7], s80 offen offset:1024 lds
    buffer_load_dwordx4 v4, s[4:7], s80 offen offset:2048 lds
    buffer_load_dwordx4 v4, s[4:7], s80 offen offset:3072 lds
    s_add_u32 s80, s80, 4096
    s_mov_b32 m0, 24576
    s_nop 0
    buffer_load_dwordx4 v4, s[4:7], s80 offen offset:0 lds
    buffer_load_dwordx4 v4, s[4:7], s80 offen offset:1024 lds
    buffer_load_dwordx4 v4, s[4:7], s80 offen offset:2048 lds
    buffer_load_dwordx4 v4, s[4:7], s80 offen offset:3072 lds
    s_add_u32 s80, s80, 4096
    s_mov_b32 m0, 28672
    s_nop 0
    buffer_load_dwordx4 v4, s[4:7], s80 offen offset:0 lds
    buffer_load_dwordx4 v4, s[4:7], s80 offen offset:1024 lds
    s_add_u32 s80, s80, 2048
    s_waitcnt vmcnt(30)
    s_movk_i32 s94, 346
    s_call_b64 s[46:47], .Lpubnow
    s_cmp_lg_u32 s43, 0
    s_cbranch_scc1 .Lld_second
    s_cmpk_ge_i32 s44, 200
    s_cbranch_scc0 .Llf159
.Llr160:
    s_mov_b32 m0, 30720
    s_nop 0
    buffer_load_dwordx4 v4, s[4:7], s80 offen offset:0 lds
    buffer_load_dwordx4 v4, s[4:7], s80 offen offset:1024 lds
    buffer_load_dwordx4 v4, s[4:7], s80 offen offset:2048 lds
    buffer_load_dwordx4 v4, s[4:7], s80 offen offset:3072 lds
    s_add_u32 s80, s80, 4096
    s_mov_b32 m0, 34816
    s_nop 0
    buffer_load_dwordx4 v4, s[4:7], s80 offen offset:0 lds
    buffer_load_dwordx4 v4, s[4:7], s80 offen offset:1024 lds
    buffer_load_dwordx4 v4, s[4:7], s80 offen offset:2048 lds
    buffer_load_dwordx4 v4, s[4:7], s80 offen offset:3072 lds
    s_add_u32 s80, s80, 4096
    s_mov_b32 m0, 38912
    s_nop 0
    buffer_load_dwordx4 v4, s[4:7], s80 offen offset:0 lds
    buffer_load_dwordx4 v4, s[4:7], s80 offen offset:1024 lds
    buffer_load_dwordx4 v4, s[4:7], s80 offen offset:2048 lds
    buffer_load_dwordx4 v4, s[4:7], s80 offen offset:3072 lds
    s_add_u32 s80, s80, 4096
    s_waitcnt vmcnt(30)
    s_cmpk_ge_i32 s44, 210
    s_cbranch_scc0 .Llf161
.Llr162:
    s_mov_b32 m0, 43008
    s_nop 0
    buffer_load_dwordx4 v4, s[4:7], s80 offen offset:0 lds
    buffer_load_dwordx4 v4, s[4:7], s80 offen offset:1024 lds
    buffer_load_dwordx4 v4, s[4:7], s80 offen offset:2048 lds
    buffer_load_dwordx4 v4, s[4:7], s80 offen offset:3072 lds
    s_add_u32 s80, s80, 4096
    s_mov_b32 m0, 47104
    s_nop 0
    buffer_load_dwordx4 v4, s[4:7], s80 offen offset:0 lds
    buffer_load_dwordx4 v4, s[4:7], s80 offen offset:1024 lds
    buffer_load_dwordx4 v4, s[4:7], s80 offen offset:2048 lds
    buffer_load_dwordx4 v4, s[4:7], s80 offen offset:3072 lds
    s_add_u32 s80, s80, 4096
    s_mov_b32 m0, 51200
    s_nop 0
    buffer_load_dwordx4 v4, s[4:7], s80 offen offset:0 lds
    buffer_load_dwordx4 v4, s[4:7], s80 offen offset:1024 lds
    s_add_u32 s80, s80, 2048
    s_waitcnt vmcnt(30)
    s_cmpk_ge_i32 s44, 220
    s_cbranch_scc0 .Llf163
.Llr164:
    s_mov_b32 m0, 53248
    s_nop 0
    buffer_load_dwordx4 v4, s[4:7], s80 offen offset:0 lds
    buffer_load_dwordx4 v4, s[4:7], s80 offen offset:1024 lds
    buffer_load_dwordx4 v4, s[4:7], s80 offen offset:2048 lds
    buffer_load_dwordx4 v4, s[4:7], s80 offen offset:3072 lds
    s_add_u32 s80, s80, 4096
    s_mov_b32 m0, 57344
    s_nop 0
    buffer_load_dwordx4 v4, s[4:7], s80 offen offset:0 lds
    buffer_load_dwordx4 v4, s[4:7], s80 offen offset:1024 lds
    buffer_load_dwordx4 v4, s[4:7], s80 offen offset:2048 lds
    buffer_load_dwordx4 v4, s[4:7], s80 offen offset:3072 lds
    s_add_u32 s80, s80, 4096
    s_mov_b32 m0, 61440
    s_nop 0
    buffer_load_dwordx4 v4, s[4:7], s80 offen offset:0 lds
    buffer_load_dwordx4 v4, s[4:7], s80 offen offset:1024 lds
    s_add_u32 s80, s80, 2048
    s_waitcnt vmcnt(30)
    s_movk_i32 s94, 378
    s_call_b64 s[46:47], .Lpubnow
    s_movk_i32 s94, 378
    s_call_b64 s[46:47], .Ldrain
    s_lshl_b32 s69, s60, 7
    s_add_u32 s69, s69, 0x29eb800
    s_mov_b32 exec_lo, 0xffffff
    s_mov_b32 exec_hi, 0x0
.Lp165:
    buffer_load_dword v9, v13, s[4:7], s69 offen sc1
    s_waitcnt vmcnt(0)
    v_cmp_ne_u32 vcc, s41, v9
    s_nop 0
    s_cbranch_vccz .Lpd166
    s_sleep 4
    s_sub_u32 s88, s88, 1
    s_cbranch_scc1 .Lend
    s_branch .Lp165
.Lpd166:
    s_mov_b64 exec, -1
    s_add_u32 s80, s75, s79
    s_add_u32 s81, s75, 122880
    s_cmpk_ge_i32 s44, 236
    s_cbranch_scc0 .Llf167
.Llr168:
    s_mov_b32 m0, 69632
    s_nop 0
    buffer_load_dwordx4 v4, s[4:7], s80 offen offset:0 lds
    buffer_load_dwordx4 v4, s[4:7], s80 offen offset:1024 lds
    buffer_load_dwordx4 v4, s[4:7], s80 offen offset:2048 lds
    buffer_load_dwordx4 v4, s[4:7], s80 offen offset:3072 lds
    s_add_u32 s80, s80, 4096
    s_mov_b32 m0, 73728
    s_nop 0
    buffer_load_dwordx4 v4, s[4:7], s80 offen offset:0 lds
    buffer_load_dwordx4 v4, s[4:7], s80 offen offset:1024 lds
    buffer_load_dwordx4 v4, s[4:7], s80 offen offset:2048 lds
    buffer_load_dwordx4 v4, s[4:7], s80 offen offset:3072 lds
    s_add_u32 s80, s80, 4096
    s_mov_b32 m0, 77824
    s_nop 0
    buffer_load_dwordx4 v4, s[4:7], s80 offen offset:0 lds
    buffer_load_dwordx4 v4, s[4:7], s80 offen offset:1024 lds
    s_add_u32 s80, s80, 2048
    s_waitcnt vmcnt(30)
    s_cmpk_ge_i32 s44, 246
    s_cbranch_scc0 .Llf169
.Llr170:
    s_mov_b32 m0, 79872
    s_nop 0
    buffer_load_dwordx4 v4, s[4:7], s80 offen offset:0 lds
    buffer_load_dwordx4 v4, s[4:7], s80 offen offset:1024 lds
    buffer_load_dwordx4 v4, s[4:7], s80 offen offset:2048 lds
    buffer_load_dwordx4 v4, s[4:7], s80 offen offset:3072 lds
    s_add_u32 s80, s80, 4096
    s_mov_b32 m0, 83968
    s_nop 0
    buffer_load_dwordx4 v4, s[4:7], s80 offen offset:0 lds
    buffer_load_dwordx4 v4, s[4:7], s80 offen offset:1024 lds
    buffer_load_dwordx4 v4, s[4:7], s80 offen offset:2048 lds
    buffer_load_dwordx4 v4, s[4:7], s80 offen offset:3072 lds
    s_add_u32 s80, s80, 4096
    s_mov_b32 m0, 88064
    s_nop 0
    buffer_load_dwordx4 v4, s[4:7], s80 offen offset:0 lds
    buffer_load_dwordx4 v4, s[4:7], s80 offen offset:1024 lds
    s_add_u32 s80, s80, 2048
    s_waitcnt vmcnt(30)
    s_cmpk_ge_i32 s44, 256
    s_cbranch_scc0 .Llf171
.Llr172:
    s_mov_b32 m0, 90112
    s_nop 0
    buffer_load_dwordx4 v4, s[4:7], s80 offen offset:0 lds
    buffer_load_dwordx4 v4, s[4:7], s80 offen offset:1024 lds
    buffer_load_dwordx4 v4, s[4:7], s80 offen offset:2048 lds
    buffer_load_dwordx4 v4, s[4:7], s80 offen offset:3072 lds
    s_add_u32 s80, s80, 4096
    s_mov_b32 m0, 94208
    s_nop 0
    buffer_load_dwordx4 v4, s[4:7], s80 offen offset:0 lds
    buffer_load_dwordx4 v4, s[4:7], s80 offen offset:1024 lds
    buffer_load_dwordx4 v4, s[4:7], s80 offen offset:2048 lds
    buffer_load_dwordx4 v4, s[4:7], s80 offen offset:3072 lds
    s_add_u32 s80, s80, 4096
    s_mov_b32 m0, 98304
    s_nop 0
    buffer_load_dwordx4 v4, s[4:7], s80 offen offset:0 lds
    buffer_load_dwordx4 v4, s[4:7], s80 offen offset:1024 lds
    s_add_u32 s80, s80, 2048
    s_waitcnt vmcnt(30)
    s_movk_i32 s94, 414
    s_call_b64 s[46:47], .Lpubnow
    s_cmpk_ge_i32 s44, 266
    s_cbranch_scc0 .Llf173
.Llr174:
    s_mov_b32 m0, 100352
    s_nop 0
    buffer_load_dwordx4 v4, s[4:7], s80 offen offset:0 lds
    buffer_load_dwordx4 v4, s[4:7], s80 offen offset:1024 lds
    buffer_load_dwordx4 v4, s[4:7], s80 offen offset:2048 lds
    buffer_load_dwordx4 v4, s[4:7], s80 offen offset:3072 lds
    s_add_u32 s80, s80, 4096
    s_mov_b32 m0, 104448
    s_nop 0
    buffer_load_dwordx4 v4, s[4:7], s80 offen offset:0 lds
    buffer_load_dwordx4 v4, s[4:7], s80 offen offset:1024 lds
    buffer_load_dwordx4 v4, s[4:7], s80 offen offset:2048 lds
    buffer_load_dwordx4 v4, s[4:7], s80 offen offset:3072 lds
    s_add_u32 s80, s80, 4096
    s_mov_b32 m0, 108544
    s_nop 0
    buffer_load_dwordx4 v4, s[4:7], s80 offen offset:0 lds
    buffer_load_dwordx4 v4, s[4:7], s80 offen offset:1024 lds
    s_add_u32 s80, s80, 2048
    s_waitcnt vmcnt(30)
    s_cmpk_ge_i32 s44, 276
    s_cbranch_scc0 .Llf175
.Llr176:
    s_mov_b32 m0, 110592
    s_nop 0
    buffer_load_dwordx4 v4, s[4:7], s80 offen offset:0 lds
    buffer_load_dwordx4 v4, s[4:7], s80 offen offset:1024 lds
    buffer_load_dwordx4 v4, s[4:7], s80 offen offset:2048 lds
    buffer_load_dwordx4 v4, s[4:7], s80 offen offset:3072 lds
    s_add_u32 s80, s80, 4096
    s_mov_b32 m0, 114688
    s_nop 0
    buffer_load_dwordx4 v4, s[4:7], s80 offen offset:0 lds
    buffer_load_dwordx4 v4, s[4:7], s80 offen offset:1024 lds
    buffer_load_dwordx4 v4, s[4:7], s80 offen offset:2048 lds
    buffer_load_dwordx4 v4, s[4:7], s80 offen offset:3072 lds
    s_add_u32 s80, s80, 4096
    s_mov_b32 m0, 118784
    s_nop 0
    buffer_load_dwordx4 v4, s[4:7], s80 offen offset:0 lds
    buffer_load_dwordx4 v4, s[4:7], s80 offen offset:1024 lds
    s_add_u32 s80, s80, 2048
    s_waitcnt vmcnt(30)
    s_cmpk_ge_i32 s44, 286
    s_cbranch_scc0 .Llf177
.Llr178:
    s_mov_b32 m0, 120832
    s_nop 0
    buffer_load_dwordx4 v4, s[4:7], s80 offen offset:0 lds
    buffer_load_dwordx4 v4, s[4:7], s80 offen offset:1024 lds
    buffer_load_dwordx4 v4, s[4:7], s80 offen offset:2048 lds
    buffer_load_dwordx4 v4, s[4:7], s80 offen offset:3072 lds
    s_add_u32 s80, s80, 4096
    s_mov_b32 m0, 124928
    s_nop 0
    buffer_load_dwordx4 v4, s[4:7], s80 offen offset:0 lds
    buffer_load_dwordx4 v4, s[4:7], s80 offen offset:1024 lds
    buffer_load_dwordx4 v4, s[4:7], s80 offen offset:2048 lds
    buffer_load_dwordx4 v4, s[4:7], s80 offen offset:3072 lds
    s_add_u32 s80, s80, 4096
    s_mov_b32 m0, 129024
    s_nop 0
    buffer_load_dwordx4 v4, s[4:7], s80 offen offset:0 lds
    buffer_load_dwordx4 v4, s[4:7], s80 offen offset:1024 lds
    s_add_u32 s80, s80, 2048
    s_waitcnt vmcnt(30)
    s_movk_i32 s94, 444
    s_call_b64 s[46:47], .Lpubnow
    s_cmpk_ge_i32 s44, 296
    s_cbranch_scc0 .Llf179
.Llr180:
    s_mov_b32 m0, 131072
    s_nop 0
    buffer_load_dwordx4 v4, s[4:7], s80 offen offset:0 lds
    buffer_load_dwordx4 v4, s[4:7], s80 offen offset:1024 lds
    buffer_load_dwordx4 v4, s[4:7], s80 offen offset:2048 lds
    buffer_load_dwordx4 v4, s[4:7], s80 offen offset:3072 lds
    s_add_u32 s80, s80, 4096
    s_mov_b32 m0, 135168
    s_nop 0
    buffer_load_dwordx4 v4, s[4:7], s80 offen offset:0 lds
    buffer_load_dwordx4 v4, s[4:7], s80 offen offset:1024 lds
    buffer_load_dwordx4 v4, s[4:7], s80 offen offset:2048 lds
    buffer_load_dwordx4 v4, s[4:7], s80 offen offset:3072 lds
    s_add_u32 s80, s80, 4096
    s_mov_b32 m0, 139264
    s_nop 0
    buffer_load_dwordx4 v4, s[4:7], s80 offen offset:0 lds
    buffer_load_dwordx4 v4, s[4:7], s80 offen offset:1024 lds
    s_add_u32 s80, s80, 2048
    s_waitcnt vmcnt(30)
    s_cmpk_ge_i32 s44, 306
    s_cbranch_scc0 .Llf181
.Llr182:
    s_mov_b32 m0, 141312
    s_nop 0
    buffer_load_dwordx4 v4, s[4:7], s80 offen offset:0 lds
    buffer_load_dwordx4 v4, s[4:7], s80 offen offset:1024 lds
    buffer_load_dwordx4 v4, s[4:7], s80 offen offset:2048 lds
    buffer_load_dwordx4 v4, s[4:7], s80 offen offset:3072 lds
    s_add_u32 s80, s80, 4096
    s_mov_b32 m0, 145408
    s_nop 0
    buffer_load_dwordx4 v4, s[4:7], s80 offen offset:0 lds
    buffer_load_dwordx4 v4, s[4:7], s80 offen offset:1024 lds
    buffer_load_dwordx4 v4, s[4:7], s80 offen offset:2048 lds
    buffer_load_dwordx4 v4, s[4:7], s80 offen offset:3072 lds
    s_add_u32 s80, s80, 4096
    s_mov_b32 m0, 149504
    s_nop 0
    buffer_load_dwordx4 v4, s[4:7], s80 offen offset:0 lds
    buffer_load_dwordx4 v4, s[4:7], s80 offen offset:1024 lds
    s_add_u32 s80, s80, 2048
    s_waitcnt vmcnt(30)
    s_cmpk_ge_i32 s44, 316
    s_cbranch_scc0 .Llf183
.Llr184:
    s_mov_b32 m0, 151552
    s_nop 0
    buffer_load_dwordx4 v4, s[4:7], s80 offen offset:0 lds
    buffer_load_dwordx4 v4, s[4:7], s80 offen offset:1024 lds
    buffer_load_dwordx4 v4, s[4:7], s80 offen offset:2048 lds
    buffer_load_dwordx4 v4, s[4:7], s80 offen offset:3072 lds
    s_add_u32 s80, s80, 4096
    s_mov_b32 m0, 155648
    s_nop 0
    buffer_load_dwordx4 v4, s[4:7], s80 offen offset:0 lds
    buffer_load_dwordx4 v4, s[4:7], s80 offen offset:1024 lds
    buffer_load_dwordx4 v4, s[4:7], s80 offen offset:2048 lds
    buffer_load_dwordx4 v4, s[4:7], s80 offen offset:3072 lds
    s_add_u32 s80, s80, 4096
    s_mov_b32 m0, 159744
    s_nop 0
    buffer_load_dwordx4 v4, s[4:7], s80 offen offset:0 lds
    buffer_load_dwordx4 v4, s[4:7], s80 offen offset:1024 lds
    s_add_u32 s80, s80, 2048
    s_waitcnt vmcnt(30)
    s_movk_i32 s94, 474
    s_call_b64 s[46:47], .Lpubnow
    s_cmpk_ge_i32 s44, 326
    s_cbranch_scc0 .Llf185
.Llr186:
    s_mov_b32 m0, 0
    s_nop 0
    buffer_load_dwordx4 v4, s[4:7], s80 offen offset:0 lds
    buffer_load_dwordx4 v4, s[4:7], s80 offen offset:1024 lds
    buffer_load_dwordx4 v4, s[4:7], s80 offen offset:2048 lds
    buffer_load_dwordx4 v4, s[4:7], s80 offen offset:3072 lds
    s_add_u32 s80, s80, 4096
    s_mov_b32 m0, 4096
    s_nop 0
    buffer_load_dwordx4 v4, s[4:7], s80 offen offset:0 lds
    buffer_load_dwordx4 v4, s[4:7], s80 offen offset:1024 lds
    buffer_load_dwordx4 v4, s[4:7], s80 offen offset:2048 lds
    buffer_load_dwordx4 v4, s[4:7], s80 offen offset:3072 lds
    s_add_u32 s80, s80, 4096
    s_mov_b32 m0, 8192
    s_nop 0
    buffer_load_dwordx4 v4, s[4:7], s80 offen offset:0 lds
    buffer_load_dwordx4 v4, s[4:7], s80 offen offset:1024 lds
    s_add_u32 s80, s80, 2048
    s_waitcnt vmcnt(30)
    s_cmpk_ge_i32 s44, 336
    s_cbranch_scc0 .Llf187
.Llr188:
    s_mov_b32 m0, 10240
    s_nop 0
    buffer_load_dwordx4 v4, s[4:7], s80 offen offset:0 lds
    buffer_load_dwordx4 v4, s[4:7], s80 offen offset:1024 lds
    buffer_load_dwordx4 v4, s[4:7], s80 offen offset:2048 lds
    buffer_load_dwordx4 v4, s[4:7], s80 offen offset:3072 lds
    s_add_u32 s80, s80, 4096
    s_mov_b32 m0, 14336
    s_nop 0
    buffer_load_dwordx4 v4, s[4:7], s80 offen offset:0 lds
    buffer_load_dwordx4 v4, s[4:7], s80 offen offset:1024 lds
    buffer_load_dwordx4 v4, s[4:7], s80 offen offset:2048 lds
    buffer_load_dwordx4 v4, s[4:7], s80 offen offset:3072 lds
    s_add_u32 s80, s80, 4096
    s_mov_b32 m0, 18432
    s_nop 0
    buffer_load_dwordx4 v4, s[4:7], s80 offen offset:0 lds
    buffer_load_dwordx4 v4, s[4:7], s80 offen offset:1024 lds
    s_add_u32 s80, s80, 2048
    s_waitcnt vmcnt(30)
    s_cmpk_ge_i32 s44, 346
    s_cbranch_scc0 .Llf189
.Llr190:
    s_mov_b32 m0, 20480
    s_nop 0
    buffer_load_dwordx4 v4, s[4:7], s80 offen offset:0 lds
    buffer_load_dwordx4 v4, s[4:7], s80 offen offset:1024 lds
    buffer_load_dwordx4 v4, s[4:7], s80 offen offset:2048 lds
    buffer_load_dwordx4 v4, s[4:7], s80 offen offset:3072 lds
    s_add_u32 s80, s80, 4096
    s_mov_b32 m0, 24576
    s_nop 0
    buffer_load_dwordx4 v4, s[4:7], s80 offen offset:0 lds
    buffer_load_dwordx4 v4, s[4:7], s80 offen offset:1024 lds
    buffer_load_dwordx4 v4, s[4:7], s80 offen offset:2048 lds
    buffer_load_dwordx4 v4, s[4:7], s80 offen offset:3072 lds
    s_add_u32 s80, s80, 4096
    s_mov_b32 m0, 28672
    s_nop 0
    buffer_load_dwordx4 v4, s[4:7], s80 offen offset:0 lds
    buffer_load_dwordx4 v4, s[4:7], s80 offen offset:1024 lds
    s_add_u32 s80, s80, 2048
    s_waitcnt vmcnt(30)
    s_movk_i32 s94, 504
    s_call_b64 s[46:47], .Lpubnow
    s_movk_i32 s94, 504
    s_call_b64 s[46:47], .Ldrain
    s_movk_i32 s43, 632
    s_sub_u32 s44, s44, 632
    v_mov_b32 v8, 632
.Lag191:
    ds_read_b128 v[248:251], v6 offset:64
    s_waitcnt lgkmcnt(0)
    v_min3_i32 v248, v249, v250, v251
    v_add_u32 v9, 150, v8
    v_min_i32 v248, v248, v9
    ds_max_i32 v5, v248
    v_cmp_lt_i32 vcc, v248, v9
    s_sleep 2
    s_sub_u32 s88, s88, 1
    s_cbranch_scc1 .Lend
    s_cbranch_vccnz .Lag191
    s_branch .Lloop_ld
.Lld_second:
    s_movk_i32 s94, 346
    s_call_b64 s[46:47], .Ldrain
.Lag192:
    ds_read_b128 v[248:251], v6 offset:64
    s_waitcnt lgkmcnt(0)
    v_min3_i32 v248, v249, v250, v251
    v_add_u32 v9, 406, v8
    v_min_i32 v248, v248, v9
    ds_max_i32 v5, v248
    v_cmp_lt_i32 vcc, v248, v9
    s_sleep 2
    s_sub_u32 s88, s88, 1
    s_cbranch_scc1 .Lend
    s_cbranch_vccnz .Lag192
    s_cmpk_ge_i32 s44, 316
    s_cbranch_scc0 .Llf193
.Llr194:
    s_add_u32 s80, s75, 83968
    s_mov_b32 m0, 153600
    s_nop 0
    buffer_load_dwordx4 v4, s[4:7], s80 offen offset:0 lds
    buffer_load_dwordx4 v4, s[4:7], s80 offen offset:1024 lds
    buffer_load_dwordx4 v4, s[4:7], s80 offen offset:2048 lds
    buffer_load_dwordx4 v4, s[4:7], s80 offen offset:3072 lds
    s_add_u32 s80, s80, 4096
    s_mov_b32 m0, 157696
    s_nop 0
    buffer_load_dwordx4 v4, s[4:7], s80 offen offset:0 lds
    buffer_load_dwordx4 v4, s[4:7], s80 offen offset:1024 lds
    buffer_load_dwordx4 v4, s[4:7], s80 offen offset:2048 lds
    buffer_load_dwordx4 v4, s[4:7], s80 offen offset:3072 lds
    s_add_u32 s80, s80, 4096
    s_waitcnt vmcnt(0)
.Lag195:
    ds_read_b128 v[248:251], v6 offset:64
    s_waitcnt lgkmcnt(0)
    v_min3_i32 v248, v249, v250, v251
    v_add_u32 v9, 504, v8
    v_min_i32 v248, v248, v9
    ds_max_i32 v5, v248
    v_cmp_lt_i32 vcc, v248, v9
    s_sleep 2
    s_sub_u32 s88, s88, 1
    s_cbranch_scc1 .Lend
    s_cbranch_vccnz .Lag195
    s_or_b32 s68, s39, s40
    s_cmp_lg_u32 s68, 0
    s_cbranch_scc1 .Lfin
    s_mov_b32 s69, 0x29ec000
    s_mov_b32 exec_lo, 0xffffffff
    s_mov_b32 exec_hi, 0xffffffff
.Lp196:
    buffer_load_dword v9, v13, s[4:7], s69 offen sc1
    s_waitcnt vmcnt(0)
    v_cmp_ne_u32 vcc, s41, v9
    s_nop 0
    s_cbranch_vccz .Lpd197
    s_sleep 2
    s_sub_u32 s88, s88, 1
    s_cbranch_scc1 .Lend
    s_branch .Lp196
.Lpd197:
    s_mov_b64 exec, -1
    s_mov_b32 s69, 0x29ec100
    s_mov_b32 exec_lo, 0xffffffff
    s_mov_b32 exec_hi, 0xffffffff
.Lp198:
    buffer_load_dword v9, v13, s[4:7], s69 offen sc1
    s_waitcnt vmcnt(0)
    v_cmp_ne_u32 vcc, s41, v9
    s_nop 0
    s_cbranch_vccz .Lpd199
    s_sleep 2
    s_sub_u32 s88, s88, 1
    s_cbranch_scc1 .Lend
    s_branch .Lp198
.Lpd199:
    s_mov_b64 exec, -1
    s_mov_b32 s69, 0x29ec200
    s_mov_b32 exec_lo, 0xffffffff
    s_mov_b32 exec_hi, 0xffffffff
.Lp200:
    buffer_load_dword v9, v13, s[4:7], s69 offen sc1
    s_waitcnt vmcnt(0)
    v_cmp_ne_u32 vcc, s41, v9
    s_nop 0
    s_cbranch_vccz .Lpd201
    s_sleep 2
    s_sub_u32 s88, s88, 1
    s_cbranch_scc1 .Lend
    s_branch .Lp200
.Lpd201:
    s_mov_b64 exec, -1
    s_mov_b32 s69, 0x29ec300
    s_mov_b32 exec_lo, 0xffffffff
    s_mov_b32 exec_hi, 0xffffffff
.Lp202:
    buffer_load_dword v9, v13, s[4:7], s69 offen sc1
    s_waitcnt vmcnt(0)
    v_cmp_ne_u32 vcc, s41, v9
    s_nop 0
    s_cbranch_vccz .Lpd203
    s_sleep 2
    s_sub_u32 s88, s88, 1
    s_cbranch_scc1 .Lend
    s_branch .Lp202
.Lpd203:
    s_mov_b64 exec, -1
    s_mov_b32 s69, 0x29f0000
    buffer_store_dword v7, v11, s[4:7], s69 offen sc1
    s_branch .Lfin
.Lspin_free:
    ds_read_b64 v[2:3], v12
    ds_read_b32 v9, v12 offset:8
    ds_read_b32 v10, v12 offset:12
    s_waitcnt lgkmcnt(0)
    v_min3_i32 v2, v2, v3, v9
    v_min_i32 v2, v2, v10
    s_nop 0
    v_readfirstlane_b32 s44, v2
    s_nop 0
    s_sub_u32 s44, s44, s43
    s_cmp_ge_i32 s44, s45
    s_cbranch_scc1 .Lspin_ret
    s_getreg_b32 s71, hwreg(HW_REG_IB_STS)
    s_bfe_u32 s82, s71, 0x20016
    s_and_b32 s71, s71, 15
    s_lshl4_add_u32 s71, s82, s71
    s_sub_u32 s71, s94, s71
    v_add_u32 v9, s71, v8
    ds_max_i32 v5, v9
    s_sleep 1
    s_sub_u32 s88, s88, 1
    s_cbranch_scc1 .Lend
    s_branch .Lspin_free
.Lspin_freeE:
    ds_read_b128 v[248:251], v12
    ds_read_b128 v[252:255], v12 offset:16
    s_waitcnt lgkmcnt(0)
    v_min3_i32 v248, v248, v249, v250
    v_min3_i32 v248, v248, v251, v255
    v_min3_i32 v2, v248, v253, v254
    s_nop 0
    v_readfirstlane_b32 s44, v2
    s_nop 0
    s_sub_u32 s44, s44, s43
    s_cmp_ge_i32 s44, s45
    s_cbranch_scc1 .Lspin_ret
    s_getreg_b32 s71, hwreg(HW_REG_IB_STS)
    s_bfe_u32 s82, s71, 0x20016
    s_and_b32 s71, s71, 15
    s_lshl4_add_u32 s71, s82, s71
    s_sub_u32 s71, s94, s71
    v_add_u32 v9, s71, v8
    ds_max_i32 v5, v9
    s_sleep 1
    s_sub_u32 s88, s88, 1
    s_cbranch_scc1 .Lend
    s_branch .Lspin_freeE
.Lpubnow:
    s_getreg_b32 s71, hwreg(HW_REG_IB_STS)
    s_bfe_u32 s82, s71, 0x20016
    s_and_b32 s71, s71, 15
    s_lshl4_add_u32 s71, s82, s71
    s_sub_u32 s71, s94, s71
    v_add_u32 v9, s71, v8
    ds_max_i32 v5, v9
    s_setpc_b64 s[46:47]
.Ldrain:
    s_getreg_b32 s71, hwreg(HW_REG_IB_STS)
    s_bfe_u32 s82, s71, 0x20016
    s_and_b32 s71, s71, 15
    s_lshl4_add_u32 s71, s82, s71
    s_sub_u32 s71, s94, s71
    v_add_u32 v9, s71, v8
    ds_max_i32 v5, v9
    s_cmp_eq_u32 s71, s94
    s_cbranch_scc1 .Lspin_ret
    s_sleep 1
    s_branch .Ldrain
.Lwait_full:
    ds_read_b32 v10, v6
    s_waitcnt lgkmcnt(0)
    v_readfirstlane_b32 s70, v10
    s_nop 0
    s_sub_u32 s70, s70, s43
    s_cmp_ge_i32 s70, s45
    s_cbranch_scc1 .Lspin_ret
    s_sleep 2
    s_sub_u32 s88, s88, 1
    s_cbranch_scc1 .Lend
    s_branch .Lwait_full
.Lhelper:
    s_mov_b32 s95, 99
    v_mov_b32 v248, 0x3f803f80
    v_mov_b32 v249, 0x3f803f80
    v_mov_b32 v250, 0x3f803f80
    v_mov_b32 v251, 0x3f803f80
    v_lshlrev_b32 v244, 2, v1
    s_sub_u32 s87, s38, 5
    s_lshl_b32 s89, s87, 5
    s_lshr_b32 s68, s2, 3
    s_add_u32 s89, s89, s68
    s_mul_i32 s87, s87, 10
    s_cmp_ge_u32 s89, 84
    s_cbranch_scc1 .Lh_nounit
    s_and_b32 s68, s2, 7
    s_mul_i32 s68, s68, 84
    s_add_u32 s89, s89, s68
    s_cmpk_ge_u32 s89, 160
    s_cbranch_scc1 .Lu_hi
    s_sub_u32 s90, s89, 0
    s_and_b32 s91, s90, 7
    s_lshr_b32 s90, s90, 3
    s_mov_b32 s10, 0xc8000
    s_mul_i32 s72, s90, 40960
    s_mov_b32 s73, 5120
    s_mov_b32 s74, 20480
    s_movk_i32 s75, 160
    s_movk_i32 s70, 6554
    s_movk_i32 s71, 1280
    s_movk_i32 s76, 0
    s_movk_i32 s77, 10
    s_mul_i32 s68, s91, 160
    s_mul_i32 s78, s91, 102400
    s_add_u32 s78, s78, 0x2480000
    s_mul_i32 s79, s91, 128
    s_lshl_b32 s69, s90, 2
    s_add_u32 s79, s79, s69
    s_add_u32 s79, s79, 0x29ea800
    s_mov_b64 s[8:9], s[20:21]
    s_mov_b32 s74, 25600
    s_mul_i32 s72, s90, 51200
    s_cmp_lt_u32 s90, 16
    s_cbranch_scc1 .Lu_dma
    s_mul_i32 s72, s90, 204800
    s_sub_u32 s72, s72, 3256320
    s_mov_b32 s73, 51200
    s_branch .Lu_dma
.Lu_hi:
    s_cmpk_ge_u32 s89, 480
    s_cbranch_scc1 .Lu_w2
    s_sub_u32 s90, s89, 160
    s_and_b32 s91, s90, 15
    s_lshr_b32 s90, s90, 4
    s_mov_b32 s10, 0x1e0000
    s_mul_i32 s72, s90, 98304
    s_mov_b32 s73, 12288
    s_mov_b32 s74, 49152
    s_movk_i32 s75, 192
    s_movk_i32 s70, 5462
    s_movk_i32 s71, 3072
    s_movk_i32 s76, 0
    s_movk_i32 s77, 12
    s_mul_i32 s68, s91, 192
    s_mul_i32 s78, s91, 122880
    s_add_u32 s78, s78, 0x2580000
    s_mul_i32 s79, s91, 128
    s_lshl_b32 s69, s90, 2
    s_add_u32 s79, s79, s69
    s_add_u32 s79, s79, 0x29eb000
    s_mov_b64 s[8:9], s[24:25]
    s_branch .Lu_dma
.Lu_w2:
    s_sub_u32 s90, s89, 480
    s_and_b32 s91, s90, 7
    s_lshr_b32 s90, s90, 3
    s_mov_b32 s10, 0x1e0000
    s_mul_i32 s72, s90, 40960
    s_mov_b32 s73, 5120
    s_mov_b32 s74, 20480
    s_movk_i32 s75, 160
    s_movk_i32 s70, 6554
    s_movk_i32 s71, 1280
    s_movk_i32 s76, 0
    s_movk_i32 s77, 10
    s_mul_i32 s68, s91, 160
    s_mul_i32 s78, s91, 245760
    s_add_u32 s78, s78, 0x2780000
    s_mul_i32 s79, s91, 128
    s_lshl_b32 s69, s90, 2
    s_add_u32 s79, s79, s69
    s_add_u32 s79, s79, 0x29eb800
    s_mov_b64 s[8:9], s[28:29]
    s_lshl_b32 s90, s90, 1
    s_lshl_b32 s72, s72, 1
.Lu_dma:
    s_and_b32 s9, s9, 0xffff
    s_add_u32 s72, s72, s68
    v_mul_u32_u24 v240, s70, v1
    v_lshrrev_b32 v240, 16, v240
    v_mul_u32_u24 v241, s77, v240
    v_sub_u32 v241, v1, v241
    v_cmp_gt_u32 s[56:57], 4, v240
    v_mul_u32_u24 v240, s71, v240
    v_lshl_add_u32 v240, v241, 4, v240
    s_lshl_b32 s81, s75, 2
    v_lshrrev_b32 v242, 2, v1
    v_mul_u32_u24 v242, s75, v242
    v_add_u32 v242, s80, v242
    v_and_b32 v241, 3, v1
    v_lshl_add_u32 v242, v241, 3, v242
    s_mov_b32 s86, s79
    s_movk_i32 s45, 1
    s_call_b64 s[46:47], .Lwait_full
    s_mov_b64 exec, s[56:57]
    s_mov_b32 s82, s80
    s_mov_b32 s83, s72
    s_mov_b32 m0, s82
    s_add_u32 s82, s82, s81
    buffer_load_dwordx4 v240, s[8:11], s83 offen lds
    s_add_u32 s83, s83, s73
    s_mov_b32 m0, s82
    s_add_u32 s82, s82, s81
    buffer_load_dwordx4 v240, s[8:11], s83 offen lds
    s_add_u32 s83, s83, s73
    s_mov_b32 m0, s82
    s_add_u32 s82, s82, s81
    buffer_load_dwordx4 v240, s[8:11], s83 offen lds
    s_add_u32 s83, s83, s73
    s_mov_b32 m0, s82
    s_add_u32 s82, s82, s81
    buffer_load_dwordx4 v240, s[8:11], s83 offen lds
    s_add_u32 s72, s72, s74
    s_mov_b32 s83, s72
    s_mov_b32 m0, s82
    s_add_u32 s82, s82, s81
    buffer_load_dwordx4 v240, s[8:11], s83 offen lds
    s_add_u32 s83, s83, s73
    s_mov_b32 m0, s82
    s_add_u32 s82, s82, s81
    buffer_load_dwordx4 v240, s[8:11], s83 offen lds
    s_add_u32 s83, s83, s73
    s_mov_b32 m0, s82
    s_add_u32 s82, s82, s81
    buffer_load_dwordx4 v240, s[8:11], s83 offen lds
    s_add_u32 s83, s83, s73
    s_mov_b32 m0, s82
    s_add_u32 s82, s82, s81
    buffer_load_dwordx4 v240, s[8:11], s83 offen lds
    s_cmpk_lt_u32 s89, 480
    s_cbranch_scc1 .Lh_d1
    s_add_u32 s72, s72, s74
    s_mov_b32 s83, s72
    s_mov_b32 m0, s82
    s_add_u32 s82, s82, s81
    buffer_load_dwordx4 v240, s[8:11], s83 offen lds
    s_add_u32 s83, s83, s73
    s_mov_b32 m0, s82
    s_add_u32 s82, s82, s81
    buffer_load_dwordx4 v240, s[8:11], s83 offen lds
    s_add_u32 s83, s83, s73
    s_mov_b32 m0, s82
    s_add_u32 s82, s82, s81
    buffer_load_dwordx4 v240, s[8:11], s83 offen lds
    s_add_u32 s83, s83, s73
    s_mov_b32 m0, s82
    s_add_u32 s82, s82, s81
    buffer_load_dwordx4 v240, s[8:11], s83 offen lds
    s_add_u32 s72, s72, s74
    s_mov_b32 s83, s72
    s_mov_b32 m0, s82
    s_add_u32 s82, s82, s81
    buffer_load_dwordx4 v240, s[8:11], s83 offen lds
    s_add_u32 s83, s83, s73
    s_mov_b32 m0, s82
    s_add_u32 s82, s82, s81
    buffer_load_dwordx4 v240, s[8:11], s83 offen lds
    s_add_u32 s83, s83, s73
    s_mov_b32 m0, s82
    s_add_u32 s82, s82, s81
    buffer_load_dwordx4 v240, s[8:11], s83 offen lds
    s_add_u32 s83, s83, s73
    s_mov_b32 m0, s82
    s_add_u32 s82, s82, s81
    buffer_load_dwordx4 v240, s[8:11], s83 offen lds
.Lh_d1:
    s_mov_b64 exec, -1
    s_setprio 2
    s_waitcnt vmcnt(0)
    s_call_b64 s[46:47], .Lrankw
    s_cmpk_ge_u32 s89, 480
    s_cbranch_scc1 .Lt_5
    s_cmpk_lt_u32 s89, 160
    s_cbranch_scc1 .Lt_5
    ds_read_b64_tr_b16 v[16:17], v242 offset:0
    ds_read_b64_tr_b16 v[18:19], v242 offset:3072
    ds_read_b64_tr_b16 v[20:21], v242 offset:32
    ds_read_b64_tr_b16 v[22:23], v242 offset:3104
    ds_read_b64_tr_b16 v[24:25], v242 offset:64
    ds_read_b64_tr_b16 v[26:27], v242 offset:3136
    ds_read_b64_tr_b16 v[28:29], v242 offset:96
    ds_read_b64_tr_b16 v[30:31], v242 offset:3168
    ds_read_b64_tr_b16 v[32:33], v242 offset:128
    ds_read_b64_tr_b16 v[34:35], v242 offset:3200
    ds_read_b64_tr_b16 v[36:37], v242 offset:160
    ds_read_b64_tr_b16 v[38:39], v242 offset:3232
    s_mul_i32 s97, s90, 6144
    s_mov_b32 s95, 0
    s_waitcnt lgkmcnt(10)
    v_mfma_f32_16x16x32_bf16 v[200:203], v[248:251], v[16:19], 0
    s_waitcnt lgkmcnt(8)
    v_mfma_f32_16x16x32_bf16 v[204:207], v[248:251], v[20:23], 0
    s_waitcnt lgkmcnt(6)
    v_mfma_f32_16x16x32_bf16 v[208:211], v[248:251], v[24:27], 0
    s_waitcnt lgkmcnt(4)
    v_mfma_f32_16x16x32_bf16 v[212:215], v[248:251], v[28:31], 0
    s_waitcnt lgkmcnt(2)
    v_mfma_f32_16x16x32_bf16 v[216:219], v[248:251], v[32:35], 0
    s_waitcnt lgkmcnt(0)
    v_mfma_f32_16x16x32_bf16 v[220:223], v[248:251], v[36:39], 0
    s_mul_i32 s68, s91, 10240
    s_lshl_b32 s69, s90, 9
    s_add_u32 s68, s68, s69
    s_add_u32 s68, s68, 0x29b0000
    v_cmp_eq_u32 vcc, 1, v3
    s_nop 1
    v_cndmask_b32 v200, v200, v204, vcc
    v_cmp_eq_u32 vcc, 2, v3
    s_nop 1
    v_cndmask_b32 v200, v200, v208, vcc
    v_cmp_eq_u32 vcc, 3, v3
    s_nop 1
    v_cndmask_b32 v200, v200, v212, vcc
    buffer_store_dword v200, v244, s[4:7], s68 offen offset:0 sc1
    v_cmp_eq_u32 vcc, 1, v3
    s_nop 1
    v_cndmask_b32 v216, v216, v220, vcc
    buffer_store_dword v216, v244, s[4:7], s68 offen offset:256 sc1
    s_branch .Lt_done
.Lt_5:
    s_and_b32 s69, s91, 1
    s_lshl_b32 s68, s69, 7
    s_sub_u32 s68, 128, s68
    v_add_u32 v243, s68, v242
    s_lshl_b32 s68, s69, 5
    v_add_u32 v242, s68, v242
    ds_read_b64_tr_b16 v[16:17], v242 offset:0
    ds_read_b64_tr_b16 v[18:19], v242 offset:2560
    ds_read_b64_tr_b16 v[20:21], v242 offset:32
    ds_read_b64_tr_b16 v[22:23], v242 offset:2592
    ds_read_b64_tr_b16 v[24:25], v242 offset:64
    ds_read_b64_tr_b16 v[26:27], v242 offset:2624
    ds_read_b64_tr_b16 v[28:29], v242 offset:96
    ds_read_b64_tr_b16 v[30:31], v242 offset:2656
    ds_read_b64_tr_b16 v[32:33], v243 offset:0
    ds_read_b64_tr_b16 v[34:35], v243 offset:2560
    s_mul_i32 s97, s90, 5120
    s_mov_b32 s95, 0
    s_cmpk_lt_u32 s89, 480
    s_cbranch_scc1 .Lt_done
    ds_read_b64_tr_b16 v[36:37], v242 offset:5120
    ds_read_b64_tr_b16 v[38:39], v242 offset:7680
    ds_read_b64_tr_b16 v[40:41], v242 offset:5152
    ds_read_b64_tr_b16 v[42:43], v242 offset:7712
    ds_read_b64_tr_b16 v[44:45], v242 offset:5184
    ds_read_b64_tr_b16 v[46:47], v242 offset:7744
    ds_read_b64_tr_b16 v[48:49], v242 offset:5216
    ds_read_b64_tr_b16 v[50:51], v242 offset:7776
    ds_read_b64_tr_b16 v[52:53], v243 offset:5120
    ds_read_b64_tr_b16 v[54:55], v243 offset:7680
    s_mov_b32 s95, 5
.Lt_done:
    s_add_u32 s97, s97, s78
    s_setprio 0
    s_branch .Lh_go
.Lh_store:
    s_add_u32 s82, s97, 4096
    s_add_u32 s83, s97, 8192
    buffer_store_dwordx4 v[16:19], v4, s[4:7], s97 offen offset:0 sc1
    buffer_store_dwordx4 v[20:23], v4, s[4:7], s97 offen offset:1024 sc1
    buffer_store_dwordx4 v[24:27], v4, s[4:7], s97 offen offset:2048 sc1
    buffer_store_dwordx4 v[28:31], v4, s[4:7], s97 offen offset:3072 sc1
    buffer_store_dwordx4 v[32:35], v4, s[4:7], s82 offen offset:0 sc1
    s_cmpk_lt_u32 s89, 160
    s_cbranch_scc1 .Lh_store2
    buffer_store_dwordx4 v[36:39], v4, s[4:7], s82 offen offset:1024 sc1
    s_cmpk_lt_u32 s89, 480
    s_cbranch_scc1 .Lh_store2
    buffer_store_dwordx4 v[40:43], v4, s[4:7], s82 offen offset:2048 sc1
    buffer_store_dwordx4 v[44:47], v4, s[4:7], s82 offen offset:3072 sc1
    buffer_store_dwordx4 v[48:51], v4, s[4:7], s83 offen offset:0 sc1
    buffer_store_dwordx4 v[52:55], v4, s[4:7], s83 offen offset:1024 sc1
.Lh_store2:
    s_setpc_b64 s[46:47]
.Lh_nounit:
    s_call_b64 s[46:47], .Lrankw
.Lh_go:
    v_mov_b32 v9, s87
    ds_write_b32 v5, v9
    s_waitcnt lgkmcnt(0)
    s_cmp_lg_u32 s95, 0
    s_cbranch_scc1 .Lhs204
    s_call_b64 s[46:47], .Lh_store
.Lhs204:
    s_add_u32 s68, s87, 150
    v_mov_b32 v9, s68
    ds_write_b32 v5, v9 offset:64
    s_mul_i32 s72, s40, 153600
    s_lshl_b32 s73, s87, 10
    s_add_u32 s72, s72, s73
    s_add_u32 s72, s72, 0x2201000
    s_cmp_lg_u32 s95, 0
    s_cbranch_scc1 .Lhs205
    s_waitcnt vmcnt(0)
    buffer_store_dword v7, v11, s[4:7], s86 offen sc1
.Lhs205:
    s_lshl_b32 s68, s38, 2
    s_sub_u32 s68, s68, 16
    v_subrev_u32 v13, s68, v5
    s_add_u32 s45, s87, 10
    s_call_b64 s[46:47], .Lwait_full
    s_lshl_b32 s68, s87, 10
    s_add_u32 s68, s68, 0
    v_add_u32 v12, s68, v4
    ds_read_b128 v[56:59], v12 offset:0
    ds_read_b128 v[60:63], v12 offset:1024
    ds_read_b128 v[64:67], v12 offset:2048
    ds_read_b128 v[68:71], v12 offset:3072
    ds_read_b128 v[72:75], v12 offset:4096
    ds_read_b128 v[76:79], v12 offset:5120
    ds_read_b128 v[80:83], v12 offset:6144
    ds_read_b128 v[84:87], v12 offset:7168
    ds_read_b128 v[88:91], v12 offset:8192
    ds_read_b128 v[92:95], v12 offset:9216
    s_add_u32 s68, s87, 30
    v_mov_b32 v9, s68
    ds_write_b32 v5, v9
    s_add_u32 s45, s87, 40
    s_call_b64 s[46:47], .Lwait_full
    s_lshl_b32 s68, s87, 10
    s_add_u32 s68, s68, 30720
    v_add_u32 v12, s68, v4
    ds_read_b128 v[96:99], v12 offset:0
    ds_read_b128 v[100:103], v12 offset:1024
    ds_read_b128 v[104:107], v12 offset:2048
    ds_read_b128 v[108:111], v12 offset:3072
    ds_read_b128 v[112:115], v12 offset:4096
    ds_read_b128 v[116:119], v12 offset:5120
    ds_read_b128 v[120:123], v12 offset:6144
    ds_read_b128 v[124:127], v12 offset:7168
    ds_read_b128 v[128:131], v12 offset:8192
    ds_read_b128 v[132:135], v12 offset:9216
    s_add_u32 s68, s87, 60
    v_mov_b32 v9, s68
    ds_write_b32 v5, v9
    s_add_u32 s45, s87, 70
    s_call_b64 s[46:47], .Lwait_full
    s_lshl_b32 s68, s87, 10
    s_add_u32 s68, s68, 61440
    v_add_u32 v12, s68, v4
    ds_read_b128 v[136:139], v12 offset:0
    ds_read_b128 v[140:143], v12 offset:1024
    ds_read_b128 v[144:147], v12 offset:2048
    ds_read_b128 v[148:151], v12 offset:3072
    ds_read_b128 v[152:155], v12 offset:4096
    ds_read_b128 v[156:159], v12 offset:5120
    ds_read_b128 v[160:163], v12 offset:6144
    ds_read_b128 v[164:167], v12 offset:7168
    ds_read_b128 v[168:171], v12 offset:8192
    ds_read_b128 v[172:175], v12 offset:9216
    s_add_u32 s68, s87, 90
    v_mov_b32 v9, s68
    ds_write_b32 v5, v9
    s_add_u32 s45, s87, 100
    s_call_b64 s[46:47], .Lwait_full
    s_lshl_b32 s68, s87, 10
    s_add_u32 s68, s68, 92160
    v_add_u32 v12, s68, v4
    ds_read_b128 v[176:179], v12 offset:0
    ds_read_b128 v[180:183], v12 offset:1024
    ds_read_b128 v[184:187], v12 offset:2048
    ds_read_b128 v[188:191], v12 offset:3072
    ds_read_b128 v[192:195], v12 offset:4096
    ds_read_b128 v[196:199], v12 offset:5120
    ds_read_b128 v[200:203], v12 offset:6144
    ds_read_b128 v[204:207], v12 offset:7168
    ds_read_b128 v[208:211], v12 offset:8192
    ds_read_b128 v[212:215], v12 offset:9216
    s_add_u32 s68, s87, 120
    v_mov_b32 v9, s68
    ds_write_b32 v5, v9
    s_add_u32 s45, s87, 130
    s_call_b64 s[46:47], .Lwait_full
    s_lshl_b32 s68, s87, 10
    s_add_u32 s68, s68, 122880
    v_add_u32 v12, s68, v4
    ds_read_b128 v[216:219], v12 offset:0
    ds_read_b128 v[220:223], v12 offset:1024
    ds_read_b128 v[224:227], v12 offset:2048
    ds_read_b128 v[228:231], v12 offset:3072
    ds_read_b128 v[232:235], v12 offset:4096
    ds_read_b128 v[236:239], v12 offset:5120
    ds_read_b128 v[240:243], v12 offset:6144
    ds_read_b128 v[244:247], v12 offset:7168
    ds_read_b128 v[248:251], v12 offset:8192
    ds_read_b128 v[252:255], v12 offset:9216
    s_add_u32 s68, s87, 1048576
    v_mov_b32 v9, s68
    ds_write_b32 v5, v9
    s_cmp_lg_u32 s95, 5
    s_cbranch_scc1 .Lhs206
    s_call_b64 s[46:47], .Lh_store
    s_waitcnt vmcnt(0)
    buffer_store_dword v7, v11, s[4:7], s86 offen sc1
.Lhs206:
    s_movk_i32 s45, 632
    s_call_b64 s[46:47], .Lwait_cfree
    s_lshl_b32 s68, s87, 10
    s_add_u32 s68, s68, 0
    v_add_u32 v12, s68, v4
    ds_read_b128 v[16:19], v12 offset:0
    ds_read_b128 v[20:23], v12 offset:1024
    ds_read_b128 v[24:27], v12 offset:2048
    ds_read_b128 v[28:31], v12 offset:3072
    ds_read_b128 v[32:35], v12 offset:4096
    ds_read_b128 v[36:39], v12 offset:5120
    ds_read_b128 v[40:43], v12 offset:6144
    ds_read_b128 v[44:47], v12 offset:7168
    ds_read_b128 v[48:51], v12 offset:8192
    ds_read_b128 v[52:55], v12 offset:9216
    ds_write_b128 v12, v[56:59] offset:0
    ds_write_b128 v12, v[60:63] offset:1024
    ds_write_b128 v12, v[64:67] offset:2048
    ds_write_b128 v12, v[68:71] offset:3072
    ds_write_b128 v12, v[72:75] offset:4096
    ds_write_b128 v12, v[76:79] offset:5120
    ds_write_b128 v12, v[80:83] offset:6144
    ds_write_b128 v12, v[84:87] offset:7168
    ds_write_b128 v12, v[88:91] offset:8192
    ds_write_b128 v12, v[92:95] offset:9216
    s_add_u32 s68, s87, 662
    v_mov_b32 v9, s68
    ds_write_b32 v5, v9 offset:64
    s_lshl_b32 s68, s87, 10
    s_add_u32 s68, s68, 30720
    v_add_u32 v12, s68, v4
    ds_read_b128 v[56:59], v12 offset:0
    ds_read_b128 v[60:63], v12 offset:1024
    ds_read_b128 v[64:67], v12 offset:2048
    ds_read_b128 v[68:71], v12 offset:3072
    ds_read_b128 v[72:75], v12 offset:4096
    ds_read_b128 v[76:79], v12 offset:5120
    ds_read_b128 v[80:83], v12 offset:6144
    ds_read_b128 v[84:87], v12 offset:7168
    ds_read_b128 v[88:91], v12 offset:8192
    ds_read_b128 v[92:95], v12 offset:9216
    ds_write_b128 v12, v[96:99] offset:0
    ds_write_b128 v12, v[100:103] offset:1024
    ds_write_b128 v12, v[104:107] offset:2048
    ds_write_b128 v12, v[108:111] offset:3072
    ds_write_b128 v12, v[112:115] offset:4096
    ds_write_b128 v12, v[116:119] offset:5120
    ds_write_b128 v12, v[120:123] offset:6144
    ds_write_b128 v12, v[124:127] offset:7168
    ds_write_b128 v12, v[128:131] offset:8192
    ds_write_b128 v12, v[132:135] offset:9216
    s_add_u32 s68, s87, 692
    v_mov_b32 v9, s68
    ds_write_b32 v5, v9 offset:64
    s_lshl_b32 s68, s87, 10
    s_add_u32 s68, s68, 61440
    v_add_u32 v12, s68, v4
    ds_read_b128 v[96:99], v12 offset:0
    ds_read_b128 v[100:103], v12 offset:1024
    ds_read_b128 v[104:107], v12 offset:2048
    ds_read_b128 v[108:111], v12 offset:3072
    ds_read_b128 v[112:115], v12 offset:4096
    ds_read_b128 v[116:119], v12 offset:5120
    ds_read_b128 v[120:123], v12 offset:6144
    ds_read_b128 v[124:127], v12 offset:7168
    ds_read_b128 v[128:131], v12 offset:8192
    ds_read_b128 v[132:135], v12 offset:9216
    ds_write_b128 v12, v[136:139] offset:0
    ds_write_b128 v12, v[140:143] offset:1024
    ds_write_b128 v12, v[144:147] offset:2048
    ds_write_b128 v12, v[148:151] offset:3072
    ds_write_b128 v12, v[152:155] offset:4096
    ds_write_b128 v12, v[156:159] offset:5120
    ds_write_b128 v12, v[160:163] offset:6144
    ds_write_b128 v12, v[164:167] offset:7168
    ds_write_b128 v12, v[168:171] offset:8192
    ds_write_b128 v12, v[172:175] offset:9216
    s_add_u32 s68, s87, 722
    v_mov_b32 v9, s68
    ds_write_b32 v5, v9 offset:64
    s_lshl_b32 s68, s87, 10
    s_add_u32 s68, s68, 92160
    v_add_u32 v12, s68, v4
    ds_read_b128 v[136:139], v12 offset:0
    ds_read_b128 v[140:143], v12 offset:1024
    ds_read_b128 v[144:147], v12 offset:2048
    ds_read_b128 v[148:151], v12 offset:3072
    ds_read_b128 v[152:155], v12 offset:4096
    ds_read_b128 v[156:159], v12 offset:5120
    ds_read_b128 v[160:163], v12 offset:6144
    ds_read_b128 v[164:167], v12 offset:7168
    ds_read_b128 v[168:171], v12 offset:8192
    ds_read_b128 v[172:175], v12 offset:9216
    ds_write_b128 v12, v[176:179] offset:0
    ds_write_b128 v12, v[180:183] offset:1024
    ds_write_b128 v12, v[184:187] offset:2048
    ds_write_b128 v12, v[188:191] offset:3072
    ds_write_b128 v12, v[192:195] offset:4096
    ds_write_b128 v12, v[196:199] offset:5120
    ds_write_b128 v12, v[200:203] offset:6144
    ds_write_b128 v12, v[204:207] offset:7168
    ds_write_b128 v12, v[208:211] offset:8192
    ds_write_b128 v12, v[212:215] offset:9216
    s_add_u32 s68, s87, 752
    v_mov_b32 v9, s68
    ds_write_b32 v5, v9 offset:64
    s_lshl_b32 s68, s87, 10
    s_add_u32 s68, s68, 122880
    v_add_u32 v12, s68, v4
    ds_read_b128 v[176:179], v12 offset:0
    ds_read_b128 v[180:183], v12 offset:1024
    ds_read_b128 v[184:187], v12 offset:2048
    ds_read_b128 v[188:191], v12 offset:3072
    ds_read_b128 v[192:195], v12 offset:4096
    ds_read_b128 v[196:199], v12 offset:5120
    ds_read_b128 v[200:203], v12 offset:6144
    ds_read_b128 v[204:207], v12 offset:7168
    ds_read_b128 v[208:211], v12 offset:8192
    ds_read_b128 v[212:215], v12 offset:9216
    ds_write_b128 v12, v[216:219] offset:0
    ds_write_b128 v12, v[220:223] offset:1024
    ds_write_b128 v12, v[224:227] offset:2048
    ds_write_b128 v12, v[228:231] offset:3072
    ds_write_b128 v12, v[232:235] offset:4096
    ds_write_b128 v12, v[236:239] offset:5120
    ds_write_b128 v12, v[240:243] offset:6144
    ds_write_b128 v12, v[244:247] offset:7168
    ds_write_b128 v12, v[248:251] offset:8192
    ds_write_b128 v12, v[252:255] offset:9216
    s_add_u32 s68, s87, 978
    v_mov_b32 v9, s68
    ds_write_b32 v5, v9 offset:64
    s_waitcnt lgkmcnt(0)
    s_movk_i32 s45, 890
    s_call_b64 s[46:47], .Lwait_cfree
    s_lshl_b32 s68, s87, 10
    s_add_u32 s68, s68, 30720
    v_add_u32 v12, s68, v4
    ds_write_b128 v12, v[56:59] offset:0
    ds_write_b128 v12, v[60:63] offset:1024
    ds_write_b128 v12, v[64:67] offset:2048
    ds_write_b128 v12, v[68:71] offset:3072
    ds_write_b128 v12, v[72:75] offset:4096
    ds_write_b128 v12, v[76:79] offset:5120
    ds_write_b128 v12, v[80:83] offset:6144
    ds_write_b128 v12, v[84:87] offset:7168
    ds_write_b128 v12, v[88:91] offset:8192
    ds_write_b128 v12, v[92:95] offset:9216
    s_add_u32 s68, s87, 1008
    v_mov_b32 v9, s68
    ds_write_b32 v5, v9 offset:64
    s_lshl_b32 s68, s87, 10
    s_add_u32 s68, s68, 61440
    v_add_u32 v12, s68, v4
    ds_write_b128 v12, v[96:99] offset:0
    ds_write_b128 v12, v[100:103] offset:1024
    ds_write_b128 v12, v[104:107] offset:2048
    ds_write_b128 v12, v[108:111] offset:3072
    ds_write_b128 v12, v[112:115] offset:4096
    ds_write_b128 v12, v[116:119] offset:5120
    ds_write_b128 v12, v[120:123] offset:6144
    ds_write_b128 v12, v[124:127] offset:7168
    ds_write_b128 v12, v[128:131] offset:8192
    ds_write_b128 v12, v[132:135] offset:9216
    s_add_u32 s68, s87, 1038
    v_mov_b32 v9, s68
    ds_write_b32 v5, v9 offset:64
    s_movk_i32 s45, 1016
    s_call_b64 s[46:47], .Lwait_cfree
    s_lshl_b32 s68, s87, 10
    s_add_u32 s68, s68, 92160
    v_add_u32 v12, s68, v4
    ds_write_b128 v12, v[136:139] offset:0
    ds_write_b128 v12, v[140:143] offset:1024
    ds_write_b128 v12, v[144:147] offset:2048
    ds_write_b128 v12, v[148:151] offset:3072
    ds_write_b128 v12, v[152:155] offset:4096
    ds_write_b128 v12, v[156:159] offset:5120
    ds_write_b128 v12, v[160:163] offset:6144
    ds_write_b128 v12, v[164:167] offset:7168
    ds_write_b128 v12, v[168:171] offset:8192
    ds_write_b128 v12, v[172:175] offset:9216
    s_add_u32 s68, s87, 1068
    v_mov_b32 v9, s68
    ds_write_b32 v5, v9 offset:64
    s_lshl_b32 s68, s87, 10
    s_add_u32 s68, s68, 122880
    v_add_u32 v12, s68, v4
    ds_write_b128 v12, v[176:179] offset:0
    ds_write_b128 v12, v[180:183] offset:1024
    ds_write_b128 v12, v[184:187] offset:2048
    ds_write_b128 v12, v[188:191] offset:3072
    ds_write_b128 v12, v[192:195] offset:4096
    ds_write_b128 v12, v[196:199] offset:5120
    ds_write_b128 v12, v[200:203] offset:6144
    ds_write_b128 v12, v[204:207] offset:7168
    ds_write_b128 v12, v[208:211] offset:8192
    ds_write_b128 v12, v[212:215] offset:9216
    s_add_u32 s68, s87, 1106
    v_mov_b32 v9, s68
    ds_write_b32 v5, v9 offset:64
    s_lshl_b32 s68, s87, 10
    s_add_u32 s68, s68, 0
    v_add_u32 v12, s68, v4
    ds_write_b128 v12, v[16:19] offset:0
    ds_write_b128 v12, v[20:23] offset:1024
    ds_write_b128 v12, v[24:27] offset:2048
    ds_write_b128 v12, v[28:31] offset:3072
    ds_write_b128 v12, v[32:35] offset:4096
    ds_write_b128 v12, v[36:39] offset:5120
    ds_write_b128 v12, v[40:43] offset:6144
    ds_write_b128 v12, v[44:47] offset:7168
    ds_write_b128 v12, v[48:51] offset:8192
    ds_write_b128 v12, v[52:55] offset:9216
    s_add_u32 s68, s87, 1632
    v_mov_b32 v9, s68
    ds_write_b32 v5, v9 offset:64
    s_branch .Lfin
.Lwait_cfree:
    v_subrev_u32 v9, 16, v6
.Lwait_cfree1:
    ds_read_b64 v[14:15], v9
    ds_read_b64 v[2:3], v9 offset:8
    s_waitcnt lgkmcnt(0)
    v_min3_i32 v14, v14, v15, v2
    v_min_i32 v14, v14, v3
    s_nop 0
    v_readfirstlane_b32 s70, v14
    s_nop 0
    s_cmp_ge_i32 s70, s45
    s_cbranch_scc1 .Lspin_ret
    s_sleep 2
    s_sub_u32 s88, s88, 1
    s_cbranch_scc1 .Lend
    s_branch .Lwait_cfree1
.Lspin_full:
.Lspin_full2:
    ds_read_b32 v10, v6
    s_waitcnt lgkmcnt(0)
    v_readfirstlane_b32 s44, v10
    s_nop 0
    s_sub_u32 s44, s44, s43
    s_cmp_ge_i32 s44, s45
    s_cbranch_scc1 .Lspin_ret2
    s_sub_u32 s88, s88, 1
    s_cbranch_scc1 .Lend
    s_branch .Lspin_full2
.Lspin_ret2:
.Lspin_ret:
    s_setpc_b64 s[46:47]
.Lcf3:
    s_movk_i32 s45, 15
    s_call_b64 s[46:47], .Lspin_full
    s_branch .Lcr4
.Lcf5:
    s_movk_i32 s45, 30
    s_call_b64 s[46:47], .Lspin_full
    s_branch .Lcr6
.Lcf7:
    s_movk_i32 s45, 45
    s_call_b64 s[46:47], .Lspin_full
    s_branch .Lcr8
.Lcf9:
    s_movk_i32 s45, 60
    s_call_b64 s[46:47], .Lspin_full
    s_branch .Lcr10
.Lcf11:
    s_movk_i32 s45, 75
    s_call_b64 s[46:47], .Lspin_full
    s_branch .Lcr12
.Lcf13:
    s_movk_i32 s45, 90
    s_call_b64 s[46:47], .Lspin_full
    s_branch .Lcr14
.Lcf15:
    s_movk_i32 s45, 105
    s_call_b64 s[46:47], .Lspin_full
    s_branch .Lcr16
.Lcf17:
    s_movk_i32 s45, 120
    s_call_b64 s[46:47], .Lspin_full
    s_branch .Lcr18
.Lcf19:
    s_movk_i32 s45, 135
    s_call_b64 s[46:47], .Lspin_full
    s_branch .Lcr20
.Lcf21:
    s_movk_i32 s45, 150
    s_call_b64 s[46:47], .Lspin_full
    s_branch .Lcr22
.Ls23:
    buffer_store_dwordx4 v[64:67], v131, s[4:7], s77 offen offset:0 sc1
    s_branch .Ls24
.Ls25:
    buffer_store_dwordx4 v[68:71], v131, s[4:7], s77 offen offset:512 sc1
    s_branch .Ls26
.Ls27:
    buffer_store_dwordx4 v[76:79], v132, s[4:7], s77 offen offset:1024 sc1
    s_branch .Ls28
.Ls29:
    buffer_store_dwordx4 v[80:83], v132, s[4:7], s77 offen offset:1536 sc1
    s_branch .Ls30
.Ls31:
    buffer_store_dwordx4 v[60:63], v4, s[4:7], s73 offen sc1
    s_branch .Ls32
.Ls33:
    buffer_store_dwordx2 v[76:77], v136, s[4:7], s75 offen sc1
    s_branch .Ls34
.Ls38:
    buffer_store_dwordx4 v[28:31], v4, s[4:7], s72 offen sc1
    s_branch .Ls39
.Ls40:
    buffer_store_dwordx2 v[44:45], v136, s[4:7], s74 offen sc1
    s_branch .Ls41
.Lcf42:
    s_movk_i32 s45, 218
    s_call_b64 s[46:47], .Lspin_full
    s_branch .Lcr43
.Lcf46:
    s_movk_i32 s45, 258
    s_call_b64 s[46:47], .Lspin_full
    s_branch .Lcr47
.Lcf48:
    s_movk_i32 s45, 294
    s_call_b64 s[46:47], .Lspin_full
    s_branch .Lcr49
.Lcf52:
    s_movk_i32 s45, 282
    s_call_b64 s[46:47], .Lspin_full
    s_branch .Lcr53
.Lcf54:
    s_movk_i32 s45, 294
    s_call_b64 s[46:47], .Lspin_full
    s_branch .Lcr55
.Lcf56:
    s_movk_i32 s45, 306
    s_call_b64 s[46:47], .Lspin_full
    s_branch .Lcr57
.Lcf58:
    s_movk_i32 s45, 318
    s_call_b64 s[46:47], .Lspin_full
    s_branch .Lcr59
.Lcf60:
    s_movk_i32 s45, 330
    s_call_b64 s[46:47], .Lspin_full
    s_branch .Lcr61
.Lcf62:
    s_movk_i32 s45, 342
    s_call_b64 s[46:47], .Lspin_full
    s_branch .Lcr63
.Lcf64:
    s_movk_i32 s45, 354
    s_call_b64 s[46:47], .Lspin_full
    s_branch .Lcr65
.Lcf66:
    s_movk_i32 s45, 366
    s_call_b64 s[46:47], .Lspin_full
    s_branch .Lcr67
.Lcf68:
    s_movk_i32 s45, 378
    s_call_b64 s[46:47], .Lspin_full
    s_branch .Lcr69
.Ls70:
    buffer_store_dwordx4 v[144:147], v4, s[4:7], s68 offen offset:0 sc1
    s_branch .Ls71
.Ls72:
    buffer_store_dwordx4 v[148:151], v4, s[4:7], s68 offen offset:1024 sc1
    s_branch .Ls73
.Ls74:
    buffer_store_dwordx4 v[152:155], v4, s[4:7], s68 offen offset:2048 sc1
    s_branch .Ls75
.Ls76:
    buffer_store_dwordx4 v[156:159], v4, s[4:7], s69 offen offset:0 sc1
    s_branch .Ls77
.Ls78:
    buffer_store_dwordx4 v[160:163], v4, s[4:7], s69 offen offset:1024 sc1
    s_branch .Ls79
.Ls80:
    buffer_store_dwordx4 v[164:167], v4, s[4:7], s69 offen offset:2048 sc1
    s_branch .Ls81
.Lcf82:
    s_movk_i32 s45, 414
    s_call_b64 s[46:47], .Lspin_full
    s_branch .Lcr83
.Lcf86:
    s_movk_i32 s45, 444
    s_call_b64 s[46:47], .Lspin_full
    s_branch .Lcr87
.Lcf88:
    s_movk_i32 s45, 474
    s_call_b64 s[46:47], .Lspin_full
    s_branch .Lcr89
.Lcf90:
    s_movk_i32 s45, 504
    s_call_b64 s[46:47], .Lspin_full
    s_branch .Lcr91
.Llf95:
    s_movk_i32 s45, -143
    s_movk_i32 s94, 0
    s_call_b64 s[46:47], .Lspin_freeE
    s_branch .Llr96
.Llf97:
    s_movk_i32 s45, -128
    s_movk_i32 s94, 15
    s_call_b64 s[46:47], .Lspin_freeE
    s_branch .Llr98
.Llf99:
    s_movk_i32 s45, -113
    s_movk_i32 s94, 30
    s_call_b64 s[46:47], .Lspin_freeE
    s_branch .Llr100
.Llf101:
    s_movk_i32 s45, -98
    s_movk_i32 s94, 45
    s_call_b64 s[46:47], .Lspin_freeE
    s_branch .Llr102
.Llf103:
    s_movk_i32 s45, -83
    s_movk_i32 s94, 60
    s_call_b64 s[46:47], .Lspin_freeE
    s_branch .Llr104
.Llf105:
    s_movk_i32 s45, -68
    s_movk_i32 s94, 75
    s_call_b64 s[46:47], .Lspin_freeE
    s_branch .Llr106
.Llf107:
    s_movk_i32 s45, -53
    s_movk_i32 s94, 90
    s_call_b64 s[46:47], .Lspin_freeE
    s_branch .Llr108
.Llf109:
    s_movk_i32 s45, -38
    s_movk_i32 s94, 105
    s_call_b64 s[46:47], .Lspin_freeE
    s_branch .Llr110
.Llf111:
    s_movk_i32 s45, -23
    s_movk_i32 s94, 120
    s_call_b64 s[46:47], .Lspin_freeE
    s_branch .Llr112
.Llf113:
    s_movk_i32 s45, -8
    s_movk_i32 s94, 135
    s_call_b64 s[46:47], .Lspin_freeE
    s_branch .Llr114
.Llf117:
    s_movk_i32 s45, 10
    s_movk_i32 s94, 158
    s_call_b64 s[46:47], .Lspin_free
    s_branch .Llr118
.Llf119:
    s_movk_i32 s45, 20
    s_movk_i32 s94, 168
    s_call_b64 s[46:47], .Lspin_free
    s_branch .Llr120
.Llf121:
    s_movk_i32 s45, 30
    s_movk_i32 s94, 178
    s_call_b64 s[46:47], .Lspin_free
    s_branch .Llr122
.Llf123:
    s_movk_i32 s45, 40
    s_movk_i32 s94, 188
    s_call_b64 s[46:47], .Lspin_free
    s_branch .Llr124
.Llf125:
    s_movk_i32 s45, 50
    s_movk_i32 s94, 198
    s_call_b64 s[46:47], .Lspin_free
    s_branch .Llr126
.Llf127:
    s_movk_i32 s45, 60
    s_movk_i32 s94, 208
    s_call_b64 s[46:47], .Lspin_free
    s_branch .Llr128
.Llf129:
    s_movk_i32 s45, 70
    s_movk_i32 s94, 218
    s_call_b64 s[46:47], .Lspin_free
    s_branch .Llr130
.Llf131:
    s_movk_i32 s45, 80
    s_movk_i32 s94, 228
    s_call_b64 s[46:47], .Lspin_free
    s_branch .Llr132
.Llf133:
    s_movk_i32 s45, 90
    s_movk_i32 s94, 238
    s_call_b64 s[46:47], .Lspin_free
    s_branch .Llr134
.Llf135:
    s_movk_i32 s45, 100
    s_movk_i32 s94, 248
    s_call_b64 s[46:47], .Lspin_free
    s_branch .Llr136
.Llf137:
    s_movk_i32 s45, 158
    s_movk_i32 s94, 258
    s_call_b64 s[46:47], .Lspin_free
    s_branch .Llr138
.Llf142:
    s_movk_i32 s45, 112
    s_movk_i32 s94, 258
    s_call_b64 s[46:47], .Lspin_free
    s_branch .Llr143
.Llf144:
    s_movk_i32 s45, 124
    s_movk_i32 s94, 270
    s_call_b64 s[46:47], .Lspin_free
    s_branch .Llr145
.Llf147:
    s_movk_i32 s45, 136
    s_movk_i32 s94, 282
    s_call_b64 s[46:47], .Lspin_free
    s_branch .Llr148
.Llf149:
    s_movk_i32 s45, 148
    s_movk_i32 s94, 294
    s_call_b64 s[46:47], .Lspin_free
    s_branch .Llr150
.Llf151:
    s_movk_i32 s45, 158
    s_movk_i32 s94, 306
    s_call_b64 s[46:47], .Lspin_free
    s_branch .Llr152
.Llf153:
    s_movk_i32 s45, 168
    s_movk_i32 s94, 316
    s_call_b64 s[46:47], .Lspin_free
    s_branch .Llr154
.Llf155:
    s_movk_i32 s45, 178
    s_movk_i32 s94, 326
    s_call_b64 s[46:47], .Lspin_free
    s_branch .Llr156
.Llf157:
    s_movk_i32 s45, 188
    s_movk_i32 s94, 336
    s_call_b64 s[46:47], .Lspin_free
    s_branch .Llr158
.Llf159:
    s_movk_i32 s45, 200
    s_movk_i32 s94, 346
    s_call_b64 s[46:47], .Lspin_free
    s_branch .Llr160
.Llf161:
    s_movk_i32 s45, 210
    s_movk_i32 s94, 358
    s_call_b64 s[46:47], .Lspin_free
    s_branch .Llr162
.Llf163:
    s_movk_i32 s45, 220
    s_movk_i32 s94, 368
    s_call_b64 s[46:47], .Lspin_free
    s_branch .Llr164
.Llf167:
    s_movk_i32 s45, 236
    s_movk_i32 s94, 384
    s_call_b64 s[46:47], .Lspin_free
    s_branch .Llr168
.Llf169:
    s_movk_i32 s45, 246
    s_movk_i32 s94, 394
    s_call_b64 s[46:47], .Lspin_free
    s_branch .Llr170
.Llf171:
    s_movk_i32 s45, 256
    s_movk_i32 s94, 404
    s_call_b64 s[46:47], .Lspin_free
    s_branch .Llr172
.Llf173:
    s_movk_i32 s45, 266
    s_movk_i32 s94, 414
    s_call_b64 s[46:47], .Lspin_free
    s_branch .Llr174
.Llf175:
    s_movk_i32 s45, 276
    s_movk_i32 s94, 424
    s_call_b64 s[46:47], .Lspin_free
    s_branch .Llr176
.Llf177:
    s_movk_i32 s45, 286
    s_movk_i32 s94, 434
    s_call_b64 s[46:47], .Lspin_free
    s_branch .Llr178
.Llf179:
    s_movk_i32 s45, 296
    s_movk_i32 s94, 444
    s_call_b64 s[46:47], .Lspin_free
    s_branch .Llr180
.Llf181:
    s_movk_i32 s45, 306
    s_movk_i32 s94, 454
    s_call_b64 s[46:47], .Lspin_free
    s_branch .Llr182
.Llf183:
    s_movk_i32 s45, 316
    s_movk_i32 s94, 464
    s_call_b64 s[46:47], .Lspin_free
    s_branch .Llr184
.Llf185:
    s_movk_i32 s45, 326
    s_movk_i32 s94, 474
    s_call_b64 s[46:47], .Lspin_free
    s_branch .Llr186
.Llf187:
    s_movk_i32 s45, 336
    s_movk_i32 s94, 484
    s_call_b64 s[46:47], .Lspin_free
    s_branch .Llr188
.Llf189:
    s_movk_i32 s45, 346
    s_movk_i32 s94, 494
    s_call_b64 s[46:47], .Lspin_free
    s_branch .Llr190
.Llf193:
    s_movk_i32 s45, 316
    s_movk_i32 s94, 346
    s_call_b64 s[46:47], .Lspin_free
    s_branch .Llr194
.Lfin:
.Lend:
    s_endpgm
.Lcode_end:
.section .rodata,"a"
.p2align 6
.amdhsa_kernel interleave_layers__sliding_local_dilated__dense_activation_squared_relu__prompt_kernel
  .amdhsa_next_free_vgpr 256
  .amdhsa_next_free_sgpr 102
  .amdhsa_accum_offset 256
  .amdhsa_group_segment_fixed_size 0
  .amdhsa_kernarg_size 88
  .amdhsa_user_sgpr_count 2
  .amdhsa_user_sgpr_kernarg_segment_ptr 1
  .amdhsa_system_sgpr_workgroup_id_x 1
.end_amdhsa_kernel
```
